```python
import torch

def _softmax(x, axis=-1):
    return torch.softmax(x, dim=axis)
def _gelu(x):
    return torch.nn.functional.gelu(x, approximate="tanh")
def _silu(x):
    return torch.nn.functional.silu(x)
def _sigmoid(x):
    return torch.sigmoid(x)
def _layernorm(x, axis=-1, eps=1e-5):
    m = x.mean(dim=axis, keepdim=True)
    v = x.var(dim=axis, keepdim=True, unbiased=False)
    return (x - m) / torch.sqrt(v + eps)
def _scatter_add(tgt, idx, src, axis=0):
    return tgt.clone().index_add_(axis, idx, src)
def _segment_sum(src, seg, n):
    out = torch.zeros((n,) + src.shape[1:], dtype=src.dtype)
    return out.index_add_(0, seg, src)
def _pad(x, pw):
    flat = tuple(v for pair in reversed(pw) for v in pair)
    return torch.nn.functional.pad(x, flat)

kernel_name = 'sequential_preLN__sliding_local_dilated__swiglu_ffn__prompt'

def setup_inputs():

    _w = (lambda a: (lambda t: t.to(torch.bfloat16) if t.is_floating_point() else t)(torch.as_tensor(a)))
    def _A_setup():
        B, S, D = 1, 2048, 640
        return {
            "x": _w((lambda *s: torch.randn(*s, dtype=torch.bfloat16) * 0.05)(B, S, D)),
            "wqkv": _w((lambda *s: torch.randn(*s, dtype=torch.bfloat16) * 0.05)(D, 3 * D)),
            "wo": _w((lambda *s: torch.randn(*s, dtype=torch.bfloat16) * 0.05)(D, D)),
        }
    _A_in = _A_setup()

    def _B_setup():
        B, S, D, F = 1, 2048, 640, 1728
        return {
            "x": _w((lambda *s: torch.randn(*s, dtype=torch.bfloat16) * 0.05)(B, S, D)),
            "w_gate": _w((lambda *s: torch.randn(*s, dtype=torch.bfloat16) * 0.05)(D, F)),
            "w_up": _w((lambda *s: torch.randn(*s, dtype=torch.bfloat16) * 0.05)(D, F)),
            "w_down": _w((lambda *s: torch.randn(*s, dtype=torch.bfloat16) * 0.05)(F, D)),
        }
    _B_in = _B_setup()

    return {
        "A_x": _A_in["x"],
        "A_wqkv": _A_in["wqkv"],
        "A_wo": _A_in["wo"],
        "B_x": _B_in["x"],
        "B_w_gate": _B_in["w_gate"],
        "B_w_up": _B_in["w_up"],
        "B_w_down": _B_in["w_down"],
    }

def reference(A_x, A_wqkv, A_wo, B_x, B_w_gate, B_w_up, B_w_down):
    def _A_ref(x, wqkv, wo):
        B, S, D = x.shape
        H = 32; Dh = D // H
        W, dil = 8, 2
        qkv = (lambda x, *d: x.permute(*d))((x @ wqkv).reshape(B, S, 3, H, Dh), 2, 0, 3, 1, 4)
        q, k, v = qkv[0], qkv[1], qkv[2]
        scale = Dh ** -0.5
        pos = torch.arange(S)
        off = torch.arange(W) * dil
        idx = pos[:, None] - off[None, :]
        mask = idx >= 0
        idx_c = torch.where(mask, idx, 0).reshape(-1)
        kg = k[:, :, idx_c, :].reshape(B, H, S, W, Dh)
        vg = v[:, :, idx_c, :].reshape(B, H, S, W, Dh)
        logits = torch.einsum("bhsd,bhswd->bhsw", q, kg) * scale
        logits = torch.where(mask[None, None, :, :], logits, -1e9)
        attn = _softmax(logits, axis=-1)
        o = torch.einsum("bhsw,bhswd->bhsd", attn, vg)
        return (lambda x, *d: x.permute(*d))(o, 0, 2, 1, 3).reshape(B, S, D) @ wo

    def _B_ref(x, w_gate, w_up, w_down):
        g = _silu(x @ w_gate)
        u = x @ w_up
        return (g * u) @ w_down

    x = A_x
    h = x + _A_ref(_layernorm(x, axis=-1), A_wqkv, A_wo)
    h2 = h + _B_ref(_layernorm(h, axis=-1), B_w_gate, B_w_up, B_w_down)
    return h2
```

```asm
; @launch grid=(256,1,1) block=(512,1,1) lds=163840
.amdgcn_target "amdgcn-amd-amdhsa--gfx950"
.text
.globl sequential_preLN__sliding_local_dilated__swiglu_ffn__prompt_kernel
.p2align 8
.type sequential_preLN__sliding_local_dilated__swiglu_ffn__prompt_kernel,@function
sequential_preLN__sliding_local_dilated__swiglu_ffn__prompt_kernel:
    s_cmp_ge_u32 s2, 256
    s_cbranch_scc1 LEND
    s_load_dwordx16 s[16:31], s[0:1], 0
    s_load_dwordx4 s[32:35], s[0:1], 64
    v_lshrrev_b32 v1, 6, v0
    v_and_b32 v0, 63, v0
    v_readfirstlane_b32 s40, v1
    s_nop 0
    s_cmp_eq_u32 s40, 7
    s_cbranch_scc1 SWAVE
    s_cmp_eq_u32 s40, 6
    s_cbranch_scc1 PWAVE
    s_cmp_ge_u32 s40, 4
    s_cbranch_scc1 LWAVE
    s_lshl_b32 s46, s40, 8
    s_add_u32 s46, s46, 144384
    v_lshl_add_u32 v250, v0, 2, s46
    v_mov_b32 v251, 0
    v_mov_b32 v254, 144384
    ds_write_b32 v250, v251
    ds_write_b32 v250, v251 offset:256
    s_setprio 3
    v_mov_b32 v4, 0x3f803f80
    v_mov_b32 v5, 0x3f803f80
    v_mov_b32 v6, 0x3f803f80
    v_mov_b32 v7, 0x3f803f80
    v_lshrrev_b32 v99, 2, v0
    s_lshl_b32 s49, s40, 4
    v_add_u32 v99, s49, v99
    v_mul_u32_u24 v99, 1088, v99
    v_and_b32 v100, 3, v0
    v_lshlrev_b32 v100, 4, v100
    s_mov_b32 s49, 31744
    v_add3_u32 v99, v99, v100, s49
    ds_write_b128 v99, v[4:7]
    s_cmp_ge_u32 s40, 2
    s_cbranch_scc1 O1_1
    v_add_u32 v99, 69632, v99
    ds_write_b128 v99, v[4:7]
O1_1:
    s_cmp_ge_u32 s40, 3
    s_cbranch_scc1 O2_2
    s_mul_i32 s49, s40, 10240
    v_lshlrev_b32 v100, 4, v0
    v_add_u32 v100, s49, v100
    s_mov_b64 exec, 0xff
    ds_write_b128 v100, v[4:7]
    s_mov_b64 exec, -1
O2_2:
    s_waitcnt lgkmcnt(0)
    s_mov_b32 s12, s34
    s_mov_b32 s13, s35
    s_mov_b32 s14, 0x1600000
    s_mov_b32 s15, 0x20000
    v_mov_b32 v99, 145664
    s_barrier
    ds_read_b32 v99, v99
    s_waitcnt lgkmcnt(0)
    v_readfirstlane_b32 s2, v99
    s_nop 0
    s_and_b32 s41, s2, 7
    s_lshl_b32 s41, s41, 1
    s_lshr_b32 s42, s2, 7
    s_add_u32 s41, s41, s42
    s_lshr_b32 s42, s2, 3
    s_and_b32 s42, s42, 15
    s_lshr_b32 s43, s42, 3
    s_lshl_b32 s44, s41, 1
    s_add_u32 s43, s43, s44
    s_and_b32 s44, s42, 7
    s_mul_i32 s3, s43, 2
    s_mul_i32 s91, s44, 1
    s_add_u32 s3, s3, s91
    s_mul_i32 s91, s3, 147
    s_lshr_b32 s91, s91, 10
    s_mul_i32 s91, s91, 7
    s_sub_u32 s3, s3, s91
    v_lshrrev_b32 v102, 4, v0
    v_lshrrev_b32 v99, 5, v0
    v_lshlrev_b32 v99, 3, v99
    v_bfe_u32 v100, v0, 2, 2
    v_add_u32 v99, v99, v100
    v_mul_u32_u24 v99, 1088, v99
    v_and_b32 v100, 3, v0
    v_lshl_add_u32 v99, v100, 3, v99
    v_bfe_u32 v100, v0, 4, 1
    s_lshl_b32 s49, s40, 7
    s_add_u32 s49, s49, 30720
    s_movk_i32 s50, 480
    v_mad_u32_u24 v92, v100, s50, v99
    v_add_u32 v92, s49, v92
    s_cmp_eq_u32 s40, 3
    s_cselect_b32 s50, 32, s50
    s_cselect_b32 s49, 31648, s49
    v_mad_u32_u24 v93, v100, s50, v99
    v_add_u32 v93, s49, v93
    v_and_b32 v104, 15, v0
    v_lshrrev_b32 v99, 1, v104
    v_xor_b32 v100, v99, v102
    v_lshlrev_b32 v100, 4, v100
    v_lshl_add_u32 v94, v104, 7, v100
    v_xor_b32 v95, 64, v94
    s_lshl_b32 s49, s40, 11
    s_add_u32 s49, s49, 2048
    v_add_u32 v96, s49, v94
    v_add_u32 v97, s49, v95
    v_and_b32 v100, 1, v0
    v_mul_u32_u24 v100, 40, v100
    v_add_u32 v99, v99, v100
    v_mul_u32_u24 v105, 488, v99
    v_lshlrev_b32 v106, 3, v102
    s_lshl_b32 s49, s40, 7
    s_add_u32 s49, s49, 102400
    v_add3_u32 v98, v105, v106, s49
    s_mov_b32 s46, 0
    s_mov_b32 s48, 0
    v_and_b32 v99, 7, v0
    v_bfe_u32 v100, v0, 3, 1
    v_lshl_add_u32 v101, v99, 1, v100
    v_lshrrev_b32 v100, 5, v0
    v_xor_b32 v99, v99, v100
    v_bfe_u32 v100, v0, 4, 1
    v_lshlrev_b32 v100, 3, v100
    v_lshl_add_u32 v100, v101, 7, v100
    s_lshl_b32 s49, s40, 11
    s_add_u32 s49, s49, 2048
    v_add_u32 v100, s49, v100
    s_mul_i32 s49, s44, 5
    s_add_u32 s50, s49, 0
    s_lshr_b32 s58, s50, 2
    s_sub_u32 s51, s58, s3
    s_cmp_lt_i32 s51, 3
    s_cselect_b32 s52, 7, 0
    s_add_u32 s51, s51, s52
    s_cmp_ge_u32 s58, 3
    s_cselect_b32 s58, s51, s58
    s_and_b32 s50, s50, 3
    s_lshl_b32 s50, s50, 1
    v_xor_b32 v101, s50, v99
    v_lshl_add_u32 v107, v101, 4, v100
    s_add_u32 s50, s49, 1
    s_lshr_b32 s59, s50, 2
    s_sub_u32 s51, s59, s3
    s_cmp_lt_i32 s51, 3
    s_cselect_b32 s52, 7, 0
    s_add_u32 s51, s51, s52
    s_cmp_ge_u32 s59, 3
    s_cselect_b32 s59, s51, s59
    s_and_b32 s50, s50, 3
    s_lshl_b32 s50, s50, 1
    v_xor_b32 v101, s50, v99
    v_lshl_add_u32 v108, v101, 4, v100
    s_add_u32 s50, s49, 2
    s_lshr_b32 s60, s50, 2
    s_sub_u32 s51, s60, s3
    s_cmp_lt_i32 s51, 3
    s_cselect_b32 s52, 7, 0
    s_add_u32 s51, s51, s52
    s_cmp_ge_u32 s60, 3
    s_cselect_b32 s60, s51, s60
    s_and_b32 s50, s50, 3
    s_lshl_b32 s50, s50, 1
    v_xor_b32 v101, s50, v99
    v_lshl_add_u32 v109, v101, 4, v100
    s_add_u32 s50, s49, 3
    s_lshr_b32 s61, s50, 2
    s_sub_u32 s51, s61, s3
    s_cmp_lt_i32 s51, 3
    s_cselect_b32 s52, 7, 0
    s_add_u32 s51, s51, s52
    s_cmp_ge_u32 s61, 3
    s_cselect_b32 s61, s51, s61
    s_and_b32 s50, s50, 3
    s_lshl_b32 s50, s50, 1
    v_xor_b32 v101, s50, v99
    v_lshl_add_u32 v110, v101, 4, v100
    s_add_u32 s50, s49, 4
    s_lshr_b32 s62, s50, 2
    s_sub_u32 s51, s62, s3
    s_cmp_lt_i32 s51, 3
    s_cselect_b32 s52, 7, 0
    s_add_u32 s51, s51, s52
    s_cmp_ge_u32 s62, 3
    s_cselect_b32 s62, s51, s62
    s_and_b32 s50, s50, 3
    s_lshl_b32 s50, s50, 1
    v_xor_b32 v101, s50, v99
    v_lshl_add_u32 v111, v101, 4, v100
    s_waitcnt lgkmcnt(0)
    v_mov_b32 v4, 0
    v_mov_b32 v5, 0
    v_mov_b32 v6, 0
    v_mov_b32 v7, 0
    v_mov_b32 v8, 0
    v_mov_b32 v9, 0
    v_mov_b32 v10, 0
    v_mov_b32 v11, 0
    v_mov_b32 v12, 0
    v_mov_b32 v13, 0
    v_mov_b32 v14, 0
    v_mov_b32 v15, 0
    v_mov_b32 v16, 0
    v_mov_b32 v17, 0
    v_mov_b32 v18, 0
    v_mov_b32 v19, 0
    v_mov_b32 v20, 0
    v_mov_b32 v21, 0
    v_mov_b32 v22, 0
    v_mov_b32 v23, 0
    v_mov_b32 v24, 0
    v_mov_b32 v25, 0
    v_mov_b32 v26, 0
    v_mov_b32 v27, 0
    v_mov_b32 v28, 0
    v_mov_b32 v29, 0
    v_mov_b32 v30, 0
    v_mov_b32 v31, 0
    v_mov_b32 v32, 0
    v_mov_b32 v33, 0
    v_mov_b32 v34, 0
    v_mov_b32 v35, 0
    v_mov_b32 v36, 0
    v_mov_b32 v37, 0
    v_mov_b32 v38, 0
    v_mov_b32 v39, 0
    v_mov_b32 v40, 0
    v_mov_b32 v41, 0
    v_mov_b32 v42, 0
    v_mov_b32 v43, 0
    v_mov_b32 v44, 0
    v_mov_b32 v45, 0
    v_mov_b32 v46, 0
    v_mov_b32 v47, 0
    v_mov_b32 v48, 0
    v_mov_b32 v49, 0
    v_mov_b32 v50, 0
    v_mov_b32 v51, 0
    v_mov_b32 v52, 0
    v_mov_b32 v53, 0
    v_mov_b32 v54, 0
    v_mov_b32 v55, 0
    v_mov_b32 v56, 0
    v_mov_b32 v57, 0
    v_mov_b32 v58, 0
    v_mov_b32 v59, 0
    v_mov_b32 v60, 0
    v_mov_b32 v61, 0
    v_mov_b32 v62, 0
    v_mov_b32 v63, 0
    v_mov_b32 v64, 0
    v_mov_b32 v65, 0
    v_mov_b32 v66, 0
    v_mov_b32 v67, 0
    v_mov_b32 v68, 0
    v_mov_b32 v69, 0
    v_mov_b32 v70, 0
    v_mov_b32 v71, 0
    v_mov_b32 v72, 0
    v_mov_b32 v73, 0
    v_mov_b32 v74, 0
    v_mov_b32 v75, 0
    v_mov_b32 v76, 0
    v_mov_b32 v77, 0
    v_mov_b32 v78, 0
    v_mov_b32 v79, 0
    v_mov_b32 v80, 0
    v_mov_b32 v81, 0
    v_mov_b32 v82, 0
    v_mov_b32 v83, 0
    v_mov_b32 v84, 0
    v_mov_b32 v88, 0
    v_mov_b32 v85, 0
    v_mov_b32 v89, 0
    v_mov_b32 v86, 0
    v_mov_b32 v90, 0
    v_mov_b32 v87, 0
    v_mov_b32 v91, 0
    v_and_b32 v100, 31, v0
    v_lshrrev_b32 v101, 5, v0
    v_mul_u32_u24 v234, 40, v101
    s_and_b32 s50, s40, 1
    s_mul_i32 s49, s50, 19520
    s_lshr_b32 s51, s40, 1
    s_mul_i32 s52, s51, 80
    s_add_u32 s49, s49, s52
    s_add_u32 s49, s49, 102400
    v_add_u32 v234, s49, v234
    s_movk_i32 s52, 488
    v_mad_u32_u24 v233, v100, s52, v234
    v_and_b32 v235, 16, v0
    v_and_b32 v99, 3, v0
    v_lshl_add_u32 v235, v99, 2, v235
    v_bfe_u32 v99, v0, 2, 2
    v_add_u32 v235, v235, v99
    v_mad_u32_u24 v234, v235, s52, v234
    v_lshrrev_b32 v235, 3, v100
    v_mul_u32_u24 v235, 20480, v235
    v_and_b32 v99, 7, v0
    v_lshl_add_u32 v235, v99, 4, v235
    v_lshl_add_u32 v236, v101, 9, v235
    s_and_b32 s49, s44, 1
    s_lshl_b32 s49, s49, 1
    s_add_u32 s51, s51, s49
    s_lshr_b32 s49, s44, 1
    s_mul_i32 s49, s49, 5120
    s_mul_i32 s52, s43, 81920
    s_add_u32 s49, s49, s52
    s_lshl_b32 s50, s50, 7
    s_add_u32 s49, s49, s50
    s_lshl_b32 s88, s51, 10
    s_add_u32 s88, s88, s49
    s_lshl_b32 s89, s51, 8
    s_add_u32 s89, s89, s49
    s_add_u32 s89, s89, 4096
    v_and_b32 v101, 3, v0
    s_lshl_b32 s50, s43, 5
    v_sub_u32 v100, v100, v101
    v_add_u32 v100, s50, v100
    s_mov_b32 s90, 0x3ea52b5c
    v_mov_b32 v237, 0xcf8547b1
    v_add_u32 v99, 0, v101
    v_cmp_gt_u32 s[64:65], 8, v99
    v_add_u32 v99, -1, v101
    v_cmp_gt_u32 s[66:67], 8, v99
    v_add_u32 v99, -2, v101
    v_cmp_gt_u32 s[68:69], 8, v99
    v_add_u32 v99, -3, v101
    v_cmp_gt_u32 s[70:71], 8, v99
    v_add_u32 v99, 4, v101
    v_cmp_gt_u32 s[72:73], 8, v99
    v_cmp_le_i32 vcc, 4, v100
    s_nop 0
    s_and_b64 s[72:73], s[72:73], vcc
    v_add_u32 v99, 3, v101
    v_cmp_gt_u32 s[74:75], 8, v99
    v_cmp_le_i32 vcc, 3, v100
    s_nop 0
    s_and_b64 s[74:75], s[74:75], vcc
    v_add_u32 v99, 2, v101
    v_cmp_gt_u32 s[76:77], 8, v99
    v_cmp_le_i32 vcc, 2, v100
    s_nop 0
    s_and_b64 s[76:77], s[76:77], vcc
    v_add_u32 v99, 1, v101
    v_cmp_gt_u32 s[78:79], 8, v99
    v_cmp_le_i32 vcc, 1, v100
    s_nop 0
    s_and_b64 s[78:79], s[78:79], vcc
    v_add_u32 v99, 8, v101
    v_cmp_gt_u32 s[80:81], 8, v99
    v_cmp_le_i32 vcc, 8, v100
    s_nop 0
    s_and_b64 s[80:81], s[80:81], vcc
    v_add_u32 v99, 7, v101
    v_cmp_gt_u32 s[82:83], 8, v99
    v_cmp_le_i32 vcc, 7, v100
    s_nop 0
    s_and_b64 s[82:83], s[82:83], vcc
    v_add_u32 v99, 6, v101
    v_cmp_gt_u32 s[84:85], 8, v99
    v_cmp_le_i32 vcc, 6, v100
    s_nop 0
    s_and_b64 s[84:85], s[84:85], vcc
    v_add_u32 v99, 5, v101
    v_cmp_gt_u32 s[86:87], 8, v99
    v_cmp_le_i32 vcc, 5, v100
    s_nop 0
    s_and_b64 s[86:87], s[86:87], vcc
    v_and_b32 v238, 3, v0
    v_lshlrev_b32 v238, 8, v238
    v_add_u32 v238, 144384, v238
    s_lshl_b32 s49, s41, 8
    s_lshl_b32 s50, s42, 4
    s_add_u32 s49, s49, s50
    s_lshl_b32 s50, s40, 2
    s_add_u32 s49, s49, s50
    s_add_u32 s45, s49, 0x1583000
    s_mov_b32 s54, 2
    s_mov_b32 s55, 0
    s_bitset1_b32 s55, s58
    s_bitset1_b32 s55, s62
    s_mov_b32 s91, 0
SP_4:
    ds_read_b64 v[252:253], v254 offset:1024
    s_add_u32 s91, s91, 1
    s_waitcnt lgkmcnt(0)
    v_min_u32 v252, v252, v253
    s_nop 0
    v_readfirstlane_b32 s92, v252
    s_cmp_ge_u32 s91, 400000
    s_cbranch_scc1 OK_3
    s_cmp_lt_u32 s92, 1
    s_cbranch_scc1 SP_4
OK_3:
    ds_read_b64_tr_b16 v[160:161], v92 offset:0
    ds_read_b64_tr_b16 v[162:163], v92 offset:4352
    ds_read_b128 v[112:115], v94 offset:0
    ds_read_b128 v[116:119], v94 offset:2048
    ds_read_b128 v[120:123], v94 offset:4096
    ds_read_b128 v[124:127], v94 offset:6144
    ds_read_b128 v[128:131], v94 offset:8192
    ds_read_b64_tr_b16 v[164:165], v92 offset:32
    ds_read_b64_tr_b16 v[166:167], v92 offset:4384
    ds_read_b128 v[132:135], v96
    ds_read_b64_tr_b16 v[168:169], v92 offset:64
    ds_read_b64_tr_b16 v[170:171], v92 offset:4416
    ds_read_b64_tr_b16 v[172:173], v93 offset:96
    ds_read_b64_tr_b16 v[174:175], v93 offset:4448
    v_add_u32 v251, 1, v251
    ds_write_b32 v250, v251
    ds_read_b64 v[252:253], v254 offset:1024
P1LOOP:
    s_waitcnt lgkmcnt(0)
    v_min_u32 v252, v252, v253
    s_nop 0
    v_readfirstlane_b32 s92, v252
    s_nop 0
    s_cmp_lt_u32 s92, s54
    s_cbranch_scc1 SP_6s
OK_5:
    v_mfma_f32_16x16x32_bf16 v[4:7], v[160:163], v[112:115], v[4:7]
    ds_read_b64_tr_b16 v[176:177], v92 offset:17408
    v_mfma_f32_16x16x32_bf16 v[8:11], v[160:163], v[116:119], v[8:11]
    ds_read_b64_tr_b16 v[178:179], v92 offset:21760
    s_add_u32 s54, s54, 1
    s_min_u32 s54, s54, 20
    v_mfma_f32_16x16x32_bf16 v[12:15], v[160:163], v[120:123], v[12:15]
    ds_read_b128 v[136:139], v95 offset:0
    s_bitcmp1_b32 s55, s48
    s_cbranch_scc1 XCAP
XCAPR:
    v_mfma_f32_16x16x32_bf16 v[16:19], v[160:163], v[124:127], v[16:19]
    ds_read_b128 v[140:143], v95 offset:2048
    s_mov_b32 s47, 34816
    s_movk_i32 s53, 10240
    s_cmp_eq_u32 s46, 20480
    v_mfma_f32_16x16x32_bf16 v[20:23], v[160:163], v[128:131], v[20:23]
    ds_read_b128 v[144:147], v95 offset:4096
    s_cselect_b32 s47, 0xfffef000, s47
    s_cselect_b32 s53, 0xffffb000, s53
    s_add_u32 s48, s48, 1
    v_mfma_f32_16x16x32_bf16 v[84:87], v[112:115], v[112:115], v[84:87]
    ds_read_b128 v[148:151], v95 offset:6144
    s_add_u32 s46, s46, s53
    v_mfma_f32_16x16x32_bf16 v[24:27], v[164:167], v[112:115], v[24:27]
    ds_read_b128 v[152:155], v95 offset:8192
    v_mfma_f32_16x16x32_bf16 v[28:31], v[164:167], v[116:119], v[28:31]
    ds_read_b64_tr_b16 v[180:181], v92 offset:17440
    v_mfma_f32_16x16x32_bf16 v[32:35], v[164:167], v[120:123], v[32:35]
    ds_read_b64_tr_b16 v[182:183], v92 offset:21792
    v_mfma_f32_16x16x32_bf16 v[36:39], v[164:167], v[124:127], v[36:39]
    ds_read_b128 v[156:159], v97
    v_mfma_f32_16x16x32_bf16 v[40:43], v[164:167], v[128:131], v[40:43]
    ds_read_b64_tr_b16 v[184:185], v92 offset:17472
    v_mfma_f32_16x16x32_bf16 v[88:91], v[132:135], v[132:135], v[88:91]
    ds_read_b64_tr_b16 v[186:187], v92 offset:21824
    v_mfma_f32_16x16x32_bf16 v[44:47], v[168:171], v[112:115], v[44:47]
    ds_read_b64_tr_b16 v[188:189], v93 offset:17504
    v_mfma_f32_16x16x32_bf16 v[48:51], v[168:171], v[116:119], v[48:51]
    ds_read_b64_tr_b16 v[190:191], v93 offset:21856
    v_mfma_f32_16x16x32_bf16 v[52:55], v[168:171], v[120:123], v[52:55]
    v_add_u32 v251, 1, v251
    ds_write_b32 v250, v251
    v_mfma_f32_16x16x32_bf16 v[56:59], v[168:171], v[124:127], v[56:59]
    ds_read_b64 v[252:253], v254 offset:1024
    v_mfma_f32_16x16x32_bf16 v[60:63], v[168:171], v[128:131], v[60:63]
    v_add_u32 v92, s47, v92
    v_mfma_f32_16x16x32_bf16 v[64:67], v[172:175], v[112:115], v[64:67]
    v_add_u32 v93, s47, v93
    v_mfma_f32_16x16x32_bf16 v[68:71], v[172:175], v[116:119], v[68:71]
    v_add_u32 v94, s53, v94
    v_mfma_f32_16x16x32_bf16 v[72:75], v[172:175], v[120:123], v[72:75]
    v_add_u32 v95, s53, v95
    v_mfma_f32_16x16x32_bf16 v[76:79], v[172:175], v[124:127], v[76:79]
    v_add_u32 v96, s53, v96
    v_mfma_f32_16x16x32_bf16 v[80:83], v[172:175], v[128:131], v[80:83]
    v_add_u32 v97, s53, v97
    s_cmp_eq_u32 s48, 10
    s_cbranch_scc1 P1LAST
    s_waitcnt lgkmcnt(0)
    v_min_u32 v252, v252, v253
    s_nop 0
    v_readfirstlane_b32 s92, v252
    s_nop 0
    s_cmp_lt_u32 s92, s54
    s_cbranch_scc1 SP_8s
OK_7:
    v_mfma_f32_16x16x32_bf16 v[4:7], v[176:179], v[136:139], v[4:7]
    ds_read_b64_tr_b16 v[160:161], v92 offset:0
    v_mfma_f32_16x16x32_bf16 v[8:11], v[176:179], v[140:143], v[8:11]
    ds_read_b64_tr_b16 v[162:163], v92 offset:4352
    s_add_u32 s54, s54, 1
    s_min_u32 s54, s54, 20
    v_mfma_f32_16x16x32_bf16 v[12:15], v[176:179], v[144:147], v[12:15]
    ds_read_b128 v[112:115], v94 offset:0
    v_mfma_f32_16x16x32_bf16 v[16:19], v[176:179], v[148:151], v[16:19]
    ds_read_b128 v[116:119], v94 offset:2048
    v_mfma_f32_16x16x32_bf16 v[20:23], v[176:179], v[152:155], v[20:23]
    ds_read_b128 v[120:123], v94 offset:4096
    v_mfma_f32_16x16x32_bf16 v[84:87], v[136:139], v[136:139], v[84:87]
    ds_read_b128 v[124:127], v94 offset:6144
    v_mfma_f32_16x16x32_bf16 v[24:27], v[180:183], v[136:139], v[24:27]
    ds_read_b128 v[128:131], v94 offset:8192
    v_mfma_f32_16x16x32_bf16 v[28:31], v[180:183], v[140:143], v[28:31]
    ds_read_b64_tr_b16 v[164:165], v92 offset:32
    v_mfma_f32_16x16x32_bf16 v[32:35], v[180:183], v[144:147], v[32:35]
    ds_read_b64_tr_b16 v[166:167], v92 offset:4384
    v_mfma_f32_16x16x32_bf16 v[36:39], v[180:183], v[148:151], v[36:39]
    ds_read_b128 v[132:135], v96
    v_mfma_f32_16x16x32_bf16 v[40:43], v[180:183], v[152:155], v[40:43]
    ds_read_b64_tr_b16 v[168:169], v92 offset:64
    v_mfma_f32_16x16x32_bf16 v[88:91], v[156:159], v[156:159], v[88:91]
    ds_read_b64_tr_b16 v[170:171], v92 offset:4416
    v_mfma_f32_16x16x32_bf16 v[44:47], v[184:187], v[136:139], v[44:47]
    ds_read_b64_tr_b16 v[172:173], v93 offset:96
    v_mfma_f32_16x16x32_bf16 v[48:51], v[184:187], v[140:143], v[48:51]
    ds_read_b64_tr_b16 v[174:175], v93 offset:4448
    v_mfma_f32_16x16x32_bf16 v[52:55], v[184:187], v[144:147], v[52:55]
    v_add_u32 v251, 1, v251
    ds_write_b32 v250, v251
    v_mfma_f32_16x16x32_bf16 v[56:59], v[184:187], v[148:151], v[56:59]
    ds_read_b64 v[252:253], v254 offset:1024
    v_mfma_f32_16x16x32_bf16 v[60:63], v[184:187], v[152:155], v[60:63]
    v_mfma_f32_16x16x32_bf16 v[64:67], v[188:191], v[136:139], v[64:67]
    v_mfma_f32_16x16x32_bf16 v[68:71], v[188:191], v[140:143], v[68:71]
    v_mfma_f32_16x16x32_bf16 v[72:75], v[188:191], v[144:147], v[72:75]
    v_mfma_f32_16x16x32_bf16 v[76:79], v[188:191], v[148:151], v[76:79]
    v_mfma_f32_16x16x32_bf16 v[80:83], v[188:191], v[152:155], v[80:83]
    s_branch P1LOOP
P1LAST:
    s_waitcnt lgkmcnt(0)
    v_mfma_f32_16x16x32_bf16 v[84:87], v[136:139], v[136:139], v[84:87]
    v_and_b32 v99, 3, v0
    v_mfma_f32_16x16x32_bf16 v[88:91], v[156:159], v[156:159], v[88:91]
    v_lshlrev_b32 v100, 3, v104
    v_mfma_f32_16x16x32_bf16 v[64:67], v[188:191], v[136:139], v[64:67]
    v_add_u32 v100, 142336, v100
    s_lshl_b32 s49, s40, 7
    v_mfma_f32_16x16x32_bf16 v[68:71], v[188:191], v[140:143], v[68:71]
    v_add_u32 v101, s49, v100
    v_mfma_f32_16x16x32_bf16 v[72:75], v[188:191], v[144:147], v[72:75]
    v_cmp_eq_u32 vcc, 1, v99
    v_mfma_f32_16x16x32_bf16 v[76:79], v[188:191], v[148:151], v[76:79]
    v_cmp_eq_u32 s[56:57], 2, v99
    v_mfma_f32_16x16x32_bf16 v[80:83], v[188:191], v[152:155], v[80:83]
    s_mov_b32 s49, 0xbacccccd
    s_mov_b32 s50, 0x3acccccd
    s_mov_b32 s51, 0x3727c5ac
    v_mfma_f32_16x16x32_bf16 v[4:7], v[176:179], v[136:139], v[4:7]
    v_cndmask_b32 v84, v84, v85, vcc
    v_cndmask_b32 v88, v88, v89, vcc
    v_mfma_f32_16x16x32_bf16 v[24:27], v[180:183], v[136:139], v[24:27]
    v_cmp_eq_u32 vcc, 3, v99
    v_cndmask_b32 v84, v84, v86, s[56:57]
    v_mfma_f32_16x16x32_bf16 v[44:47], v[184:187], v[136:139], v[44:47]
    v_cndmask_b32 v88, v88, v90, s[56:57]
    v_cndmask_b32 v84, v84, v87, vcc
    v_mfma_f32_16x16x32_bf16 v[8:11], v[176:179], v[140:143], v[8:11]
    v_cndmask_b32 v88, v88, v91, vcc
    s_mov_b32 exec_lo, 0x00f0000f
    s_mov_b32 exec_hi, 0xf0000f00
    ds_write_b32 v100, v84 offset:4
    ds_write_b32 v101, v88 offset:132
    s_mov_b64 exec, -1
    v_mfma_f32_16x16x32_bf16 v[12:15], v[176:179], v[144:147], v[12:15]
    s_cmp_lg_u32 s40, 3
    s_cbranch_scc1 E1_9
    ds_write_b32 v100, v64 offset:0
    ds_write_b32 v100, v68 offset:128
    ds_write_b32 v100, v72 offset:256
    ds_write_b32 v100, v76 offset:384
    ds_write_b32 v100, v80 offset:512
E1_9:
    v_add_u32 v251, 2, v251
    ds_write_b32 v250, v251
    v_mfma_f32_16x16x32_bf16 v[16:19], v[176:179], v[148:151], v[16:19]
    v_mov_b32_dpp v172, v64 row_newbcast:0 row_mask:0xf bank_mask:0xf
    v_mov_b32_dpp v173, v65 row_newbcast:0 row_mask:0xf bank_mask:0xf
    v_mfma_f32_16x16x32_bf16 v[20:23], v[176:179], v[152:155], v[20:23]
    v_mov_b32_dpp v174, v66 row_newbcast:0 row_mask:0xf bank_mask:0xf
    v_mov_b32_dpp v175, v67 row_newbcast:0 row_mask:0xf bank_mask:0xf
    v_mfma_f32_16x16x32_bf16 v[28:31], v[180:183], v[140:143], v[28:31]
    v_mov_b32_dpp v160, v4 row_newbcast:0 row_mask:0xf bank_mask:0xf
    v_mov_b32_dpp v161, v5 row_newbcast:0 row_mask:0xf bank_mask:0xf
    v_mfma_f32_16x16x32_bf16 v[32:35], v[180:183], v[144:147], v[32:35]
    v_mov_b32_dpp v162, v6 row_newbcast:0 row_mask:0xf bank_mask:0xf
    v_mov_b32_dpp v163, v7 row_newbcast:0 row_mask:0xf bank_mask:0xf
    v_mfma_f32_16x16x32_bf16 v[36:39], v[180:183], v[148:151], v[36:39]
    v_mov_b32_dpp v164, v24 row_newbcast:0 row_mask:0xf bank_mask:0xf
    v_mov_b32_dpp v165, v25 row_newbcast:0 row_mask:0xf bank_mask:0xf
    v_mfma_f32_16x16x32_bf16 v[40:43], v[180:183], v[152:155], v[40:43]
    v_mov_b32_dpp v166, v26 row_newbcast:0 row_mask:0xf bank_mask:0xf
    v_mov_b32_dpp v167, v27 row_newbcast:0 row_mask:0xf bank_mask:0xf
    ds_read_b32 v134, v238
    v_mfma_f32_16x16x32_bf16 v[48:51], v[184:187], v[140:143], v[48:51]
    v_mov_b32_dpp v168, v44 row_newbcast:0 row_mask:0xf bank_mask:0xf
    v_mov_b32_dpp v169, v45 row_newbcast:0 row_mask:0xf bank_mask:0xf
    v_mfma_f32_16x16x32_bf16 v[52:55], v[184:187], v[144:147], v[52:55]
    v_mov_b32_dpp v170, v46 row_newbcast:0 row_mask:0xf bank_mask:0xf
    v_mov_b32_dpp v171, v47 row_newbcast:0 row_mask:0xf bank_mask:0xf
    v_mfma_f32_16x16x32_bf16 v[56:59], v[184:187], v[148:151], v[56:59]
    v_mfma_f32_16x16x32_bf16 v[60:63], v[184:187], v[152:155], v[60:63]
    s_waitcnt lgkmcnt(0)
    v_cmp_le_u32 vcc, 22, v134
    s_nop 0
    s_cmp_lg_u64 vcc, -1
    s_cbranch_scc1 SP_11s
OK_10:
    ds_read_b64 v[112:113], v100 offset:0
    ds_read_b64 v[114:115], v100 offset:128
    ds_read_b64 v[116:117], v100 offset:256
    ds_read_b64 v[118:119], v100 offset:384
    ds_read_b64 v[120:121], v100 offset:512
    s_waitcnt lgkmcnt(4)
    v_mul_f32 v112, s49, v112
    v_mul_f32 v113, s50, v113
    v_fma_f32 v113, -v112, v112, v113
    v_max_f32 v113, 0, v113
    v_add_f32 v113, s51, v113
    v_rsq_f32 v113, v113
    s_waitcnt lgkmcnt(3)
    v_mul_f32 v114, s49, v114
    v_mul_f32 v115, s50, v115
    v_fma_f32 v115, -v114, v114, v115
    v_max_f32 v115, 0, v115
    v_add_f32 v115, s51, v115
    v_rsq_f32 v115, v115
    s_waitcnt lgkmcnt(2)
    v_mul_f32 v116, s49, v116
    v_mul_f32 v117, s50, v117
    v_fma_f32 v117, -v116, v116, v117
    v_max_f32 v117, 0, v117
    v_add_f32 v117, s51, v117
    v_rsq_f32 v117, v117
    s_waitcnt lgkmcnt(1)
    v_mul_f32 v118, s49, v118
    v_mul_f32 v119, s50, v119
    v_fma_f32 v119, -v118, v118, v119
    v_max_f32 v119, 0, v119
    v_add_f32 v119, s51, v119
    v_rsq_f32 v119, v119
    s_waitcnt lgkmcnt(0)
    v_mul_f32 v120, s49, v120
    v_mul_f32 v121, s50, v121
    v_fma_f32 v121, -v120, v120, v121
    v_max_f32 v121, 0, v121
    v_add_f32 v121, s51, v121
    v_rsq_f32 v121, v121
    v_pk_fma_f32 v[4:5], v[160:161], v[112:113], v[4:5] op_sel_hi:[1,0,1]
    v_pk_fma_f32 v[6:7], v[162:163], v[112:113], v[6:7] op_sel_hi:[1,0,1]
    v_pk_fma_f32 v[24:25], v[164:165], v[112:113], v[24:25] op_sel_hi:[1,0,1]
    v_pk_fma_f32 v[26:27], v[166:167], v[112:113], v[26:27] op_sel_hi:[1,0,1]
    v_pk_fma_f32 v[44:45], v[168:169], v[112:113], v[44:45] op_sel_hi:[1,0,1]
    v_pk_fma_f32 v[46:47], v[170:171], v[112:113], v[46:47] op_sel_hi:[1,0,1]
    v_pk_mul_f32 v[4:5], v[4:5], v[112:113] op_sel:[0,1]
    v_pk_mul_f32 v[6:7], v[6:7], v[112:113] op_sel:[0,1]
    v_pk_mul_f32 v[24:25], v[24:25], v[112:113] op_sel:[0,1]
    v_pk_mul_f32 v[26:27], v[26:27], v[112:113] op_sel:[0,1]
    v_pk_mul_f32 v[44:45], v[44:45], v[112:113] op_sel:[0,1]
    v_pk_mul_f32 v[46:47], v[46:47], v[112:113] op_sel:[0,1]
    v_cvt_pk_bf16_f32 v122, v4, v5
    v_cvt_pk_bf16_f32 v123, v6, v7
    v_cvt_pk_bf16_f32 v124, v24, v25
    v_cvt_pk_bf16_f32 v125, v26, v27
    v_cvt_pk_bf16_f32 v126, v44, v45
    v_cvt_pk_bf16_f32 v127, v46, v47
    ds_write_b64 v98, v[122:123] offset:0
    ds_write_b64 v98, v[124:125] offset:32
    ds_write_b64 v98, v[126:127] offset:64
    v_pk_fma_f32 v[8:9], v[160:161], v[114:115], v[8:9] op_sel_hi:[1,0,1]
    v_pk_fma_f32 v[10:11], v[162:163], v[114:115], v[10:11] op_sel_hi:[1,0,1]
    v_pk_fma_f32 v[28:29], v[164:165], v[114:115], v[28:29] op_sel_hi:[1,0,1]
    v_pk_fma_f32 v[30:31], v[166:167], v[114:115], v[30:31] op_sel_hi:[1,0,1]
    v_pk_fma_f32 v[48:49], v[168:169], v[114:115], v[48:49] op_sel_hi:[1,0,1]
    v_pk_fma_f32 v[50:51], v[170:171], v[114:115], v[50:51] op_sel_hi:[1,0,1]
    v_pk_mul_f32 v[8:9], v[8:9], v[114:115] op_sel:[0,1]
    v_pk_mul_f32 v[10:11], v[10:11], v[114:115] op_sel:[0,1]
    v_pk_mul_f32 v[28:29], v[28:29], v[114:115] op_sel:[0,1]
    v_pk_mul_f32 v[30:31], v[30:31], v[114:115] op_sel:[0,1]
    v_pk_mul_f32 v[48:49], v[48:49], v[114:115] op_sel:[0,1]
    v_pk_mul_f32 v[50:51], v[50:51], v[114:115] op_sel:[0,1]
    v_cvt_pk_bf16_f32 v128, v8, v9
    v_cvt_pk_bf16_f32 v129, v10, v11
    v_cvt_pk_bf16_f32 v130, v28, v29
    v_cvt_pk_bf16_f32 v131, v30, v31
    v_cvt_pk_bf16_f32 v132, v48, v49
    v_cvt_pk_bf16_f32 v133, v50, v51
    ds_write_b64 v98, v[128:129] offset:3904
    ds_write_b64 v98, v[130:131] offset:3936
    ds_write_b64 v98, v[132:133] offset:3968
    v_pk_fma_f32 v[12:13], v[160:161], v[116:117], v[12:13] op_sel_hi:[1,0,1]
    v_pk_fma_f32 v[14:15], v[162:163], v[116:117], v[14:15] op_sel_hi:[1,0,1]
    v_pk_fma_f32 v[32:33], v[164:165], v[116:117], v[32:33] op_sel_hi:[1,0,1]
    v_pk_fma_f32 v[34:35], v[166:167], v[116:117], v[34:35] op_sel_hi:[1,0,1]
    v_pk_fma_f32 v[52:53], v[168:169], v[116:117], v[52:53] op_sel_hi:[1,0,1]
    v_pk_fma_f32 v[54:55], v[170:171], v[116:117], v[54:55] op_sel_hi:[1,0,1]
    v_pk_mul_f32 v[12:13], v[12:13], v[116:117] op_sel:[0,1]
    v_pk_mul_f32 v[14:15], v[14:15], v[116:117] op_sel:[0,1]
    v_pk_mul_f32 v[32:33], v[32:33], v[116:117] op_sel:[0,1]
    v_pk_mul_f32 v[34:35], v[34:35], v[116:117] op_sel:[0,1]
    v_pk_mul_f32 v[52:53], v[52:53], v[116:117] op_sel:[0,1]
    v_pk_mul_f32 v[54:55], v[54:55], v[116:117] op_sel:[0,1]
    v_cvt_pk_bf16_f32 v122, v12, v13
    v_cvt_pk_bf16_f32 v123, v14, v15
    v_cvt_pk_bf16_f32 v124, v32, v33
    v_cvt_pk_bf16_f32 v125, v34, v35
    v_cvt_pk_bf16_f32 v126, v52, v53
    v_cvt_pk_bf16_f32 v127, v54, v55
    ds_write_b64 v98, v[122:123] offset:7808
    ds_write_b64 v98, v[124:125] offset:7840
    ds_write_b64 v98, v[126:127] offset:7872
    v_pk_fma_f32 v[16:17], v[160:161], v[118:119], v[16:17] op_sel_hi:[1,0,1]
    v_pk_fma_f32 v[18:19], v[162:163], v[118:119], v[18:19] op_sel_hi:[1,0,1]
    v_pk_fma_f32 v[36:37], v[164:165], v[118:119], v[36:37] op_sel_hi:[1,0,1]
    v_pk_fma_f32 v[38:39], v[166:167], v[118:119], v[38:39] op_sel_hi:[1,0,1]
    v_pk_fma_f32 v[56:57], v[168:169], v[118:119], v[56:57] op_sel_hi:[1,0,1]
    v_pk_fma_f32 v[58:59], v[170:171], v[118:119], v[58:59] op_sel_hi:[1,0,1]
    v_pk_mul_f32 v[16:17], v[16:17], v[118:119] op_sel:[0,1]
    v_pk_mul_f32 v[18:19], v[18:19], v[118:119] op_sel:[0,1]
    v_pk_mul_f32 v[36:37], v[36:37], v[118:119] op_sel:[0,1]
    v_pk_mul_f32 v[38:39], v[38:39], v[118:119] op_sel:[0,1]
    v_pk_mul_f32 v[56:57], v[56:57], v[118:119] op_sel:[0,1]
    v_pk_mul_f32 v[58:59], v[58:59], v[118:119] op_sel:[0,1]
    v_cvt_pk_bf16_f32 v128, v16, v17
    v_cvt_pk_bf16_f32 v129, v18, v19
    v_cvt_pk_bf16_f32 v130, v36, v37
    v_cvt_pk_bf16_f32 v131, v38, v39
    v_cvt_pk_bf16_f32 v132, v56, v57
    v_cvt_pk_bf16_f32 v133, v58, v59
    ds_write_b64 v98, v[128:129] offset:11712
    ds_write_b64 v98, v[130:131] offset:11744
    ds_write_b64 v98, v[132:133] offset:11776
    v_pk_fma_f32 v[20:21], v[160:161], v[120:121], v[20:21] op_sel_hi:[1,0,1]
    v_pk_fma_f32 v[22:23], v[162:163], v[120:121], v[22:23] op_sel_hi:[1,0,1]
    v_pk_fma_f32 v[40:41], v[164:165], v[120:121], v[40:41] op_sel_hi:[1,0,1]
    v_pk_fma_f32 v[42:43], v[166:167], v[120:121], v[42:43] op_sel_hi:[1,0,1]
    v_pk_fma_f32 v[60:61], v[168:169], v[120:121], v[60:61] op_sel_hi:[1,0,1]
    v_pk_fma_f32 v[62:63], v[170:171], v[120:121], v[62:63] op_sel_hi:[1,0,1]
    v_pk_mul_f32 v[20:21], v[20:21], v[120:121] op_sel:[0,1]
    v_pk_mul_f32 v[22:23], v[22:23], v[120:121] op_sel:[0,1]
    v_pk_mul_f32 v[40:41], v[40:41], v[120:121] op_sel:[0,1]
    v_pk_mul_f32 v[42:43], v[42:43], v[120:121] op_sel:[0,1]
    v_pk_mul_f32 v[60:61], v[60:61], v[120:121] op_sel:[0,1]
    v_pk_mul_f32 v[62:63], v[62:63], v[120:121] op_sel:[0,1]
    v_cvt_pk_bf16_f32 v122, v20, v21
    v_cvt_pk_bf16_f32 v123, v22, v23
    v_cvt_pk_bf16_f32 v124, v40, v41
    v_cvt_pk_bf16_f32 v125, v42, v43
    v_cvt_pk_bf16_f32 v126, v60, v61
    v_cvt_pk_bf16_f32 v127, v62, v63
    ds_write_b64 v98, v[122:123] offset:15616
    ds_write_b64 v98, v[124:125] offset:15648
    ds_write_b64 v98, v[126:127] offset:15680
    s_cmp_eq_u32 s40, 3
    s_cbranch_scc1 E2_12
    v_pk_fma_f32 v[64:65], v[172:173], v[112:113], v[64:65] op_sel_hi:[1,0,1]
    v_pk_fma_f32 v[66:67], v[174:175], v[112:113], v[66:67] op_sel_hi:[1,0,1]
    v_pk_fma_f32 v[68:69], v[172:173], v[114:115], v[68:69] op_sel_hi:[1,0,1]
    v_pk_fma_f32 v[70:71], v[174:175], v[114:115], v[70:71] op_sel_hi:[1,0,1]
    v_pk_fma_f32 v[72:73], v[172:173], v[116:117], v[72:73] op_sel_hi:[1,0,1]
    v_pk_fma_f32 v[74:75], v[174:175], v[116:117], v[74:75] op_sel_hi:[1,0,1]
    v_pk_mul_f32 v[64:65], v[64:65], v[112:113] op_sel:[0,1]
    v_pk_mul_f32 v[66:67], v[66:67], v[112:113] op_sel:[0,1]
    v_pk_mul_f32 v[68:69], v[68:69], v[114:115] op_sel:[0,1]
    v_pk_mul_f32 v[70:71], v[70:71], v[114:115] op_sel:[0,1]
    v_pk_mul_f32 v[72:73], v[72:73], v[116:117] op_sel:[0,1]
    v_pk_mul_f32 v[74:75], v[74:75], v[116:117] op_sel:[0,1]
    v_cvt_pk_bf16_f32 v122, v64, v65
    v_cvt_pk_bf16_f32 v123, v66, v67
    v_cvt_pk_bf16_f32 v124, v68, v69
    v_cvt_pk_bf16_f32 v125, v70, v71
    v_cvt_pk_bf16_f32 v126, v72, v73
    v_cvt_pk_bf16_f32 v127, v74, v75
    ds_write_b64 v98, v[122:123] offset:96
    ds_write_b64 v98, v[124:125] offset:4000
    ds_write_b64 v98, v[126:127] offset:7904
    v_pk_fma_f32 v[76:77], v[172:173], v[118:119], v[76:77] op_sel_hi:[1,0,1]
    v_pk_fma_f32 v[78:79], v[174:175], v[118:119], v[78:79] op_sel_hi:[1,0,1]
    v_pk_fma_f32 v[80:81], v[172:173], v[120:121], v[80:81] op_sel_hi:[1,0,1]
    v_pk_fma_f32 v[82:83], v[174:175], v[120:121], v[82:83] op_sel_hi:[1,0,1]
    v_pk_mul_f32 v[76:77], v[76:77], v[118:119] op_sel:[0,1]
    v_pk_mul_f32 v[78:79], v[78:79], v[118:119] op_sel:[0,1]
    v_pk_mul_f32 v[80:81], v[80:81], v[120:121] op_sel:[0,1]
    v_pk_mul_f32 v[82:83], v[82:83], v[120:121] op_sel:[0,1]
    v_cvt_pk_bf16_f32 v128, v76, v77
    v_cvt_pk_bf16_f32 v129, v78, v79
    v_cvt_pk_bf16_f32 v130, v80, v81
    v_cvt_pk_bf16_f32 v131, v82, v83
    ds_write_b64 v98, v[128:129] offset:11808
    ds_write_b64 v98, v[130:131] offset:15712
E2_12:
    v_add_u32 v251, 1, v251
    ds_write_b32 v250, v251
    s_mov_b32 s91, 0
SP_14:
    ds_read_b32 v112, v238
    s_add_u32 s91, s91, 1
    s_waitcnt lgkmcnt(0)
    v_cmp_le_u32 vcc, 23, v112
    s_cmp_ge_u32 s91, 400000
    s_cbranch_scc1 OK_13
    s_cmp_lg_u64 vcc, -1
    s_cbranch_scc1 SP_14
OK_13:
    ds_read_b64 v[2:3], v233 offset:3904
    ds_read_b64 v[12:13], v233 offset:4064
    ds_read_b64 v[22:23], v233 offset:2112
    ds_read_b64 v[32:33], v233 offset:160
    ds_read_b64 v[4:5], v233 offset:3912
    ds_read_b64 v[14:15], v233 offset:4072
    ds_read_b64 v[24:25], v233 offset:2120
    ds_read_b64 v[34:35], v233 offset:168
    ds_read_b64 v[6:7], v233 offset:3920
    ds_read_b64 v[16:17], v233 offset:4080
    ds_read_b64 v[26:27], v233 offset:2128
    ds_read_b64 v[36:37], v233 offset:176
    ds_read_b64 v[8:9], v233 offset:3928
    ds_read_b64 v[18:19], v233 offset:4088
    ds_read_b64 v[28:29], v233 offset:2136
    ds_read_b64 v[38:39], v233 offset:184
    ds_read_b64 v[10:11], v233 offset:3936
    ds_read_b64 v[20:21], v233 offset:4096
    ds_read_b64 v[30:31], v233 offset:2144
    ds_read_b64 v[40:41], v233 offset:192
    s_waitcnt lgkmcnt(15)
    v_mfma_f32_4x4x4_16b_bf16 v[72:75], v[12:13], v[2:3], 0
    ds_read_b64_tr_b16 v[42:43], v234 offset:4224
    v_mfma_f32_4x4x4_16b_bf16 v[76:79], v[22:23], v[2:3], 0
    ds_read_b64_tr_b16 v[44:45], v234 offset:4232
    v_mfma_f32_4x4x4_16b_bf16 v[80:83], v[32:33], v[2:3], 0
    ds_read_b64_tr_b16 v[46:47], v234 offset:4240
    s_waitcnt lgkmcnt(15)
    v_mfma_f32_4x4x4_16b_bf16 v[72:75], v[14:15], v[4:5], v[72:75]
    ds_read_b64_tr_b16 v[48:49], v234 offset:4248
    v_mfma_f32_4x4x4_16b_bf16 v[76:79], v[24:25], v[4:5], v[76:79]
    ds_read_b64_tr_b16 v[50:51], v234 offset:4256
    v_mfma_f32_4x4x4_16b_bf16 v[80:83], v[34:35], v[4:5], v[80:83]
    ds_read_b64_tr_b16 v[52:53], v234 offset:2272
    s_waitcnt lgkmcnt(14)
    v_mfma_f32_4x4x4_16b_bf16 v[72:75], v[16:17], v[6:7], v[72:75]
    ds_read_b64_tr_b16 v[54:55], v234 offset:2280
    v_mfma_f32_4x4x4_16b_bf16 v[76:79], v[26:27], v[6:7], v[76:79]
    ds_read_b64_tr_b16 v[56:57], v234 offset:2288
    v_mfma_f32_4x4x4_16b_bf16 v[80:83], v[36:37], v[6:7], v[80:83]
    ds_read_b64_tr_b16 v[58:59], v234 offset:2296
    s_waitcnt lgkmcnt(13)
    v_mfma_f32_4x4x4_16b_bf16 v[72:75], v[18:19], v[8:9], v[72:75]
    ds_read_b64_tr_b16 v[60:61], v234 offset:2304
    v_mfma_f32_4x4x4_16b_bf16 v[76:79], v[28:29], v[8:9], v[76:79]
    ds_read_b64_tr_b16 v[62:63], v234 offset:320
    v_mfma_f32_4x4x4_16b_bf16 v[80:83], v[38:39], v[8:9], v[80:83]
    ds_read_b64_tr_b16 v[64:65], v234 offset:328
    s_waitcnt lgkmcnt(12)
    v_mfma_f32_4x4x4_16b_bf16 v[72:75], v[20:21], v[10:11], v[72:75]
    ds_read_b64_tr_b16 v[66:67], v234 offset:336
    v_mfma_f32_4x4x4_16b_bf16 v[76:79], v[30:31], v[10:11], v[76:79]
    ds_read_b64_tr_b16 v[68:69], v234 offset:344
    v_mfma_f32_4x4x4_16b_bf16 v[80:83], v[40:41], v[10:11], v[80:83]
    ds_read_b64_tr_b16 v[70:71], v234 offset:352
    v_cndmask_b32 v72, v237, v72, s[64:65]
    v_cndmask_b32 v73, v237, v73, s[66:67]
    v_cndmask_b32 v74, v237, v74, s[68:69]
    v_cndmask_b32 v75, v237, v75, s[70:71]
    v_cndmask_b32 v76, v237, v76, s[72:73]
    v_cndmask_b32 v77, v237, v77, s[74:75]
    v_cndmask_b32 v78, v237, v78, s[76:77]
    v_cndmask_b32 v79, v237, v79, s[78:79]
    v_cndmask_b32 v80, v237, v80, s[80:81]
    v_cndmask_b32 v81, v237, v81, s[82:83]
    v_cndmask_b32 v82, v237, v82, s[84:85]
    v_cndmask_b32 v83, v237, v83, s[86:87]
    v_max3_f32 v112, v72, v73, v74
    v_max3_f32 v112, v112, v75, v76
    v_max3_f32 v112, v112, v77, v78
    v_max3_f32 v112, v112, v79, v80
    v_max3_f32 v112, v112, v81, v82
    v_max_f32 v112, v112, v83
    v_mul_f32 v112, s90, v112
    v_fma_f32 v72, v72, s90, -v112
    v_fma_f32 v73, v73, s90, -v112
    v_fma_f32 v74, v74, s90, -v112
    v_fma_f32 v75, v75, s90, -v112
    v_fma_f32 v76, v76, s90, -v112
    v_fma_f32 v77, v77, s90, -v112
    v_fma_f32 v78, v78, s90, -v112
    v_fma_f32 v79, v79, s90, -v112
    v_fma_f32 v80, v80, s90, -v112
    v_fma_f32 v81, v81, s90, -v112
    v_fma_f32 v82, v82, s90, -v112
    v_fma_f32 v83, v83, s90, -v112
    v_exp_f32 v72, v72
    v_exp_f32 v73, v73
    v_exp_f32 v74, v74
    v_exp_f32 v75, v75
    v_exp_f32 v76, v76
    v_exp_f32 v77, v77
    v_exp_f32 v78, v78
    v_exp_f32 v79, v79
    v_exp_f32 v80, v80
    v_exp_f32 v81, v81
    v_exp_f32 v82, v82
    v_exp_f32 v83, v83
    v_add_f32 v112, v72, v73
    v_add_f32 v112, v112, v74
    v_add_f32 v112, v112, v75
    v_add_f32 v112, v112, v76
    v_add_f32 v112, v112, v77
    v_add_f32 v112, v112, v78
    v_add_f32 v112, v112, v79
    v_add_f32 v112, v112, v80
    v_add_f32 v112, v112, v81
    v_add_f32 v112, v112, v82
    v_add_f32 v112, v112, v83
    v_rcp_f32 v112, v112
    s_nop 0
    v_mul_f32 v72, v72, v112
    v_mul_f32 v73, v73, v112
    v_mul_f32 v74, v74, v112
    v_mul_f32 v75, v75, v112
    v_mul_f32 v76, v76, v112
    v_mul_f32 v77, v77, v112
    v_mul_f32 v78, v78, v112
    v_mul_f32 v79, v79, v112
    v_mul_f32 v80, v80, v112
    v_mul_f32 v81, v81, v112
    v_mul_f32 v82, v82, v112
    v_mul_f32 v83, v83, v112
    v_cvt_pk_bf16_f32 v84, v72, v73
    v_cvt_pk_bf16_f32 v85, v74, v75
    v_cvt_pk_bf16_f32 v86, v76, v77
    v_cvt_pk_bf16_f32 v87, v78, v79
    v_cvt_pk_bf16_f32 v88, v80, v81
    v_cvt_pk_bf16_f32 v89, v82, v83
    s_waitcnt lgkmcnt(10)
    v_mfma_f32_4x4x4_16b_bf16 v[92:95], v[42:43], v[84:85], 0
    v_mfma_f32_4x4x4_16b_bf16 v[96:99], v[44:45], v[84:85], 0
    v_mfma_f32_4x4x4_16b_bf16 v[100:103], v[46:47], v[84:85], 0
    v_mfma_f32_4x4x4_16b_bf16 v[104:107], v[48:49], v[84:85], 0
    v_mfma_f32_4x4x4_16b_bf16 v[108:111], v[50:51], v[84:85], 0
    s_waitcnt lgkmcnt(5)
    v_mfma_f32_4x4x4_16b_bf16 v[92:95], v[52:53], v[86:87], v[92:95]
    v_mfma_f32_4x4x4_16b_bf16 v[96:99], v[54:55], v[86:87], v[96:99]
    v_mfma_f32_4x4x4_16b_bf16 v[100:103], v[56:57], v[86:87], v[100:103]
    v_mfma_f32_4x4x4_16b_bf16 v[104:107], v[58:59], v[86:87], v[104:107]
    v_mfma_f32_4x4x4_16b_bf16 v[108:111], v[60:61], v[86:87], v[108:111]
    s_waitcnt lgkmcnt(0)
    v_mfma_f32_4x4x4_16b_bf16 v[92:95], v[62:63], v[88:89], v[92:95]
    v_mfma_f32_4x4x4_16b_bf16 v[96:99], v[64:65], v[88:89], v[96:99]
    v_mfma_f32_4x4x4_16b_bf16 v[100:103], v[66:67], v[88:89], v[100:103]
    v_mfma_f32_4x4x4_16b_bf16 v[104:107], v[68:69], v[88:89], v[104:107]
    v_mfma_f32_4x4x4_16b_bf16 v[108:111], v[70:71], v[88:89], v[108:111]
    s_nop 0
    v_cvt_pk_bf16_f32 v114, v92, v93
    v_cvt_pk_bf16_f32 v115, v94, v95
    v_cvt_pk_bf16_f32 v116, v96, v97
    v_cvt_pk_bf16_f32 v117, v98, v99
    v_cvt_pk_bf16_f32 v118, v100, v101
    v_cvt_pk_bf16_f32 v119, v102, v103
    v_cvt_pk_bf16_f32 v120, v104, v105
    v_cvt_pk_bf16_f32 v121, v106, v107
    v_cvt_pk_bf16_f32 v122, v108, v109
    v_cvt_pk_bf16_f32 v123, v110, v111
    buffer_store_dwordx4 v[114:117], v236, s[12:15], s88 offen sc1
    buffer_store_dwordx4 v[118:121], v236, s[12:15], s88 offen offset:256 sc1
    v_mov_b32 v124, v122
    v_mov_b32 v125, v123
    s_nop 0
    v_permlane32_swap_b32 v122, v124
    v_permlane32_swap_b32 v123, v125
    s_mov_b32 exec_hi, 0
    buffer_store_dwordx4 v[122:125], v235, s[12:15], s89 offen sc1
    s_mov_b64 exec, -1
    v_mov_b32 v252, 1
    v_mov_b32 v253, 0
    s_waitcnt vmcnt(0)
    s_mov_b64 exec, 1
    buffer_store_dword v252, v253, s[12:15], s45 offen
    s_mov_b64 exec, -1
    v_add_u32 v251, 1, v251
    ds_write_b32 v250, v251
    s_lshl_b32 s46, s43, 2
    s_add_u32 s46, s46, s40
    s_mul_i32 s50, s46, 20480
    s_add_u32 s50, s50, 0x280000
    s_mul_i32 s47, s46, 20480
    s_xor_b32 s51, s46, 1
    s_mul_i32 s48, s51, 20480
    s_and_b32 s52, s40, 1
    s_lshl_b32 s51, s52, 10
    s_add_u32 s47, s47, s51
    s_add_u32 s48, s48, s51
    s_mul_i32 s52, s52, 5120
    s_mul_i32 s53, s44, 5
    s_lshl_b32 s54, s46, 10
    s_lshl_b32 s49, s44, 7
    s_add_u32 s49, s49, s54
    s_add_u32 s49, s49, 0x1500000
    v_lshlrev_b32 v44, 4, v0
    v_and_b32 v54, 15, v0
    v_lshrrev_b32 v55, 5, v0
    v_lshlrev_b32 v55, 6, v55
    v_lshl_add_u32 v47, v54, 2, v55
    v_lshrrev_b32 v54, 2, v0
    v_mul_u32_u24 v54, 160, v54
    v_and_b32 v55, 3, v0
    v_lshl_add_u32 v45, v55, 3, v54
    v_add_u32 v45, s52, v45
    v_add_u32 v46, 61440, v45
    v_mov_b32 v48, 0x3f803f80
    s_mul_i32 s51, s40, 5120
    s_add_u32 s51, s51, 28672
    v_add_u32 v52, s51, v44
    s_xor_b32 s51, s40, 1
    s_mul_i32 s51, s51, 5120
    s_add_u32 s51, s51, 28672
    v_add_u32 v53, s51, v44
    v_lshrrev_b32 v54, 5, v0
    v_lshlrev_b32 v54, 8, v54
    v_and_b32 v172, 15, v0
    v_lshl_add_u32 v172, v172, 4, v54
    v_and_b32 v51, 3, v0
    v_lshlrev_b32 v51, 8, v51
    v_add_u32 v51, 144384, v51
    v_lshlrev_b32 v4, 16, v240
    v_and_b32 v5, 0xffff0000, v240
    v_lshlrev_b32 v6, 16, v241
    v_and_b32 v7, 0xffff0000, v241
    v_lshlrev_b32 v8, 16, v242
    v_and_b32 v9, 0xffff0000, v242
    v_lshlrev_b32 v10, 16, v243
    v_and_b32 v11, 0xffff0000, v243
    v_lshlrev_b32 v12, 16, v244
    v_and_b32 v13, 0xffff0000, v244
    v_lshlrev_b32 v14, 16, v245
    v_and_b32 v15, 0xffff0000, v245
    v_lshlrev_b32 v16, 16, v246
    v_and_b32 v17, 0xffff0000, v246
    v_lshlrev_b32 v18, 16, v247
    v_and_b32 v19, 0xffff0000, v247
    v_lshlrev_b32 v20, 16, v248
    v_and_b32 v21, 0xffff0000, v248
    v_lshlrev_b32 v22, 16, v249
    v_and_b32 v23, 0xffff0000, v249
    s_mov_b32 s91, 0
SP_16:
    ds_read_b64 v[252:253], v254 offset:1024
    s_add_u32 s91, s91, 1
    s_waitcnt lgkmcnt(0)
    v_min_u32 v252, v252, v253
    s_nop 0
    v_readfirstlane_b32 s92, v252
    s_cmp_ge_u32 s91, 400000
    s_cbranch_scc1 OK_15
    s_cmp_lt_u32 s92, 21
    s_cbranch_scc1 SP_16
OK_15:
    ds_read_b64_tr_b16 v[140:141], v45 offset:0
    ds_read_b64_tr_b16 v[142:143], v45 offset:2560
    ds_read_b64_tr_b16 v[144:145], v45 offset:32
    ds_read_b64_tr_b16 v[146:147], v45 offset:2592
    ds_read_b64_tr_b16 v[148:149], v45 offset:64
    ds_read_b64_tr_b16 v[150:151], v45 offset:2624
    ds_read_b64_tr_b16 v[152:153], v45 offset:96
    ds_read_b64_tr_b16 v[154:155], v45 offset:2656
    ds_read_b64_tr_b16 v[156:157], v45 offset:128
    ds_read_b64_tr_b16 v[158:159], v45 offset:2688
    ds_read_b64_tr_b16 v[160:161], v45 offset:10240
    ds_read_b64_tr_b16 v[162:163], v45 offset:12800
    s_mov_b32 s91, 0
SP_18:
    ds_read_b32 v252, v254 offset:1032
    s_add_u32 s91, s91, 1
    s_waitcnt lgkmcnt(0)
    v_readfirstlane_b32 s92, v252
    s_cmp_ge_u32 s91, 400000
    s_cbranch_scc1 OK_17
    s_cmp_lt_u32 s92, 1
    s_cbranch_scc1 SP_18
OK_17:
    s_waitcnt lgkmcnt(0)
    v_lshlrev_b32 v56, 2, v0
    s_bitcmp1_b32 s43, 0
    s_cselect_b32 exec_lo, 0, -1
    s_cselect_b32 exec_hi, -1, 0
    s_and_b32 s54, s45, 0xffffff00
    s_mov_b32 s91, 0
    buffer_load_dword v239, v56, s[12:15], s54 offen sc1
GL_20:
    buffer_load_dword v238, v56, s[12:15], s54 offen sc1
    s_waitcnt vmcnt(1)
    v_cmp_le_u32 vcc, 1, v239
    s_add_u32 s91, s91, 1
    s_cmp_eq_u64 vcc, exec
    s_cbranch_scc1 GO_19
    buffer_load_dword v239, v56, s[12:15], s54 offen sc1
    s_waitcnt vmcnt(1)
    v_cmp_le_u32 vcc, 1, v238
    s_cmp_ge_u32 s91, 80000
    s_cbranch_scc1 GO_19
    s_cmp_lg_u64 vcc, exec
    s_cbranch_scc1 GL_20
GO_19:
    s_mov_b64 exec, -1
    buffer_load_dwordx4 v[60:63], v44, s[12:15], s47 offen sc1
    buffer_load_dwordx4 v[64:67], v44, s[12:15], s48 offen sc1
    buffer_load_dwordx4 v[68:71], v44, s[12:15], s47 offen offset:2048 sc1
    s_add_u32 s47, s47, 4096
    buffer_load_dwordx4 v[72:75], v44, s[12:15], s48 offen offset:2048 sc1
    s_add_u32 s48, s48, 4096
    buffer_load_dwordx4 v[76:79], v44, s[12:15], s47 offen sc1
    buffer_load_dwordx4 v[80:83], v44, s[12:15], s48 offen sc1
    buffer_load_dwordx4 v[84:87], v44, s[12:15], s47 offen offset:2048 sc1
    s_add_u32 s47, s47, 4096
    buffer_load_dwordx4 v[88:91], v44, s[12:15], s48 offen offset:2048 sc1
    s_add_u32 s48, s48, 4096
    buffer_load_dwordx4 v[92:95], v44, s[12:15], s47 offen sc1
    buffer_load_dwordx4 v[96:99], v44, s[12:15], s48 offen sc1
    buffer_load_dwordx4 v[100:103], v44, s[12:15], s47 offen offset:2048 sc1
    s_add_u32 s47, s47, 4096
    buffer_load_dwordx4 v[104:107], v44, s[12:15], s48 offen offset:2048 sc1
    s_add_u32 s48, s48, 4096
    buffer_load_dwordx4 v[108:111], v44, s[12:15], s47 offen sc1
    buffer_load_dwordx4 v[112:115], v44, s[12:15], s48 offen sc1
    buffer_load_dwordx4 v[116:119], v44, s[12:15], s47 offen offset:2048 sc1
    s_add_u32 s47, s47, 4096
    buffer_load_dwordx4 v[120:123], v44, s[12:15], s48 offen offset:2048 sc1
    s_add_u32 s48, s48, 4096
    buffer_load_dwordx4 v[124:127], v44, s[12:15], s47 offen sc1
    buffer_load_dwordx4 v[128:131], v44, s[12:15], s48 offen sc1
    buffer_load_dwordx4 v[132:135], v44, s[12:15], s47 offen offset:2048 sc1
    s_add_u32 s47, s47, 4096
    buffer_load_dwordx4 v[136:139], v44, s[12:15], s48 offen offset:2048 sc1
    s_add_u32 s48, s48, 4096
    v_add_u32 v251, 1, v251
    ds_write_b32 v250, v251
    s_waitcnt vmcnt(18)
    v_mfma_f32_16x16x32_bf16 v[4:7], v[140:143], v[60:63], v[4:7]
    ds_read_b64_tr_b16 v[164:165], v45 offset:10272
    v_mfma_f32_16x16x32_bf16 v[24:27], v[140:143], v[64:67], 0
    ds_read_b64_tr_b16 v[166:167], v45 offset:12832
    v_mfma_f32_16x16x32_bf16 v[8:11], v[144:147], v[60:63], v[8:11]
    ds_read_b64_tr_b16 v[140:141], v45 offset:10304
    v_mfma_f32_16x16x32_bf16 v[28:31], v[144:147], v[64:67], 0
    ds_read_b64_tr_b16 v[142:143], v45 offset:12864
    v_mfma_f32_16x16x32_bf16 v[12:15], v[148:151], v[60:63], v[12:15]
    ds_read_b64_tr_b16 v[144:145], v45 offset:10336
    v_mfma_f32_16x16x32_bf16 v[32:35], v[148:151], v[64:67], 0
    ds_read_b64_tr_b16 v[146:147], v45 offset:12896
    v_mfma_f32_16x16x32_bf16 v[16:19], v[152:155], v[60:63], v[16:19]
    ds_read_b64_tr_b16 v[148:149], v45 offset:10368
    v_mfma_f32_16x16x32_bf16 v[36:39], v[152:155], v[64:67], 0
    ds_read_b64_tr_b16 v[150:151], v45 offset:12928
    v_mfma_f32_16x16x32_bf16 v[20:23], v[156:159], v[60:63], v[20:23]
    ds_read_b64_tr_b16 v[152:153], v45 offset:20480
    v_mfma_f32_16x16x32_bf16 v[40:43], v[156:159], v[64:67], 0
    ds_read_b64_tr_b16 v[154:155], v45 offset:23040
    s_waitcnt vmcnt(16)
    v_mfma_f32_16x16x32_bf16 v[4:7], v[160:163], v[68:71], v[4:7]
    ds_read_b64_tr_b16 v[156:157], v45 offset:20512
    v_mfma_f32_16x16x32_bf16 v[24:27], v[160:163], v[72:75], v[24:27]
    ds_read_b64_tr_b16 v[158:159], v45 offset:23072
    s_waitcnt lgkmcnt(10)
    v_mfma_f32_16x16x32_bf16 v[8:11], v[164:167], v[68:71], v[8:11]
    ds_read_b64_tr_b16 v[160:161], v45 offset:20544
    v_mfma_f32_16x16x32_bf16 v[28:31], v[164:167], v[72:75], v[28:31]
    ds_read_b64_tr_b16 v[162:163], v45 offset:23104
    s_waitcnt lgkmcnt(10)
    v_mfma_f32_16x16x32_bf16 v[12:15], v[140:143], v[68:71], v[12:15]
    ds_read_b64_tr_b16 v[164:165], v45 offset:20576
    v_mfma_f32_16x16x32_bf16 v[32:35], v[140:143], v[72:75], v[32:35]
    ds_read_b64_tr_b16 v[166:167], v45 offset:23136
    s_waitcnt lgkmcnt(10)
    v_mfma_f32_16x16x32_bf16 v[16:19], v[144:147], v[68:71], v[16:19]
    ds_read_b64_tr_b16 v[140:141], v45 offset:20608
    v_mfma_f32_16x16x32_bf16 v[36:39], v[144:147], v[72:75], v[36:39]
    ds_read_b64_tr_b16 v[142:143], v45 offset:23168
    s_waitcnt lgkmcnt(10)
    v_mfma_f32_16x16x32_bf16 v[20:23], v[148:151], v[68:71], v[20:23]
    ds_read_b64_tr_b16 v[144:145], v45 offset:30720
    v_mfma_f32_16x16x32_bf16 v[40:43], v[148:151], v[72:75], v[40:43]
    ds_read_b64_tr_b16 v[146:147], v45 offset:33280
    s_waitcnt vmcnt(14) lgkmcnt(10)
    v_mfma_f32_16x16x32_bf16 v[4:7], v[152:155], v[76:79], v[4:7]
    ds_read_b64_tr_b16 v[148:149], v45 offset:30752
    v_mfma_f32_16x16x32_bf16 v[24:27], v[152:155], v[80:83], v[24:27]
    ds_read_b64_tr_b16 v[150:151], v45 offset:33312
    s_waitcnt lgkmcnt(10)
    v_mfma_f32_16x16x32_bf16 v[8:11], v[156:159], v[76:79], v[8:11]
    ds_read_b64_tr_b16 v[152:153], v45 offset:30784
    v_mfma_f32_16x16x32_bf16 v[28:31], v[156:159], v[80:83], v[28:31]
    ds_read_b64_tr_b16 v[154:155], v45 offset:33344
    s_waitcnt lgkmcnt(10)
    v_mfma_f32_16x16x32_bf16 v[12:15], v[160:163], v[76:79], v[12:15]
    ds_read_b64_tr_b16 v[156:157], v45 offset:30816
    v_mfma_f32_16x16x32_bf16 v[32:35], v[160:163], v[80:83], v[32:35]
    ds_read_b64_tr_b16 v[158:159], v45 offset:33376
    s_waitcnt lgkmcnt(10)
    v_mfma_f32_16x16x32_bf16 v[16:19], v[164:167], v[76:79], v[16:19]
    ds_read_b64_tr_b16 v[160:161], v45 offset:30848
    v_mfma_f32_16x16x32_bf16 v[36:39], v[164:167], v[80:83], v[36:39]
    ds_read_b64_tr_b16 v[162:163], v45 offset:33408
    s_waitcnt lgkmcnt(10)
    v_mfma_f32_16x16x32_bf16 v[20:23], v[140:143], v[76:79], v[20:23]
    ds_read_b64_tr_b16 v[164:165], v45 offset:40960
    v_mfma_f32_16x16x32_bf16 v[40:43], v[140:143], v[80:83], v[40:43]
    ds_read_b64_tr_b16 v[166:167], v45 offset:43520
    s_waitcnt vmcnt(12) lgkmcnt(10)
    v_mfma_f32_16x16x32_bf16 v[4:7], v[144:147], v[84:87], v[4:7]
    ds_read_b64_tr_b16 v[140:141], v45 offset:40992
    v_mfma_f32_16x16x32_bf16 v[24:27], v[144:147], v[88:91], v[24:27]
    ds_read_b64_tr_b16 v[142:143], v45 offset:43552
    s_waitcnt lgkmcnt(10)
    v_mfma_f32_16x16x32_bf16 v[8:11], v[148:151], v[84:87], v[8:11]
    ds_read_b64_tr_b16 v[144:145], v45 offset:41024
    v_mfma_f32_16x16x32_bf16 v[28:31], v[148:151], v[88:91], v[28:31]
    ds_read_b64_tr_b16 v[146:147], v45 offset:43584
    s_waitcnt lgkmcnt(10)
    v_mfma_f32_16x16x32_bf16 v[12:15], v[152:155], v[84:87], v[12:15]
    ds_read_b64_tr_b16 v[148:149], v45 offset:41056
    v_mfma_f32_16x16x32_bf16 v[32:35], v[152:155], v[88:91], v[32:35]
    ds_read_b64_tr_b16 v[150:151], v45 offset:43616
    s_waitcnt lgkmcnt(10)
    v_mfma_f32_16x16x32_bf16 v[16:19], v[156:159], v[84:87], v[16:19]
    ds_read_b64_tr_b16 v[152:153], v45 offset:41088
    v_mfma_f32_16x16x32_bf16 v[36:39], v[156:159], v[88:91], v[36:39]
    ds_read_b64_tr_b16 v[154:155], v45 offset:43648
    s_waitcnt lgkmcnt(10)
    v_mfma_f32_16x16x32_bf16 v[20:23], v[160:163], v[84:87], v[20:23]
    ds_read_b64_tr_b16 v[156:157], v45 offset:51200
    v_mfma_f32_16x16x32_bf16 v[40:43], v[160:163], v[88:91], v[40:43]
    ds_read_b64_tr_b16 v[158:159], v45 offset:53760
    s_waitcnt vmcnt(10) lgkmcnt(10)
    v_mfma_f32_16x16x32_bf16 v[4:7], v[164:167], v[92:95], v[4:7]
    ds_read_b64_tr_b16 v[160:161], v45 offset:51232
    v_mfma_f32_16x16x32_bf16 v[24:27], v[164:167], v[96:99], v[24:27]
    ds_read_b64_tr_b16 v[162:163], v45 offset:53792
    s_waitcnt lgkmcnt(10)
    v_mfma_f32_16x16x32_bf16 v[8:11], v[140:143], v[92:95], v[8:11]
    ds_read_b64_tr_b16 v[164:165], v45 offset:51264
    v_mfma_f32_16x16x32_bf16 v[28:31], v[140:143], v[96:99], v[28:31]
    ds_read_b64_tr_b16 v[166:167], v45 offset:53824
    s_waitcnt lgkmcnt(10)
    v_mfma_f32_16x16x32_bf16 v[12:15], v[144:147], v[92:95], v[12:15]
    ds_read_b64_tr_b16 v[140:141], v45 offset:51296
    v_mfma_f32_16x16x32_bf16 v[32:35], v[144:147], v[96:99], v[32:35]
    ds_read_b64_tr_b16 v[142:143], v45 offset:53856
    s_waitcnt lgkmcnt(10)
    v_mfma_f32_16x16x32_bf16 v[16:19], v[148:151], v[92:95], v[16:19]
    ds_read_b64_tr_b16 v[144:145], v45 offset:51328
    v_mfma_f32_16x16x32_bf16 v[36:39], v[148:151], v[96:99], v[36:39]
    ds_read_b64_tr_b16 v[146:147], v45 offset:53888
    s_waitcnt lgkmcnt(10)
    v_mfma_f32_16x16x32_bf16 v[20:23], v[152:155], v[92:95], v[20:23]
    v_add_u32 v251, 1, v251
    ds_write_b32 v250, v251
    ds_read_b64_tr_b16 v[148:149], v46 offset:0
    v_mfma_f32_16x16x32_bf16 v[40:43], v[152:155], v[96:99], v[40:43]
    ds_read_b64_tr_b16 v[150:151], v46 offset:2560
    s_waitcnt vmcnt(8) lgkmcnt(11)
    v_mfma_f32_16x16x32_bf16 v[4:7], v[156:159], v[100:103], v[4:7]
    ds_read_b64_tr_b16 v[152:153], v46 offset:32
    v_mfma_f32_16x16x32_bf16 v[24:27], v[156:159], v[104:107], v[24:27]
    ds_read_b64_tr_b16 v[154:155], v46 offset:2592
    s_waitcnt lgkmcnt(11)
    v_mfma_f32_16x16x32_bf16 v[8:11], v[160:163], v[100:103], v[8:11]
    ds_read_b64_tr_b16 v[156:157], v46 offset:64
    v_mfma_f32_16x16x32_bf16 v[28:31], v[160:163], v[104:107], v[28:31]
    ds_read_b64_tr_b16 v[158:159], v46 offset:2624
    s_waitcnt lgkmcnt(11)
    v_mfma_f32_16x16x32_bf16 v[12:15], v[164:167], v[100:103], v[12:15]
    ds_read_b64_tr_b16 v[160:161], v46 offset:96
    v_mfma_f32_16x16x32_bf16 v[32:35], v[164:167], v[104:107], v[32:35]
    ds_read_b64_tr_b16 v[162:163], v46 offset:2656
    s_waitcnt lgkmcnt(11)
    v_mfma_f32_16x16x32_bf16 v[16:19], v[140:143], v[100:103], v[16:19]
    ds_read_b64_tr_b16 v[164:165], v46 offset:128
    v_mfma_f32_16x16x32_bf16 v[36:39], v[140:143], v[104:107], v[36:39]
    ds_read_b64_tr_b16 v[166:167], v46 offset:2688
    s_waitcnt lgkmcnt(11)
    v_mfma_f32_16x16x32_bf16 v[20:23], v[144:147], v[100:103], v[20:23]
    ds_read_b64_tr_b16 v[140:141], v46 offset:10240
    v_mfma_f32_16x16x32_bf16 v[40:43], v[144:147], v[104:107], v[40:43]
    ds_read_b64_tr_b16 v[142:143], v46 offset:12800
    s_waitcnt vmcnt(6) lgkmcnt(10)
    v_mfma_f32_16x16x32_bf16 v[4:7], v[148:151], v[108:111], v[4:7]
    ds_read_b64_tr_b16 v[144:145], v46 offset:10272
    v_mfma_f32_16x16x32_bf16 v[24:27], v[148:151], v[112:115], v[24:27]
    ds_read_b64_tr_b16 v[146:147], v46 offset:12832
    s_waitcnt lgkmcnt(10)
    v_mfma_f32_16x16x32_bf16 v[8:11], v[152:155], v[108:111], v[8:11]
    ds_read_b64_tr_b16 v[148:149], v46 offset:10304
    v_mfma_f32_16x16x32_bf16 v[28:31], v[152:155], v[112:115], v[28:31]
    ds_read_b64_tr_b16 v[150:151], v46 offset:12864
    s_waitcnt lgkmcnt(10)
    v_mfma_f32_16x16x32_bf16 v[12:15], v[156:159], v[108:111], v[12:15]
    ds_read_b64_tr_b16 v[152:153], v46 offset:10336
    v_mfma_f32_16x16x32_bf16 v[32:35], v[156:159], v[112:115], v[32:35]
    ds_read_b64_tr_b16 v[154:155], v46 offset:12896
    s_waitcnt lgkmcnt(10)
    v_mfma_f32_16x16x32_bf16 v[16:19], v[160:163], v[108:111], v[16:19]
    ds_read_b64_tr_b16 v[156:157], v46 offset:10368
    v_mfma_f32_16x16x32_bf16 v[36:39], v[160:163], v[112:115], v[36:39]
    ds_read_b64_tr_b16 v[158:159], v46 offset:12928
    s_waitcnt lgkmcnt(10)
    v_mfma_f32_16x16x32_bf16 v[20:23], v[164:167], v[108:111], v[20:23]
    ds_read_b64_tr_b16 v[160:161], v46 offset:20480
    v_mfma_f32_16x16x32_bf16 v[40:43], v[164:167], v[112:115], v[40:43]
    ds_read_b64_tr_b16 v[162:163], v46 offset:23040
    s_waitcnt vmcnt(4) lgkmcnt(10)
    v_mfma_f32_16x16x32_bf16 v[4:7], v[140:143], v[116:119], v[4:7]
    ds_read_b64_tr_b16 v[164:165], v46 offset:20512
    v_mfma_f32_16x16x32_bf16 v[24:27], v[140:143], v[120:123], v[24:27]
    ds_read_b64_tr_b16 v[166:167], v46 offset:23072
    s_waitcnt lgkmcnt(10)
    v_mfma_f32_16x16x32_bf16 v[8:11], v[144:147], v[116:119], v[8:11]
    ds_read_b64_tr_b16 v[140:141], v46 offset:20544
    v_mfma_f32_16x16x32_bf16 v[28:31], v[144:147], v[120:123], v[28:31]
    ds_read_b64_tr_b16 v[142:143], v46 offset:23104
    ds_read_b32 v57, v51
    s_waitcnt lgkmcnt(11)
    v_mfma_f32_16x16x32_bf16 v[12:15], v[148:151], v[116:119], v[12:15]
    ds_read_b64_tr_b16 v[144:145], v46 offset:20576
    v_mfma_f32_16x16x32_bf16 v[32:35], v[148:151], v[120:123], v[32:35]
    ds_read_b64_tr_b16 v[146:147], v46 offset:23136
    s_waitcnt lgkmcnt(11)
    v_mfma_f32_16x16x32_bf16 v[16:19], v[152:155], v[116:119], v[16:19]
    ds_read_b64_tr_b16 v[148:149], v46 offset:20608
    v_mfma_f32_16x16x32_bf16 v[36:39], v[152:155], v[120:123], v[36:39]
    ds_read_b64_tr_b16 v[150:151], v46 offset:23168
    s_waitcnt lgkmcnt(11)
    v_mfma_f32_16x16x32_bf16 v[20:23], v[156:159], v[116:119], v[20:23]
    ds_read_b64_tr_b16 v[152:153], v46 offset:30720
    v_mfma_f32_16x16x32_bf16 v[40:43], v[156:159], v[120:123], v[40:43]
    ds_read_b64_tr_b16 v[154:155], v46 offset:33280
    s_waitcnt vmcnt(2) lgkmcnt(11)
    v_mfma_f32_16x16x32_bf16 v[4:7], v[160:163], v[124:127], v[4:7]
    ds_read_b64_tr_b16 v[156:157], v46 offset:30752
    v_mfma_f32_16x16x32_bf16 v[24:27], v[160:163], v[128:131], v[24:27]
    ds_read_b64_tr_b16 v[158:159], v46 offset:33312
    s_waitcnt lgkmcnt(11)
    v_mfma_f32_16x16x32_bf16 v[8:11], v[164:167], v[124:127], v[8:11]
    ds_read_b64_tr_b16 v[160:161], v46 offset:30784
    v_mfma_f32_16x16x32_bf16 v[28:31], v[164:167], v[128:131], v[28:31]
    ds_read_b64_tr_b16 v[162:163], v46 offset:33344
    s_waitcnt lgkmcnt(11)
    v_mfma_f32_16x16x32_bf16 v[12:15], v[140:143], v[124:127], v[12:15]
    ds_read_b64_tr_b16 v[164:165], v46 offset:30816
    v_mfma_f32_16x16x32_bf16 v[32:35], v[140:143], v[128:131], v[32:35]
    ds_read_b64_tr_b16 v[166:167], v46 offset:33376
    s_waitcnt lgkmcnt(12)
    v_cmp_le_u32 vcc, 26, v57
    s_nop 0
    s_cmp_lg_u64 vcc, -1
    s_cbranch_scc1 SP_22s
OK_21:
    s_xor_b32 s51, s40, 1
    s_lshl_b32 s51, s51, 8
    s_add_u32 s51, s51, 144384
    v_mov_b32 v51, s51
    s_waitcnt lgkmcnt(10)
    v_mfma_f32_16x16x32_bf16 v[16:19], v[144:147], v[124:127], v[16:19]
    ds_read_b64_tr_b16 v[140:141], v46 offset:30848
    v_mfma_f32_16x16x32_bf16 v[36:39], v[144:147], v[128:131], v[36:39]
    ds_read_b64_tr_b16 v[142:143], v46 offset:33408
    s_waitcnt lgkmcnt(10)
    v_mfma_f32_16x16x32_bf16 v[20:23], v[148:151], v[124:127], v[20:23]
    v_add_u32 v251, 1, v251
    ds_write_b32 v250, v251
    v_mfma_f32_16x16x32_bf16 v[40:43], v[148:151], v[128:131], v[40:43]
    s_waitcnt vmcnt(0)
    s_waitcnt lgkmcnt(9)
    v_mfma_f32_16x16x32_bf16 v[24:27], v[152:155], v[136:139], v[24:27]
    s_waitcnt lgkmcnt(7)
    v_mfma_f32_16x16x32_bf16 v[28:31], v[156:159], v[136:139], v[28:31]
    s_waitcnt lgkmcnt(5)
    v_mfma_f32_16x16x32_bf16 v[32:35], v[160:163], v[136:139], v[32:35]
    s_waitcnt lgkmcnt(3)
    v_mfma_f32_16x16x32_bf16 v[36:39], v[164:167], v[136:139], v[36:39]
    s_waitcnt lgkmcnt(1)
    v_mfma_f32_16x16x32_bf16 v[40:43], v[140:143], v[136:139], v[40:43]
    v_mfma_f32_16x16x32_bf16 v[4:7], v[152:155], v[132:135], v[4:7]
    ds_write_b128 v52, v[24:27] offset:0
    v_mfma_f32_16x16x32_bf16 v[8:11], v[156:159], v[132:135], v[8:11]
    ds_write_b128 v52, v[28:31] offset:1024
    v_mfma_f32_16x16x32_bf16 v[12:15], v[160:163], v[132:135], v[12:15]
    ds_write_b128 v52, v[32:35] offset:2048
    v_mfma_f32_16x16x32_bf16 v[16:19], v[164:167], v[132:135], v[16:19]
    ds_write_b128 v52, v[36:39] offset:3072
    v_mfma_f32_16x16x32_bf16 v[20:23], v[140:143], v[132:135], v[20:23]
    ds_write_b128 v52, v[40:43] offset:4096
    v_add_u32 v251, 1, v251
    ds_write_b32 v250, v251
    s_mov_b32 s91, 0
SP_24:
    ds_read_b32 v57, v51
    s_add_u32 s91, s91, 1
    s_waitcnt lgkmcnt(0)
    v_cmp_le_u32 vcc, 28, v57
    s_cmp_ge_u32 s91, 400000
    s_cbranch_scc1 OK_23
    s_cmp_lg_u64 vcc, -1
    s_cbranch_scc1 SP_24
OK_23:
    ds_read_b128 v[24:27], v53 offset:0
    ds_read_b128 v[28:31], v53 offset:1024
    ds_read_b128 v[32:35], v53 offset:2048
    ds_read_b128 v[36:39], v53 offset:3072
    ds_read_b128 v[40:43], v53 offset:4096
    s_waitcnt lgkmcnt(4)
    v_pk_add_f32 v[4:5], v[4:5], v[24:25]
    v_pk_add_f32 v[6:7], v[6:7], v[26:27]
    v_cvt_pk_bf16_f32 v240, v4, v5
    v_cvt_pk_bf16_f32 v241, v6, v7
    s_waitcnt lgkmcnt(3)
    v_pk_add_f32 v[8:9], v[8:9], v[28:29]
    v_pk_add_f32 v[10:11], v[10:11], v[30:31]
    v_cvt_pk_bf16_f32 v242, v8, v9
    v_cvt_pk_bf16_f32 v243, v10, v11
    s_waitcnt lgkmcnt(2)
    v_pk_add_f32 v[12:13], v[12:13], v[32:33]
    v_pk_add_f32 v[14:15], v[14:15], v[34:35]
    v_cvt_pk_bf16_f32 v244, v12, v13
    v_cvt_pk_bf16_f32 v245, v14, v15
    s_waitcnt lgkmcnt(1)
    v_pk_add_f32 v[16:17], v[16:17], v[36:37]
    v_pk_add_f32 v[18:19], v[18:19], v[38:39]
    v_cvt_pk_bf16_f32 v246, v16, v17
    v_cvt_pk_bf16_f32 v247, v18, v19
    s_waitcnt lgkmcnt(0)
    v_pk_add_f32 v[20:21], v[20:21], v[40:41]
    v_pk_add_f32 v[22:23], v[22:23], v[42:43]
    v_cvt_pk_bf16_f32 v248, v20, v21
    v_cvt_pk_bf16_f32 v249, v22, v23
    s_lshr_b32 s51, s53, 1
    s_lshl_b32 s51, s51, 10
    s_add_u32 s51, s51, s50
    s_bitcmp1_b32 s53, 0
    s_cbranch_scc1 IO_25
    buffer_store_dwordx4 v[240:243], v44, s[12:15], s51 offen offset:0 sc1
    buffer_store_dwordx4 v[244:247], v44, s[12:15], s51 offen offset:1024 sc1
    v_mov_b32 v168, v248
    v_mov_b32 v169, v249
    v_mov_b32 v170, v248
    v_mov_b32 v171, v249
    s_nop 0
    v_permlane16_swap_b32 v168, v170
    v_permlane16_swap_b32 v169, v171
    s_mov_b32 exec_lo, 0xffff
    s_mov_b32 exec_hi, 0xffff
    buffer_store_dwordx4 v[168:171], v172, s[12:15], s51 offen offset:2048 sc1
    s_mov_b64 exec, -1
    s_branch IE_26
IO_25:
    buffer_store_dwordx4 v[242:245], v44, s[12:15], s51 offen offset:1024 sc1
    buffer_store_dwordx4 v[246:249], v44, s[12:15], s51 offen offset:2048 sc1
    v_mov_b32 v168, v240
    v_mov_b32 v169, v241
    v_mov_b32 v170, v240
    v_mov_b32 v171, v241
    s_nop 0
    v_permlane16_swap_b32 v168, v170
    v_permlane16_swap_b32 v169, v171
    s_mov_b32 exec_lo, 0xffff
    s_mov_b32 exec_hi, 0xffff
    buffer_store_dwordx4 v[168:171], v172, s[12:15], s51 offen offset:512 sc1
    s_mov_b64 exec, -1
IE_26:
    v_dot2_f32_bf16 v49, v240, v48, 0
    v_dot2_f32_bf16 v50, v240, v240, 0
    v_dot2_f32_bf16 v49, v241, v48, v49
    v_dot2_f32_bf16 v50, v241, v241, v50
    v_dot2_f32_bf16 v49, v242, v48, v49
    v_dot2_f32_bf16 v50, v242, v242, v50
    v_dot2_f32_bf16 v49, v243, v48, v49
    v_dot2_f32_bf16 v50, v243, v243, v50
    v_dot2_f32_bf16 v49, v244, v48, v49
    v_dot2_f32_bf16 v50, v244, v244, v50
    v_dot2_f32_bf16 v49, v245, v48, v49
    v_dot2_f32_bf16 v50, v245, v245, v50
    v_dot2_f32_bf16 v49, v246, v48, v49
    v_dot2_f32_bf16 v50, v246, v246, v50
    v_dot2_f32_bf16 v49, v247, v48, v49
    v_dot2_f32_bf16 v50, v247, v247, v50
    v_dot2_f32_bf16 v49, v248, v48, v49
    v_dot2_f32_bf16 v50, v248, v248, v50
    v_dot2_f32_bf16 v49, v249, v48, v49
    v_dot2_f32_bf16 v50, v249, v249, v50
    s_nop 2
    v_permlane32_swap_b32 v49, v50
    v_add_f32 v49, v49, v50
    v_mov_b32 v50, v49
    s_nop 1
    v_permlane16_swap_b32 v49, v50
    v_add_f32 v49, v49, v50
    s_mov_b32 exec_lo, 0xffff
    s_mov_b32 exec_hi, 0xffff
    buffer_store_dword v49, v47, s[12:15], s49 offen sc1
    s_mov_b64 exec, -1
    v_lshlrev_b32 v54, 7, v0
    s_and_b32 s52, s53, 1
    s_lshl_b32 s52, s52, 9
    s_add_u32 s51, s51, s52
    v_mov_b32 v252, 2
    v_mov_b32 v253, 0
    s_waitcnt vmcnt(0)
    s_mov_b64 exec, 1
    buffer_store_dword v252, v253, s[12:15], s45 offen
    s_mov_b64 exec, -1
    v_add_u32 v251, 1, v251
    ds_write_b32 v250, v251
    s_lshl_b32 s46, s41, 3
    s_lshl_b32 s51, s40, 1
    s_add_u32 s46, s46, s51
    s_mul_i32 s47, s46, 20480
    s_add_u32 s47, s47, 0x280000
    s_add_u32 s48, s47, 20480
    s_lshl_b32 s51, s46, 10
    s_add_u32 s51, s51, 0x1500000
    s_mov_b32 s50, 0
    s_mov_b32 s55, 0xbacccccd
    s_mov_b32 s56, 0x3acccccd
    s_mov_b32 s57, 0x3727c5ac
    s_mov_b32 s58, 0xbfb8aa3b
    v_lshlrev_b32 v116, 4, v0
    v_lshrrev_b32 v1, 4, v0
    v_lshlrev_b32 v1, 8, v1
    v_and_b32 v2, 15, v0
    v_lshl_add_u32 v1, v2, 2, v1
    v_lshrrev_b32 v2, 2, v0
    v_mul_u32_u24 v2, 224, v2
    v_and_b32 v3, 3, v0
    v_lshl_add_u32 v119, v3, 3, v2
    v_add_u32 v117, 114688, v119
    v_add_u32 v120, s47, v116
    v_add_u32 v121, s48, v116
    s_bitcmp1_b32 s41, 0
    s_cselect_b32 s49, 0, 0
    s_mov_b32 s50, 2048
    s_mov_b32 s59, 2048
    s_waitcnt lgkmcnt(0)
    v_lshlrev_b32 v3, 2, v0
    s_and_b32 s54, s40, 1
    s_lshl_b32 s54, s54, 1
    s_lshl_b32 s54, 0x33333333, s54
    s_bitcmp1_b32 s40, 1
    s_cselect_b32 exec_lo, 0, s54
    s_cselect_b32 exec_hi, s54, 0
    s_and_b32 s54, s45, 0xffffff00
    s_mov_b32 s91, 0
    buffer_load_dword v239, v3, s[12:15], s54 offen sc1
GL_28:
    buffer_load_dword v238, v3, s[12:15], s54 offen sc1
    s_waitcnt vmcnt(1)
    v_cmp_le_u32 vcc, 2, v239
    s_add_u32 s91, s91, 1
    s_cmp_eq_u64 vcc, exec
    s_cbranch_scc1 GO_27
    buffer_load_dword v239, v3, s[12:15], s54 offen sc1
    s_waitcnt vmcnt(1)
    v_cmp_le_u32 vcc, 2, v238
    s_cmp_ge_u32 s91, 80000
    s_cbranch_scc1 GO_27
    s_cmp_lg_u64 vcc, exec
    s_cbranch_scc1 GL_28
GO_27:
    s_mov_b64 exec, -1
    buffer_load_dwordx4 v[132:135], v120, s[12:15], s49 offen sc1
    buffer_load_dwordx4 v[136:139], v121, s[12:15], s49 offen sc1
    buffer_load_dword v124, v1, s[12:15], s51 offen offset:0 sc1
    buffer_load_dword v125, v1, s[12:15], s51 offen offset:64 sc1
    buffer_load_dword v126, v1, s[12:15], s51 offen offset:128 sc1
    buffer_load_dword v127, v1, s[12:15], s51 offen offset:192 sc1
    buffer_load_dword v128, v1, s[12:15], s51 offen offset:1024 sc1
    buffer_load_dword v129, v1, s[12:15], s51 offen offset:1088 sc1
    buffer_load_dword v130, v1, s[12:15], s51 offen offset:1152 sc1
    buffer_load_dword v131, v1, s[12:15], s51 offen offset:1216 sc1
    buffer_load_dwordx4 v[140:143], v120, s[12:15], s49 offen offset:1024 sc1
    buffer_load_dwordx4 v[144:147], v121, s[12:15], s49 offen offset:1024 sc1
    s_add_u32 s49, s49, s50
    buffer_load_dwordx4 v[148:151], v120, s[12:15], s49 offen sc1
    buffer_load_dwordx4 v[152:155], v121, s[12:15], s49 offen sc1
    buffer_load_dwordx4 v[156:159], v120, s[12:15], s49 offen offset:1024 sc1
    buffer_load_dwordx4 v[160:163], v121, s[12:15], s49 offen offset:1024 sc1
    s_add_u32 s49, s49, s59
    buffer_load_dwordx4 v[164:167], v120, s[12:15], s49 offen sc1
    buffer_load_dwordx4 v[168:171], v121, s[12:15], s49 offen sc1
    buffer_load_dwordx4 v[172:175], v120, s[12:15], s49 offen offset:1024 sc1
    buffer_load_dwordx4 v[176:179], v121, s[12:15], s49 offen offset:1024 sc1
    s_add_u32 s49, s49, s50
    buffer_load_dwordx4 v[180:183], v120, s[12:15], s49 offen sc1
    buffer_load_dwordx4 v[184:187], v121, s[12:15], s49 offen sc1
    buffer_load_dwordx4 v[188:191], v120, s[12:15], s49 offen offset:1024 sc1
    buffer_load_dwordx4 v[192:195], v121, s[12:15], s49 offen offset:1024 sc1
    s_add_u32 s49, s49, s59
    v_add_u32 v251, 1, v251
    ds_write_b32 v250, v251
    s_mov_b32 s91, 0
SP_30:
    ds_read_b64 v[252:253], v254 offset:1024
    s_add_u32 s91, s91, 1
    s_waitcnt lgkmcnt(0)
    v_min_u32 v252, v252, v253
    s_nop 0
    v_readfirstlane_b32 s92, v252
    s_cmp_ge_u32 s91, 400000
    s_cbranch_scc1 OK_29
    s_cmp_lt_u32 s92, 22
    s_cbranch_scc1 SP_30
OK_29:
    ds_read_b64_tr_b16 v[196:197], v117 offset:0
    ds_read_b64_tr_b16 v[198:199], v117 offset:3584
    ds_read_b64_tr_b16 v[200:201], v117 offset:32
    ds_read_b64_tr_b16 v[202:203], v117 offset:3616
    ds_read_b64_tr_b16 v[204:205], v117 offset:64
    ds_read_b64_tr_b16 v[206:207], v117 offset:3648
    ds_read_b64_tr_b16 v[208:209], v117 offset:96
    ds_read_b64_tr_b16 v[210:211], v117 offset:3680
    ds_read_b64_tr_b16 v[212:213], v117 offset:128
    ds_read_b64_tr_b16 v[214:215], v117 offset:3712
    ds_read_b64_tr_b16 v[216:217], v117 offset:160
    ds_read_b64_tr_b16 v[218:219], v117 offset:3744
    v_add_u32 v118, 0, v119
    s_waitcnt vmcnt(22) lgkmcnt(10)
    v_mfma_f32_16x16x32_bf16 v[4:7], v[196:199], v[132:135], 0
    ds_read_b64_tr_b16 v[220:221], v117 offset:192
    v_mfma_f32_16x16x32_bf16 v[60:63], v[196:199], v[136:139], 0
    ds_read_b64_tr_b16 v[222:223], v117 offset:3776
    s_waitcnt lgkmcnt(10)
    v_mfma_f32_16x16x32_bf16 v[8:11], v[200:203], v[132:135], 0
    ds_read_b64_tr_b16 v[196:197], v117 offset:7168
    v_mfma_f32_16x16x32_bf16 v[64:67], v[200:203], v[136:139], 0
    ds_read_b64_tr_b16 v[198:199], v117 offset:10752
    s_waitcnt lgkmcnt(10)
    v_mfma_f32_16x16x32_bf16 v[12:15], v[204:207], v[132:135], 0
    ds_read_b64_tr_b16 v[200:201], v117 offset:7200
    v_mfma_f32_16x16x32_bf16 v[68:71], v[204:207], v[136:139], 0
    ds_read_b64_tr_b16 v[202:203], v117 offset:10784
    s_waitcnt lgkmcnt(10)
    v_mfma_f32_16x16x32_bf16 v[16:19], v[208:211], v[132:135], 0
    ds_read_b64_tr_b16 v[204:205], v117 offset:7232
    v_mfma_f32_16x16x32_bf16 v[72:75], v[208:211], v[136:139], 0
    ds_read_b64_tr_b16 v[206:207], v117 offset:10816
    s_waitcnt lgkmcnt(10)
    v_mfma_f32_16x16x32_bf16 v[20:23], v[212:215], v[132:135], 0
    ds_read_b64_tr_b16 v[208:209], v117 offset:7264
    v_mfma_f32_16x16x32_bf16 v[76:79], v[212:215], v[136:139], 0
    ds_read_b64_tr_b16 v[210:211], v117 offset:10848
    s_waitcnt lgkmcnt(10)
    v_mfma_f32_16x16x32_bf16 v[24:27], v[216:219], v[132:135], 0
    ds_read_b64_tr_b16 v[212:213], v117 offset:7296
    v_mfma_f32_16x16x32_bf16 v[80:83], v[216:219], v[136:139], 0
    ds_read_b64_tr_b16 v[214:215], v117 offset:10880
    s_waitcnt lgkmcnt(10)
    v_mfma_f32_16x16x32_bf16 v[28:31], v[220:223], v[132:135], 0
    ds_read_b64_tr_b16 v[216:217], v117 offset:7328
    v_mfma_f32_16x16x32_bf16 v[84:87], v[220:223], v[136:139], 0
    ds_read_b64_tr_b16 v[218:219], v117 offset:10912
    s_waitcnt lgkmcnt(10)
    v_mfma_f32_16x16x32_bf16 v[32:35], v[196:199], v[132:135], 0
    ds_read_b64_tr_b16 v[220:221], v117 offset:7360
    v_mfma_f32_16x16x32_bf16 v[88:91], v[196:199], v[136:139], 0
    ds_read_b64_tr_b16 v[222:223], v117 offset:10944
    s_waitcnt lgkmcnt(10)
    v_mfma_f32_16x16x32_bf16 v[36:39], v[200:203], v[132:135], 0
    ds_read_b64_tr_b16 v[196:197], v117 offset:14336
    v_mfma_f32_16x16x32_bf16 v[92:95], v[200:203], v[136:139], 0
    ds_read_b64_tr_b16 v[198:199], v117 offset:17920
    s_waitcnt lgkmcnt(10)
    v_mfma_f32_16x16x32_bf16 v[40:43], v[204:207], v[132:135], 0
    ds_read_b64_tr_b16 v[200:201], v117 offset:14368
    v_mfma_f32_16x16x32_bf16 v[96:99], v[204:207], v[136:139], 0
    ds_read_b64_tr_b16 v[202:203], v117 offset:17952
    s_waitcnt lgkmcnt(10)
    v_mfma_f32_16x16x32_bf16 v[44:47], v[208:211], v[132:135], 0
    ds_read_b64_tr_b16 v[204:205], v117 offset:14400
    v_mfma_f32_16x16x32_bf16 v[100:103], v[208:211], v[136:139], 0
    ds_read_b64_tr_b16 v[206:207], v117 offset:17984
    s_waitcnt lgkmcnt(10)
    v_mfma_f32_16x16x32_bf16 v[48:51], v[212:215], v[132:135], 0
    ds_read_b64 v[252:253], v254 offset:1024
    ds_read_b64_tr_b16 v[208:209], v117 offset:14432
    v_mfma_f32_16x16x32_bf16 v[104:107], v[212:215], v[136:139], 0
    ds_read_b64_tr_b16 v[210:211], v117 offset:18016
    s_waitcnt lgkmcnt(11)
    v_mfma_f32_16x16x32_bf16 v[52:55], v[216:219], v[132:135], 0
    ds_read_b64_tr_b16 v[212:213], v117 offset:14464
    v_mfma_f32_16x16x32_bf16 v[108:111], v[216:219], v[136:139], 0
    ds_read_b64_tr_b16 v[214:215], v117 offset:18048
    s_waitcnt lgkmcnt(11)
    v_mfma_f32_16x16x32_bf16 v[56:59], v[220:223], v[132:135], 0
    ds_read_b64_tr_b16 v[216:217], v117 offset:14496
    v_mfma_f32_16x16x32_bf16 v[112:115], v[220:223], v[136:139], 0
    ds_read_b64_tr_b16 v[218:219], v117 offset:18080
    s_waitcnt vmcnt(12) lgkmcnt(11)
    v_mfma_f32_16x16x32_bf16 v[4:7], v[196:199], v[140:143], v[4:7]
    ds_read_b64_tr_b16 v[220:221], v117 offset:14528
    v_mfma_f32_16x16x32_bf16 v[60:63], v[196:199], v[144:147], v[60:63]
    ds_read_b64_tr_b16 v[222:223], v117 offset:18112
    s_waitcnt lgkmcnt(11)
    v_mfma_f32_16x16x32_bf16 v[8:11], v[200:203], v[140:143], v[8:11]
    ds_read_b64_tr_b16 v[196:197], v117 offset:21504
    v_mfma_f32_16x16x32_bf16 v[64:67], v[200:203], v[144:147], v[64:67]
    ds_read_b64_tr_b16 v[198:199], v117 offset:25088
    s_waitcnt lgkmcnt(11)
    v_mfma_f32_16x16x32_bf16 v[12:15], v[204:207], v[140:143], v[12:15]
    ds_read_b64_tr_b16 v[200:201], v117 offset:21536
    v_mfma_f32_16x16x32_bf16 v[68:71], v[204:207], v[144:147], v[68:71]
    ds_read_b64_tr_b16 v[202:203], v117 offset:25120
    buffer_load_dwordx4 v[132:135], v120, s[12:15], s49 offen sc1
    s_waitcnt lgkmcnt(10)
    v_mfma_f32_16x16x32_bf16 v[16:19], v[208:211], v[140:143], v[16:19]
    ds_read_b64_tr_b16 v[204:205], v117 offset:21568
    v_mfma_f32_16x16x32_bf16 v[72:75], v[208:211], v[144:147], v[72:75]
    ds_read_b64_tr_b16 v[206:207], v117 offset:25152
    s_waitcnt lgkmcnt(10)
    v_mfma_f32_16x16x32_bf16 v[20:23], v[212:215], v[140:143], v[20:23]
    ds_read_b64_tr_b16 v[208:209], v117 offset:21600
    v_mfma_f32_16x16x32_bf16 v[76:79], v[212:215], v[144:147], v[76:79]
    ds_read_b64_tr_b16 v[210:211], v117 offset:25184
    s_waitcnt lgkmcnt(10)
    v_mfma_f32_16x16x32_bf16 v[24:27], v[216:219], v[140:143], v[24:27]
    v_min_u32 v252, v252, v253
    ds_read_b64_tr_b16 v[212:213], v117 offset:21632
    v_mfma_f32_16x16x32_bf16 v[80:83], v[216:219], v[144:147], v[80:83]
    ds_read_b64_tr_b16 v[214:215], v117 offset:25216
    s_waitcnt lgkmcnt(10)
    v_mfma_f32_16x16x32_bf16 v[28:31], v[220:223], v[140:143], v[28:31]
    v_readfirstlane_b32 s92, v252
    ds_read_b64_tr_b16 v[216:217], v117 offset:21664
    v_mfma_f32_16x16x32_bf16 v[84:87], v[220:223], v[144:147], v[84:87]
    ds_read_b64_tr_b16 v[218:219], v117 offset:25248
    buffer_load_dwordx4 v[136:139], v121, s[12:15], s49 offen sc1
    s_waitcnt lgkmcnt(10)
    v_mfma_f32_16x16x32_bf16 v[32:35], v[196:199], v[140:143], v[32:35]
    s_cmp_lt_u32 s92, 23
    s_cbranch_scc1 SP_32s
OK_31:
    ds_read_b64_tr_b16 v[220:221], v117 offset:21696
    v_mfma_f32_16x16x32_bf16 v[88:91], v[196:199], v[144:147], v[88:91]
    ds_read_b64_tr_b16 v[222:223], v117 offset:25280
    s_waitcnt lgkmcnt(10)
    v_mfma_f32_16x16x32_bf16 v[36:39], v[200:203], v[140:143], v[36:39]
    v_add_u32 v251, 1, v251
    ds_write_b32 v250, v251
    ds_read_b64_tr_b16 v[196:197], v118 offset:0
    v_mfma_f32_16x16x32_bf16 v[92:95], v[200:203], v[144:147], v[92:95]
    ds_read_b64_tr_b16 v[198:199], v118 offset:3584
    s_waitcnt lgkmcnt(11)
    v_mfma_f32_16x16x32_bf16 v[40:43], v[204:207], v[140:143], v[40:43]
    ds_read_b64_tr_b16 v[200:201], v118 offset:32
    v_mfma_f32_16x16x32_bf16 v[96:99], v[204:207], v[144:147], v[96:99]
    ds_read_b64_tr_b16 v[202:203], v118 offset:3616
    s_waitcnt lgkmcnt(11)
    v_mfma_f32_16x16x32_bf16 v[44:47], v[208:211], v[140:143], v[44:47]
    ds_read_b64_tr_b16 v[204:205], v118 offset:64
    v_mfma_f32_16x16x32_bf16 v[100:103], v[208:211], v[144:147], v[100:103]
    ds_read_b64_tr_b16 v[206:207], v118 offset:3648
    s_waitcnt lgkmcnt(11)
    v_mfma_f32_16x16x32_bf16 v[48:51], v[212:215], v[140:143], v[48:51]
    ds_read_b64_tr_b16 v[208:209], v118 offset:96
    v_mfma_f32_16x16x32_bf16 v[104:107], v[212:215], v[144:147], v[104:107]
    ds_read_b64_tr_b16 v[210:211], v118 offset:3680
    s_waitcnt lgkmcnt(11)
    v_mfma_f32_16x16x32_bf16 v[52:55], v[216:219], v[140:143], v[52:55]
    ds_read_b64_tr_b16 v[212:213], v118 offset:128
    v_mfma_f32_16x16x32_bf16 v[108:111], v[216:219], v[144:147], v[108:111]
    ds_read_b64_tr_b16 v[214:215], v118 offset:3712
    s_waitcnt lgkmcnt(11)
    v_mfma_f32_16x16x32_bf16 v[56:59], v[220:223], v[140:143], v[56:59]
    ds_read_b64_tr_b16 v[216:217], v118 offset:160
    v_mfma_f32_16x16x32_bf16 v[112:115], v[220:223], v[144:147], v[112:115]
    ds_read_b64_tr_b16 v[218:219], v118 offset:3744
    v_add_u32 v117, 28672, v119
    s_waitcnt vmcnt(12) lgkmcnt(10)
    v_mfma_f32_16x16x32_bf16 v[4:7], v[196:199], v[148:151], v[4:7]
    ds_read_b64_tr_b16 v[220:221], v118 offset:192
    v_mfma_f32_16x16x32_bf16 v[60:63], v[196:199], v[152:155], v[60:63]
    ds_read_b64_tr_b16 v[222:223], v118 offset:3776
    v_add_f32 v124, v124, v126
    s_waitcnt lgkmcnt(10)
    v_mfma_f32_16x16x32_bf16 v[8:11], v[200:203], v[148:151], v[8:11]
    ds_read_b64_tr_b16 v[196:197], v118 offset:7168
    v_mfma_f32_16x16x32_bf16 v[64:67], v[200:203], v[152:155], v[64:67]
    ds_read_b64_tr_b16 v[198:199], v118 offset:10752
    v_add_f32 v125, v125, v127
    s_waitcnt lgkmcnt(10)
    v_mfma_f32_16x16x32_bf16 v[12:15], v[204:207], v[148:151], v[12:15]
    ds_read_b64_tr_b16 v[200:201], v118 offset:7200
    v_mfma_f32_16x16x32_bf16 v[68:71], v[204:207], v[152:155], v[68:71]
    ds_read_b64_tr_b16 v[202:203], v118 offset:10784
    buffer_load_dwordx4 v[140:143], v120, s[12:15], s49 offen offset:1024 sc1
    s_waitcnt lgkmcnt(10)
    v_mfma_f32_16x16x32_bf16 v[16:19], v[208:211], v[148:151], v[16:19]
    ds_read_b64_tr_b16 v[204:205], v118 offset:7232
    v_mfma_f32_16x16x32_bf16 v[72:75], v[208:211], v[152:155], v[72:75]
    ds_read_b64_tr_b16 v[206:207], v118 offset:10816
    v_permlane32_swap_b32 v124, v125
    s_waitcnt lgkmcnt(10)
    v_mfma_f32_16x16x32_bf16 v[20:23], v[212:215], v[148:151], v[20:23]
    ds_read_b64_tr_b16 v[208:209], v118 offset:7264
    v_mfma_f32_16x16x32_bf16 v[76:79], v[212:215], v[152:155], v[76:79]
    ds_read_b64_tr_b16 v[210:211], v118 offset:10848
    v_add_f32 v124, v124, v125
    s_waitcnt lgkmcnt(10)
    v_mfma_f32_16x16x32_bf16 v[24:27], v[216:219], v[148:151], v[24:27]
    ds_read_b64_tr_b16 v[212:213], v118 offset:7296
    v_mfma_f32_16x16x32_bf16 v[80:83], v[216:219], v[152:155], v[80:83]
    ds_read_b64_tr_b16 v[214:215], v118 offset:10880
    v_mov_b32 v125, v124
    s_waitcnt lgkmcnt(10)
    v_mfma_f32_16x16x32_bf16 v[28:31], v[220:223], v[148:151], v[28:31]
    ds_read_b64_tr_b16 v[216:217], v118 offset:7328
    v_mfma_f32_16x16x32_bf16 v[84:87], v[220:223], v[152:155], v[84:87]
    ds_read_b64_tr_b16 v[218:219], v118 offset:10912
    buffer_load_dwordx4 v[144:147], v121, s[12:15], s49 offen offset:1024 sc1
    s_add_u32 s49, s49, s50
    s_waitcnt lgkmcnt(10)
    v_mfma_f32_16x16x32_bf16 v[32:35], v[196:199], v[148:151], v[32:35]
    ds_read_b64_tr_b16 v[220:221], v118 offset:7360
    v_mfma_f32_16x16x32_bf16 v[88:91], v[196:199], v[152:155], v[88:91]
    ds_read_b64_tr_b16 v[222:223], v118 offset:10944
    v_permlane16_swap_b32 v124, v125
    s_waitcnt lgkmcnt(10)
    v_mfma_f32_16x16x32_bf16 v[36:39], v[200:203], v[148:151], v[36:39]
    ds_read_b64_tr_b16 v[196:197], v118 offset:14336
    v_mfma_f32_16x16x32_bf16 v[92:95], v[200:203], v[152:155], v[92:95]
    ds_read_b64_tr_b16 v[198:199], v118 offset:17920
    s_waitcnt lgkmcnt(10)
    v_mfma_f32_16x16x32_bf16 v[40:43], v[204:207], v[148:151], v[40:43]
    ds_read_b64_tr_b16 v[200:201], v118 offset:14368
    v_mfma_f32_16x16x32_bf16 v[96:99], v[204:207], v[152:155], v[96:99]
    ds_read_b64_tr_b16 v[202:203], v118 offset:17952
    s_waitcnt lgkmcnt(10)
    v_mfma_f32_16x16x32_bf16 v[44:47], v[208:211], v[148:151], v[44:47]
    ds_read_b64_tr_b16 v[204:205], v118 offset:14400
    v_mfma_f32_16x16x32_bf16 v[100:103], v[208:211], v[152:155], v[100:103]
    ds_read_b64_tr_b16 v[206:207], v118 offset:17984
    s_waitcnt lgkmcnt(10)
    v_mfma_f32_16x16x32_bf16 v[48:51], v[212:215], v[148:151], v[48:51]
    ds_read_b64 v[252:253], v254 offset:1024
    ds_read_b64_tr_b16 v[208:209], v118 offset:14432
    v_mfma_f32_16x16x32_bf16 v[104:107], v[212:215], v[152:155], v[104:107]
    ds_read_b64_tr_b16 v[210:211], v118 offset:18016
    v_add_f32 v124, v124, v125
    s_waitcnt lgkmcnt(11)
    v_mfma_f32_16x16x32_bf16 v[52:55], v[216:219], v[148:151], v[52:55]
    ds_read_b64_tr_b16 v[212:213], v118 offset:14464
    v_mfma_f32_16x16x32_bf16 v[108:111], v[216:219], v[152:155], v[108:111]
    ds_read_b64_tr_b16 v[214:215], v118 offset:18048
    v_mov_b32 v125, v124
    s_waitcnt lgkmcnt(11)
    v_mfma_f32_16x16x32_bf16 v[56:59], v[220:223], v[148:151], v[56:59]
    ds_read_b64_tr_b16 v[216:217], v118 offset:14496
    v_mfma_f32_16x16x32_bf16 v[112:115], v[220:223], v[152:155], v[112:115]
    ds_read_b64_tr_b16 v[218:219], v118 offset:18080
    v_permlane32_swap_b32 v124, v125
    s_waitcnt vmcnt(12) lgkmcnt(11)
    v_mfma_f32_16x16x32_bf16 v[4:7], v[196:199], v[156:159], v[4:7]
    ds_read_b64_tr_b16 v[220:221], v118 offset:14528
    v_mfma_f32_16x16x32_bf16 v[60:63], v[196:199], v[160:163], v[60:63]
    ds_read_b64_tr_b16 v[222:223], v118 offset:18112
    v_mul_f32 v124, s55, v124
    s_waitcnt lgkmcnt(11)
    v_mfma_f32_16x16x32_bf16 v[8:11], v[200:203], v[156:159], v[8:11]
    ds_read_b64_tr_b16 v[196:197], v118 offset:21504
    v_mfma_f32_16x16x32_bf16 v[64:67], v[200:203], v[160:163], v[64:67]
    ds_read_b64_tr_b16 v[198:199], v118 offset:25088
    v_mul_f32 v125, s56, v125
    s_waitcnt lgkmcnt(11)
    v_mfma_f32_16x16x32_bf16 v[12:15], v[204:207], v[156:159], v[12:15]
    ds_read_b64_tr_b16 v[200:201], v118 offset:21536
    v_mfma_f32_16x16x32_bf16 v[68:71], v[204:207], v[160:163], v[68:71]
    ds_read_b64_tr_b16 v[202:203], v118 offset:25120
    buffer_load_dwordx4 v[148:151], v120, s[12:15], s49 offen sc1
    s_waitcnt lgkmcnt(10)
    v_mfma_f32_16x16x32_bf16 v[16:19], v[208:211], v[156:159], v[16:19]
    ds_read_b64_tr_b16 v[204:205], v118 offset:21568
    v_mfma_f32_16x16x32_bf16 v[72:75], v[208:211], v[160:163], v[72:75]
    ds_read_b64_tr_b16 v[206:207], v118 offset:25152
    v_fma_f32 v125, -v124, v124, v125
    s_waitcnt lgkmcnt(10)
    v_mfma_f32_16x16x32_bf16 v[20:23], v[212:215], v[156:159], v[20:23]
    ds_read_b64_tr_b16 v[208:209], v118 offset:21600
    v_mfma_f32_16x16x32_bf16 v[76:79], v[212:215], v[160:163], v[76:79]
    ds_read_b64_tr_b16 v[210:211], v118 offset:25184
    v_max_f32 v125, 0, v125
    s_waitcnt lgkmcnt(10)
    v_mfma_f32_16x16x32_bf16 v[24:27], v[216:219], v[156:159], v[24:27]
    v_min_u32 v252, v252, v253
    ds_read_b64_tr_b16 v[212:213], v118 offset:21632
    v_mfma_f32_16x16x32_bf16 v[80:83], v[216:219], v[160:163], v[80:83]
    ds_read_b64_tr_b16 v[214:215], v118 offset:25216
    v_add_f32 v126, s57, v125
    s_waitcnt lgkmcnt(10)
    v_mfma_f32_16x16x32_bf16 v[28:31], v[220:223], v[156:159], v[28:31]
    v_readfirstlane_b32 s92, v252
    ds_read_b64_tr_b16 v[216:217], v118 offset:21664
    v_mfma_f32_16x16x32_bf16 v[84:87], v[220:223], v[160:163], v[84:87]
    ds_read_b64_tr_b16 v[218:219], v118 offset:25248
    buffer_load_dwordx4 v[152:155], v121, s[12:15], s49 offen sc1
    s_waitcnt lgkmcnt(10)
    v_mfma_f32_16x16x32_bf16 v[32:35], v[196:199], v[156:159], v[32:35]
    s_cmp_lt_u32 s92, 24
    s_cbranch_scc1 SP_34s
OK_33:
    ds_read_b64_tr_b16 v[220:221], v118 offset:21696
    v_mfma_f32_16x16x32_bf16 v[88:91], v[196:199], v[160:163], v[88:91]
    ds_read_b64_tr_b16 v[222:223], v118 offset:25280
    v_rsq_f32 v125, v126
    s_waitcnt lgkmcnt(10)
    v_mfma_f32_16x16x32_bf16 v[36:39], v[200:203], v[156:159], v[36:39]
    v_add_u32 v251, 1, v251
    ds_write_b32 v250, v251
    ds_read_b64_tr_b16 v[196:197], v117 offset:0
    v_mfma_f32_16x16x32_bf16 v[92:95], v[200:203], v[160:163], v[92:95]
    ds_read_b64_tr_b16 v[198:199], v117 offset:3584
    s_waitcnt lgkmcnt(11)
    v_mfma_f32_16x16x32_bf16 v[40:43], v[204:207], v[156:159], v[40:43]
    ds_read_b64_tr_b16 v[200:201], v117 offset:32
    v_mfma_f32_16x16x32_bf16 v[96:99], v[204:207], v[160:163], v[96:99]
    ds_read_b64_tr_b16 v[202:203], v117 offset:3616
    s_waitcnt lgkmcnt(11)
    v_mfma_f32_16x16x32_bf16 v[44:47], v[208:211], v[156:159], v[44:47]
    ds_read_b64_tr_b16 v[204:205], v117 offset:64
    v_mfma_f32_16x16x32_bf16 v[100:103], v[208:211], v[160:163], v[100:103]
    ds_read_b64_tr_b16 v[206:207], v117 offset:3648
    s_waitcnt lgkmcnt(11)
    v_mfma_f32_16x16x32_bf16 v[48:51], v[212:215], v[156:159], v[48:51]
    ds_read_b64_tr_b16 v[208:209], v117 offset:96
    v_mfma_f32_16x16x32_bf16 v[104:107], v[212:215], v[160:163], v[104:107]
    ds_read_b64_tr_b16 v[210:211], v117 offset:3680
    v_mul_f32 v125, s58, v125
    s_waitcnt lgkmcnt(11)
    v_mfma_f32_16x16x32_bf16 v[52:55], v[216:219], v[156:159], v[52:55]
    ds_read_b64_tr_b16 v[212:213], v117 offset:128
    v_mfma_f32_16x16x32_bf16 v[108:111], v[216:219], v[160:163], v[108:111]
    ds_read_b64_tr_b16 v[214:215], v117 offset:3712
    v_add_f32 v128, v128, v130
    s_waitcnt lgkmcnt(11)
    v_mfma_f32_16x16x32_bf16 v[56:59], v[220:223], v[156:159], v[56:59]
    ds_read_b64_tr_b16 v[216:217], v117 offset:160
    v_mfma_f32_16x16x32_bf16 v[112:115], v[220:223], v[160:163], v[112:115]
    ds_read_b64_tr_b16 v[218:219], v117 offset:3744
    v_add_f32 v129, v129, v131
    v_add_u32 v118, 57344, v119
    s_waitcnt vmcnt(12) lgkmcnt(10)
    v_mfma_f32_16x16x32_bf16 v[4:7], v[196:199], v[164:167], v[4:7]
    ds_read_b64_tr_b16 v[220:221], v117 offset:192
    v_mfma_f32_16x16x32_bf16 v[60:63], v[196:199], v[168:171], v[60:63]
    ds_read_b64_tr_b16 v[222:223], v117 offset:3776
    v_permlane32_swap_b32 v128, v129
    s_waitcnt lgkmcnt(10)
    v_mfma_f32_16x16x32_bf16 v[8:11], v[200:203], v[164:167], v[8:11]
    ds_read_b64_tr_b16 v[196:197], v117 offset:7168
    v_mfma_f32_16x16x32_bf16 v[64:67], v[200:203], v[168:171], v[64:67]
    ds_read_b64_tr_b16 v[198:199], v117 offset:10752
    v_add_f32 v128, v128, v129
    s_waitcnt lgkmcnt(10)
    v_mfma_f32_16x16x32_bf16 v[12:15], v[204:207], v[164:167], v[12:15]
    ds_read_b64_tr_b16 v[200:201], v117 offset:7200
    v_mfma_f32_16x16x32_bf16 v[68:71], v[204:207], v[168:171], v[68:71]
    ds_read_b64_tr_b16 v[202:203], v117 offset:10784
    buffer_load_dwordx4 v[156:159], v120, s[12:15], s49 offen offset:1024 sc1
    s_waitcnt lgkmcnt(10)
    v_mfma_f32_16x16x32_bf16 v[16:19], v[208:211], v[164:167], v[16:19]
    ds_read_b64_tr_b16 v[204:205], v117 offset:7232
    v_mfma_f32_16x16x32_bf16 v[72:75], v[208:211], v[168:171], v[72:75]
    ds_read_b64_tr_b16 v[206:207], v117 offset:10816
    v_mov_b32 v129, v128
    s_waitcnt lgkmcnt(10)
    v_mfma_f32_16x16x32_bf16 v[20:23], v[212:215], v[164:167], v[20:23]
    ds_read_b64_tr_b16 v[208:209], v117 offset:7264
    v_mfma_f32_16x16x32_bf16 v[76:79], v[212:215], v[168:171], v[76:79]
    ds_read_b64_tr_b16 v[210:211], v117 offset:10848
    v_permlane16_swap_b32 v128, v129
    s_waitcnt lgkmcnt(10)
    v_mfma_f32_16x16x32_bf16 v[24:27], v[216:219], v[164:167], v[24:27]
    ds_read_b64_tr_b16 v[212:213], v117 offset:7296
    v_mfma_f32_16x16x32_bf16 v[80:83], v[216:219], v[168:171], v[80:83]
    ds_read_b64_tr_b16 v[214:215], v117 offset:10880
    v_add_f32 v128, v128, v129
    s_waitcnt lgkmcnt(10)
    v_mfma_f32_16x16x32_bf16 v[28:31], v[220:223], v[164:167], v[28:31]
    ds_read_b64_tr_b16 v[216:217], v117 offset:7328
    v_mfma_f32_16x16x32_bf16 v[84:87], v[220:223], v[168:171], v[84:87]
    ds_read_b64_tr_b16 v[218:219], v117 offset:10912
    buffer_load_dwordx4 v[160:163], v121, s[12:15], s49 offen offset:1024 sc1
    s_add_u32 s49, s49, s59
    s_waitcnt lgkmcnt(10)
    v_mfma_f32_16x16x32_bf16 v[32:35], v[196:199], v[164:167], v[32:35]
    ds_read_b64_tr_b16 v[220:221], v117 offset:7360
    v_mfma_f32_16x16x32_bf16 v[88:91], v[196:199], v[168:171], v[88:91]
    ds_read_b64_tr_b16 v[222:223], v117 offset:10944
    v_mov_b32 v129, v128
    s_waitcnt lgkmcnt(10)
    v_mfma_f32_16x16x32_bf16 v[36:39], v[200:203], v[164:167], v[36:39]
    ds_read_b64_tr_b16 v[196:197], v117 offset:14336
    v_mfma_f32_16x16x32_bf16 v[92:95], v[200:203], v[168:171], v[92:95]
    ds_read_b64_tr_b16 v[198:199], v117 offset:17920
    s_waitcnt lgkmcnt(10)
    v_mfma_f32_16x16x32_bf16 v[40:43], v[204:207], v[164:167], v[40:43]
    ds_read_b64_tr_b16 v[200:201], v117 offset:14368
    v_mfma_f32_16x16x32_bf16 v[96:99], v[204:207], v[168:171], v[96:99]
    ds_read_b64_tr_b16 v[202:203], v117 offset:17952
    s_waitcnt lgkmcnt(10)
    v_mfma_f32_16x16x32_bf16 v[44:47], v[208:211], v[164:167], v[44:47]
    ds_read_b64_tr_b16 v[204:205], v117 offset:14400
    v_mfma_f32_16x16x32_bf16 v[100:103], v[208:211], v[168:171], v[100:103]
    ds_read_b64_tr_b16 v[206:207], v117 offset:17984
    s_waitcnt lgkmcnt(10)
    v_mfma_f32_16x16x32_bf16 v[48:51], v[212:215], v[164:167], v[48:51]
    ds_read_b64 v[252:253], v254 offset:1024
    ds_read_b64_tr_b16 v[208:209], v117 offset:14432
    v_mfma_f32_16x16x32_bf16 v[104:107], v[212:215], v[168:171], v[104:107]
    ds_read_b64_tr_b16 v[210:211], v117 offset:18016
    v_permlane32_swap_b32 v128, v129
    s_waitcnt lgkmcnt(11)
    v_mfma_f32_16x16x32_bf16 v[52:55], v[216:219], v[164:167], v[52:55]
    ds_read_b64_tr_b16 v[212:213], v117 offset:14464
    v_mfma_f32_16x16x32_bf16 v[108:111], v[216:219], v[168:171], v[108:111]
    ds_read_b64_tr_b16 v[214:215], v117 offset:18048
    v_mul_f32 v128, s55, v128
    s_waitcnt lgkmcnt(11)
    v_mfma_f32_16x16x32_bf16 v[56:59], v[220:223], v[164:167], v[56:59]
    ds_read_b64_tr_b16 v[216:217], v117 offset:14496
    v_mfma_f32_16x16x32_bf16 v[112:115], v[220:223], v[168:171], v[112:115]
    ds_read_b64_tr_b16 v[218:219], v117 offset:18080
    v_mul_f32 v129, s56, v129
    s_waitcnt vmcnt(12) lgkmcnt(11)
    v_mfma_f32_16x16x32_bf16 v[4:7], v[196:199], v[172:175], v[4:7]
    ds_read_b64_tr_b16 v[220:221], v117 offset:14528
    v_mfma_f32_16x16x32_bf16 v[60:63], v[196:199], v[176:179], v[60:63]
    ds_read_b64_tr_b16 v[222:223], v117 offset:18112
    v_fma_f32 v129, -v128, v128, v129
    s_waitcnt lgkmcnt(11)
    v_mfma_f32_16x16x32_bf16 v[8:11], v[200:203], v[172:175], v[8:11]
    ds_read_b64_tr_b16 v[196:197], v117 offset:21504
    v_mfma_f32_16x16x32_bf16 v[64:67], v[200:203], v[176:179], v[64:67]
    ds_read_b64_tr_b16 v[198:199], v117 offset:25088
    v_max_f32 v129, 0, v129
    s_waitcnt lgkmcnt(11)
    v_mfma_f32_16x16x32_bf16 v[12:15], v[204:207], v[172:175], v[12:15]
    ds_read_b64_tr_b16 v[200:201], v117 offset:21536
    v_mfma_f32_16x16x32_bf16 v[68:71], v[204:207], v[176:179], v[68:71]
    ds_read_b64_tr_b16 v[202:203], v117 offset:25120
    buffer_load_dwordx4 v[164:167], v120, s[12:15], s49 offen sc1
    s_waitcnt lgkmcnt(10)
    v_mfma_f32_16x16x32_bf16 v[16:19], v[208:211], v[172:175], v[16:19]
    ds_read_b64_tr_b16 v[204:205], v117 offset:21568
    v_mfma_f32_16x16x32_bf16 v[72:75], v[208:211], v[176:179], v[72:75]
    ds_read_b64_tr_b16 v[206:207], v117 offset:25152
    v_add_f32 v130, s57, v129
    s_waitcnt lgkmcnt(10)
    v_mfma_f32_16x16x32_bf16 v[20:23], v[212:215], v[172:175], v[20:23]
    ds_read_b64_tr_b16 v[208:209], v117 offset:21600
    v_mfma_f32_16x16x32_bf16 v[76:79], v[212:215], v[176:179], v[76:79]
    ds_read_b64_tr_b16 v[210:211], v117 offset:25184
    v_rsq_f32 v129, v130
    s_waitcnt lgkmcnt(10)
    v_mfma_f32_16x16x32_bf16 v[24:27], v[216:219], v[172:175], v[24:27]
    v_min_u32 v252, v252, v253
    ds_read_b64_tr_b16 v[212:213], v117 offset:21632
    v_mfma_f32_16x16x32_bf16 v[80:83], v[216:219], v[176:179], v[80:83]
    ds_read_b64_tr_b16 v[214:215], v117 offset:25216
    v_mul_f32 v129, s58, v129
    s_waitcnt lgkmcnt(10)
    v_mfma_f32_16x16x32_bf16 v[28:31], v[220:223], v[172:175], v[28:31]
    v_readfirstlane_b32 s92, v252
    ds_read_b64_tr_b16 v[216:217], v117 offset:21664
    v_mfma_f32_16x16x32_bf16 v[84:87], v[220:223], v[176:179], v[84:87]
    ds_read_b64_tr_b16 v[218:219], v117 offset:25248
    buffer_load_dwordx4 v[168:171], v121, s[12:15], s49 offen sc1
    s_waitcnt lgkmcnt(10)
    v_mfma_f32_16x16x32_bf16 v[32:35], v[196:199], v[172:175], v[32:35]
    s_cmp_lt_u32 s92, 25
    s_cbranch_scc1 SP_36s
OK_35:
    ds_read_b64_tr_b16 v[220:221], v117 offset:21696
    v_mfma_f32_16x16x32_bf16 v[88:91], v[196:199], v[176:179], v[88:91]
    ds_read_b64_tr_b16 v[222:223], v117 offset:25280
    s_waitcnt lgkmcnt(10)
    v_mfma_f32_16x16x32_bf16 v[36:39], v[200:203], v[172:175], v[36:39]
    v_add_u32 v251, 1, v251
    ds_write_b32 v250, v251
    ds_read_b64_tr_b16 v[196:197], v118 offset:0
    v_mfma_f32_16x16x32_bf16 v[92:95], v[200:203], v[176:179], v[92:95]
    ds_read_b64_tr_b16 v[198:199], v118 offset:3584
    s_waitcnt lgkmcnt(11)
    v_mfma_f32_16x16x32_bf16 v[40:43], v[204:207], v[172:175], v[40:43]
    ds_read_b64_tr_b16 v[200:201], v118 offset:32
    v_mfma_f32_16x16x32_bf16 v[96:99], v[204:207], v[176:179], v[96:99]
    ds_read_b64_tr_b16 v[202:203], v118 offset:3616
    s_waitcnt lgkmcnt(11)
    v_mfma_f32_16x16x32_bf16 v[44:47], v[208:211], v[172:175], v[44:47]
    ds_read_b64_tr_b16 v[204:205], v118 offset:64
    v_mfma_f32_16x16x32_bf16 v[100:103], v[208:211], v[176:179], v[100:103]
    ds_read_b64_tr_b16 v[206:207], v118 offset:3648
    s_waitcnt lgkmcnt(11)
    v_mfma_f32_16x16x32_bf16 v[48:51], v[212:215], v[172:175], v[48:51]
    ds_read_b64_tr_b16 v[208:209], v118 offset:96
    v_mfma_f32_16x16x32_bf16 v[104:107], v[212:215], v[176:179], v[104:107]
    ds_read_b64_tr_b16 v[210:211], v118 offset:3680
    s_waitcnt lgkmcnt(11)
    v_mfma_f32_16x16x32_bf16 v[52:55], v[216:219], v[172:175], v[52:55]
    ds_read_b64_tr_b16 v[212:213], v118 offset:128
    v_mfma_f32_16x16x32_bf16 v[108:111], v[216:219], v[176:179], v[108:111]
    ds_read_b64_tr_b16 v[214:215], v118 offset:3712
    s_waitcnt lgkmcnt(11)
    v_mfma_f32_16x16x32_bf16 v[56:59], v[220:223], v[172:175], v[56:59]
    ds_read_b64_tr_b16 v[216:217], v118 offset:160
    v_mfma_f32_16x16x32_bf16 v[112:115], v[220:223], v[176:179], v[112:115]
    ds_read_b64_tr_b16 v[218:219], v118 offset:3744
    v_add_u32 v117, 86016, v119
    s_waitcnt vmcnt(12) lgkmcnt(10)
    v_mfma_f32_16x16x32_bf16 v[4:7], v[196:199], v[180:183], v[4:7]
    ds_read_b64_tr_b16 v[220:221], v118 offset:192
    v_mfma_f32_16x16x32_bf16 v[60:63], v[196:199], v[184:187], v[60:63]
    ds_read_b64_tr_b16 v[222:223], v118 offset:3776
    s_waitcnt lgkmcnt(10)
    v_mfma_f32_16x16x32_bf16 v[8:11], v[200:203], v[180:183], v[8:11]
    ds_read_b64_tr_b16 v[196:197], v118 offset:7168
    v_mfma_f32_16x16x32_bf16 v[64:67], v[200:203], v[184:187], v[64:67]
    ds_read_b64_tr_b16 v[198:199], v118 offset:10752
    s_waitcnt lgkmcnt(10)
    v_mfma_f32_16x16x32_bf16 v[12:15], v[204:207], v[180:183], v[12:15]
    ds_read_b64_tr_b16 v[200:201], v118 offset:7200
    v_mfma_f32_16x16x32_bf16 v[68:71], v[204:207], v[184:187], v[68:71]
    ds_read_b64_tr_b16 v[202:203], v118 offset:10784
    buffer_load_dwordx4 v[172:175], v120, s[12:15], s49 offen offset:1024 sc1
    s_waitcnt lgkmcnt(10)
    v_mfma_f32_16x16x32_bf16 v[16:19], v[208:211], v[180:183], v[16:19]
    ds_read_b64_tr_b16 v[204:205], v118 offset:7232
    v_mfma_f32_16x16x32_bf16 v[72:75], v[208:211], v[184:187], v[72:75]
    ds_read_b64_tr_b16 v[206:207], v118 offset:10816
    s_waitcnt lgkmcnt(10)
    v_mfma_f32_16x16x32_bf16 v[20:23], v[212:215], v[180:183], v[20:23]
    ds_read_b64_tr_b16 v[208:209], v118 offset:7264
    v_mfma_f32_16x16x32_bf16 v[76:79], v[212:215], v[184:187], v[76:79]
    ds_read_b64_tr_b16 v[210:211], v118 offset:10848
    s_waitcnt lgkmcnt(10)
    v_mfma_f32_16x16x32_bf16 v[24:27], v[216:219], v[180:183], v[24:27]
    ds_read_b64_tr_b16 v[212:213], v118 offset:7296
    v_mfma_f32_16x16x32_bf16 v[80:83], v[216:219], v[184:187], v[80:83]
    ds_read_b64_tr_b16 v[214:215], v118 offset:10880
    s_waitcnt lgkmcnt(10)
    v_mfma_f32_16x16x32_bf16 v[28:31], v[220:223], v[180:183], v[28:31]
    ds_read_b64_tr_b16 v[216:217], v118 offset:7328
    v_mfma_f32_16x16x32_bf16 v[84:87], v[220:223], v[184:187], v[84:87]
    ds_read_b64_tr_b16 v[218:219], v118 offset:10912
    buffer_load_dwordx4 v[176:179], v121, s[12:15], s49 offen offset:1024 sc1
    s_add_u32 s49, s49, s50
    s_waitcnt lgkmcnt(10)
    v_mfma_f32_16x16x32_bf16 v[32:35], v[196:199], v[180:183], v[32:35]
    ds_read_b64_tr_b16 v[220:221], v118 offset:7360
    v_mfma_f32_16x16x32_bf16 v[88:91], v[196:199], v[184:187], v[88:91]
    ds_read_b64_tr_b16 v[222:223], v118 offset:10944
    s_waitcnt lgkmcnt(10)
    v_mfma_f32_16x16x32_bf16 v[36:39], v[200:203], v[180:183], v[36:39]
    ds_read_b64_tr_b16 v[196:197], v118 offset:14336
    v_mfma_f32_16x16x32_bf16 v[92:95], v[200:203], v[184:187], v[92:95]
    ds_read_b64_tr_b16 v[198:199], v118 offset:17920
    s_waitcnt lgkmcnt(10)
    v_mfma_f32_16x16x32_bf16 v[40:43], v[204:207], v[180:183], v[40:43]
    ds_read_b64_tr_b16 v[200:201], v118 offset:14368
    v_mfma_f32_16x16x32_bf16 v[96:99], v[204:207], v[184:187], v[96:99]
    ds_read_b64_tr_b16 v[202:203], v118 offset:17952
    s_waitcnt lgkmcnt(10)
    v_mfma_f32_16x16x32_bf16 v[44:47], v[208:211], v[180:183], v[44:47]
    ds_read_b64_tr_b16 v[204:205], v118 offset:14400
    v_mfma_f32_16x16x32_bf16 v[100:103], v[208:211], v[184:187], v[100:103]
    ds_read_b64_tr_b16 v[206:207], v118 offset:17984
    s_waitcnt lgkmcnt(10)
    v_mfma_f32_16x16x32_bf16 v[48:51], v[212:215], v[180:183], v[48:51]
    ds_read_b64 v[252:253], v254 offset:1024
    ds_read_b64_tr_b16 v[208:209], v118 offset:14432
    v_mfma_f32_16x16x32_bf16 v[104:107], v[212:215], v[184:187], v[104:107]
    ds_read_b64_tr_b16 v[210:211], v118 offset:18016
    s_waitcnt lgkmcnt(11)
    v_mfma_f32_16x16x32_bf16 v[52:55], v[216:219], v[180:183], v[52:55]
    ds_read_b64_tr_b16 v[212:213], v118 offset:14464
    v_mfma_f32_16x16x32_bf16 v[108:111], v[216:219], v[184:187], v[108:111]
    ds_read_b64_tr_b16 v[214:215], v118 offset:18048
    s_waitcnt lgkmcnt(11)
    v_mfma_f32_16x16x32_bf16 v[56:59], v[220:223], v[180:183], v[56:59]
    ds_read_b64_tr_b16 v[216:217], v118 offset:14496
    v_mfma_f32_16x16x32_bf16 v[112:115], v[220:223], v[184:187], v[112:115]
    ds_read_b64_tr_b16 v[218:219], v118 offset:18080
    s_waitcnt vmcnt(12) lgkmcnt(11)
    v_mfma_f32_16x16x32_bf16 v[4:7], v[196:199], v[188:191], v[4:7]
    ds_read_b64_tr_b16 v[220:221], v118 offset:14528
    v_mfma_f32_16x16x32_bf16 v[60:63], v[196:199], v[192:195], v[60:63]
    ds_read_b64_tr_b16 v[222:223], v118 offset:18112
    s_waitcnt lgkmcnt(11)
    v_mfma_f32_16x16x32_bf16 v[8:11], v[200:203], v[188:191], v[8:11]
    ds_read_b64_tr_b16 v[196:197], v118 offset:21504
    v_mfma_f32_16x16x32_bf16 v[64:67], v[200:203], v[192:195], v[64:67]
    ds_read_b64_tr_b16 v[198:199], v118 offset:25088
    s_waitcnt lgkmcnt(11)
    v_mfma_f32_16x16x32_bf16 v[12:15], v[204:207], v[188:191], v[12:15]
    ds_read_b64_tr_b16 v[200:201], v118 offset:21536
    v_mfma_f32_16x16x32_bf16 v[68:71], v[204:207], v[192:195], v[68:71]
    ds_read_b64_tr_b16 v[202:203], v118 offset:25120
    buffer_load_dwordx4 v[180:183], v120, s[12:15], s49 offen sc1
    s_waitcnt lgkmcnt(10)
    v_mfma_f32_16x16x32_bf16 v[16:19], v[208:211], v[188:191], v[16:19]
    ds_read_b64_tr_b16 v[204:205], v118 offset:21568
    v_mfma_f32_16x16x32_bf16 v[72:75], v[208:211], v[192:195], v[72:75]
    ds_read_b64_tr_b16 v[206:207], v118 offset:25152
    s_waitcnt lgkmcnt(10)
    v_mfma_f32_16x16x32_bf16 v[20:23], v[212:215], v[188:191], v[20:23]
    ds_read_b64_tr_b16 v[208:209], v118 offset:21600
    v_mfma_f32_16x16x32_bf16 v[76:79], v[212:215], v[192:195], v[76:79]
    ds_read_b64_tr_b16 v[210:211], v118 offset:25184
    s_waitcnt lgkmcnt(10)
    v_mfma_f32_16x16x32_bf16 v[24:27], v[216:219], v[188:191], v[24:27]
    v_min_u32 v252, v252, v253
    ds_read_b64_tr_b16 v[212:213], v118 offset:21632
    v_mfma_f32_16x16x32_bf16 v[80:83], v[216:219], v[192:195], v[80:83]
    ds_read_b64_tr_b16 v[214:215], v118 offset:25216
    s_waitcnt lgkmcnt(10)
    v_mfma_f32_16x16x32_bf16 v[28:31], v[220:223], v[188:191], v[28:31]
    v_readfirstlane_b32 s92, v252
    ds_read_b64_tr_b16 v[216:217], v118 offset:21664
    v_mfma_f32_16x16x32_bf16 v[84:87], v[220:223], v[192:195], v[84:87]
    ds_read_b64_tr_b16 v[218:219], v118 offset:25248
    buffer_load_dwordx4 v[184:187], v121, s[12:15], s49 offen sc1
    s_waitcnt lgkmcnt(10)
    v_mfma_f32_16x16x32_bf16 v[32:35], v[196:199], v[188:191], v[32:35]
    s_cmp_lt_u32 s92, 26
    s_cbranch_scc1 SP_38s
OK_37:
    ds_read_b64_tr_b16 v[220:221], v118 offset:21696
    v_mfma_f32_16x16x32_bf16 v[88:91], v[196:199], v[192:195], v[88:91]
    ds_read_b64_tr_b16 v[222:223], v118 offset:25280
    s_waitcnt lgkmcnt(10)
    v_mfma_f32_16x16x32_bf16 v[36:39], v[200:203], v[188:191], v[36:39]
    v_add_u32 v251, 1, v251
    ds_write_b32 v250, v251
    ds_read_b64_tr_b16 v[196:197], v117 offset:0
    v_mfma_f32_16x16x32_bf16 v[92:95], v[200:203], v[192:195], v[92:95]
    ds_read_b64_tr_b16 v[198:199], v117 offset:3584
    s_waitcnt lgkmcnt(11)
    v_mfma_f32_16x16x32_bf16 v[40:43], v[204:207], v[188:191], v[40:43]
    ds_read_b64_tr_b16 v[200:201], v117 offset:32
    v_mfma_f32_16x16x32_bf16 v[96:99], v[204:207], v[192:195], v[96:99]
    ds_read_b64_tr_b16 v[202:203], v117 offset:3616
    s_waitcnt lgkmcnt(11)
    v_mfma_f32_16x16x32_bf16 v[44:47], v[208:211], v[188:191], v[44:47]
    ds_read_b64_tr_b16 v[204:205], v117 offset:64
    v_mfma_f32_16x16x32_bf16 v[100:103], v[208:211], v[192:195], v[100:103]
    ds_read_b64_tr_b16 v[206:207], v117 offset:3648
    s_waitcnt lgkmcnt(11)
    v_mfma_f32_16x16x32_bf16 v[48:51], v[212:215], v[188:191], v[48:51]
    ds_read_b64_tr_b16 v[208:209], v117 offset:96
    v_mfma_f32_16x16x32_bf16 v[104:107], v[212:215], v[192:195], v[104:107]
    ds_read_b64_tr_b16 v[210:211], v117 offset:3680
    s_waitcnt lgkmcnt(11)
    v_mfma_f32_16x16x32_bf16 v[52:55], v[216:219], v[188:191], v[52:55]
    ds_read_b64_tr_b16 v[212:213], v117 offset:128
    v_mfma_f32_16x16x32_bf16 v[108:111], v[216:219], v[192:195], v[108:111]
    ds_read_b64_tr_b16 v[214:215], v117 offset:3712
    s_waitcnt lgkmcnt(11)
    v_mfma_f32_16x16x32_bf16 v[56:59], v[220:223], v[188:191], v[56:59]
    ds_read_b64_tr_b16 v[216:217], v117 offset:160
    v_mfma_f32_16x16x32_bf16 v[112:115], v[220:223], v[192:195], v[112:115]
    ds_read_b64_tr_b16 v[218:219], v117 offset:3744
    v_add_u32 v118, 114688, v119
    s_waitcnt vmcnt(12) lgkmcnt(10)
    v_mfma_f32_16x16x32_bf16 v[4:7], v[196:199], v[132:135], v[4:7]
    ds_read_b64_tr_b16 v[220:221], v117 offset:192
    v_mfma_f32_16x16x32_bf16 v[60:63], v[196:199], v[136:139], v[60:63]
    ds_read_b64_tr_b16 v[222:223], v117 offset:3776
    s_waitcnt lgkmcnt(10)
    v_mfma_f32_16x16x32_bf16 v[8:11], v[200:203], v[132:135], v[8:11]
    ds_read_b64_tr_b16 v[196:197], v117 offset:7168
    v_mfma_f32_16x16x32_bf16 v[64:67], v[200:203], v[136:139], v[64:67]
    ds_read_b64_tr_b16 v[198:199], v117 offset:10752
    s_waitcnt lgkmcnt(10)
    v_mfma_f32_16x16x32_bf16 v[12:15], v[204:207], v[132:135], v[12:15]
    ds_read_b64_tr_b16 v[200:201], v117 offset:7200
    v_mfma_f32_16x16x32_bf16 v[68:71], v[204:207], v[136:139], v[68:71]
    ds_read_b64_tr_b16 v[202:203], v117 offset:10784
    buffer_load_dwordx4 v[188:191], v120, s[12:15], s49 offen offset:1024 sc1
    s_waitcnt lgkmcnt(10)
    v_mfma_f32_16x16x32_bf16 v[16:19], v[208:211], v[132:135], v[16:19]
    ds_read_b64_tr_b16 v[204:205], v117 offset:7232
    v_mfma_f32_16x16x32_bf16 v[72:75], v[208:211], v[136:139], v[72:75]
    ds_read_b64_tr_b16 v[206:207], v117 offset:10816
    s_waitcnt lgkmcnt(10)
    v_mfma_f32_16x16x32_bf16 v[20:23], v[212:215], v[132:135], v[20:23]
    ds_read_b64_tr_b16 v[208:209], v117 offset:7264
    v_mfma_f32_16x16x32_bf16 v[76:79], v[212:215], v[136:139], v[76:79]
    ds_read_b64_tr_b16 v[210:211], v117 offset:10848
    s_waitcnt lgkmcnt(10)
    v_mfma_f32_16x16x32_bf16 v[24:27], v[216:219], v[132:135], v[24:27]
    ds_read_b64_tr_b16 v[212:213], v117 offset:7296
    v_mfma_f32_16x16x32_bf16 v[80:83], v[216:219], v[136:139], v[80:83]
    ds_read_b64_tr_b16 v[214:215], v117 offset:10880
    s_waitcnt lgkmcnt(10)
    v_mfma_f32_16x16x32_bf16 v[28:31], v[220:223], v[132:135], v[28:31]
    ds_read_b64_tr_b16 v[216:217], v117 offset:7328
    v_mfma_f32_16x16x32_bf16 v[84:87], v[220:223], v[136:139], v[84:87]
    ds_read_b64_tr_b16 v[218:219], v117 offset:10912
    buffer_load_dwordx4 v[192:195], v121, s[12:15], s49 offen offset:1024 sc1
    s_add_u32 s49, s49, s59
    s_waitcnt lgkmcnt(10)
    v_mfma_f32_16x16x32_bf16 v[32:35], v[196:199], v[132:135], v[32:35]
    ds_read_b64_tr_b16 v[220:221], v117 offset:7360
    v_mfma_f32_16x16x32_bf16 v[88:91], v[196:199], v[136:139], v[88:91]
    ds_read_b64_tr_b16 v[222:223], v117 offset:10944
    s_waitcnt lgkmcnt(10)
    v_mfma_f32_16x16x32_bf16 v[36:39], v[200:203], v[132:135], v[36:39]
    ds_read_b64_tr_b16 v[196:197], v117 offset:14336
    v_mfma_f32_16x16x32_bf16 v[92:95], v[200:203], v[136:139], v[92:95]
    ds_read_b64_tr_b16 v[198:199], v117 offset:17920
    s_waitcnt lgkmcnt(10)
    v_mfma_f32_16x16x32_bf16 v[40:43], v[204:207], v[132:135], v[40:43]
    ds_read_b64_tr_b16 v[200:201], v117 offset:14368
    v_mfma_f32_16x16x32_bf16 v[96:99], v[204:207], v[136:139], v[96:99]
    ds_read_b64_tr_b16 v[202:203], v117 offset:17952
    s_waitcnt lgkmcnt(10)
    v_mfma_f32_16x16x32_bf16 v[44:47], v[208:211], v[132:135], v[44:47]
    ds_read_b64_tr_b16 v[204:205], v117 offset:14400
    v_mfma_f32_16x16x32_bf16 v[100:103], v[208:211], v[136:139], v[100:103]
    ds_read_b64_tr_b16 v[206:207], v117 offset:17984
    s_waitcnt lgkmcnt(10)
    v_mfma_f32_16x16x32_bf16 v[48:51], v[212:215], v[132:135], v[48:51]
    ds_read_b64 v[252:253], v254 offset:1024
    ds_read_b64_tr_b16 v[208:209], v117 offset:14432
    v_mfma_f32_16x16x32_bf16 v[104:107], v[212:215], v[136:139], v[104:107]
    ds_read_b64_tr_b16 v[210:211], v117 offset:18016
    s_waitcnt lgkmcnt(11)
    v_mfma_f32_16x16x32_bf16 v[52:55], v[216:219], v[132:135], v[52:55]
    ds_read_b64_tr_b16 v[212:213], v117 offset:14464
    v_mfma_f32_16x16x32_bf16 v[108:111], v[216:219], v[136:139], v[108:111]
    ds_read_b64_tr_b16 v[214:215], v117 offset:18048
    s_waitcnt lgkmcnt(11)
    v_mfma_f32_16x16x32_bf16 v[56:59], v[220:223], v[132:135], v[56:59]
    ds_read_b64_tr_b16 v[216:217], v117 offset:14496
    v_mfma_f32_16x16x32_bf16 v[112:115], v[220:223], v[136:139], v[112:115]
    ds_read_b64_tr_b16 v[218:219], v117 offset:18080
    s_waitcnt vmcnt(12) lgkmcnt(11)
    v_mfma_f32_16x16x32_bf16 v[4:7], v[196:199], v[140:143], v[4:7]
    ds_read_b64_tr_b16 v[220:221], v117 offset:14528
    v_mfma_f32_16x16x32_bf16 v[60:63], v[196:199], v[144:147], v[60:63]
    ds_read_b64_tr_b16 v[222:223], v117 offset:18112
    s_waitcnt lgkmcnt(11)
    v_mfma_f32_16x16x32_bf16 v[8:11], v[200:203], v[140:143], v[8:11]
    ds_read_b64_tr_b16 v[196:197], v117 offset:21504
    v_mfma_f32_16x16x32_bf16 v[64:67], v[200:203], v[144:147], v[64:67]
    ds_read_b64_tr_b16 v[198:199], v117 offset:25088
    s_waitcnt lgkmcnt(11)
    v_mfma_f32_16x16x32_bf16 v[12:15], v[204:207], v[140:143], v[12:15]
    ds_read_b64_tr_b16 v[200:201], v117 offset:21536
    v_mfma_f32_16x16x32_bf16 v[68:71], v[204:207], v[144:147], v[68:71]
    ds_read_b64_tr_b16 v[202:203], v117 offset:25120
    buffer_load_dwordx4 v[132:135], v120, s[12:15], s49 offen sc1
    s_waitcnt lgkmcnt(10)
    v_mfma_f32_16x16x32_bf16 v[16:19], v[208:211], v[140:143], v[16:19]
    ds_read_b64_tr_b16 v[204:205], v117 offset:21568
    v_mfma_f32_16x16x32_bf16 v[72:75], v[208:211], v[144:147], v[72:75]
    ds_read_b64_tr_b16 v[206:207], v117 offset:25152
    s_waitcnt lgkmcnt(10)
    v_mfma_f32_16x16x32_bf16 v[20:23], v[212:215], v[140:143], v[20:23]
    ds_read_b64_tr_b16 v[208:209], v117 offset:21600
    v_mfma_f32_16x16x32_bf16 v[76:79], v[212:215], v[144:147], v[76:79]
    ds_read_b64_tr_b16 v[210:211], v117 offset:25184
    s_waitcnt lgkmcnt(10)
    v_mfma_f32_16x16x32_bf16 v[24:27], v[216:219], v[140:143], v[24:27]
    v_min_u32 v252, v252, v253
    ds_read_b64_tr_b16 v[212:213], v117 offset:21632
    v_mfma_f32_16x16x32_bf16 v[80:83], v[216:219], v[144:147], v[80:83]
    ds_read_b64_tr_b16 v[214:215], v117 offset:25216
    s_waitcnt lgkmcnt(10)
    v_mfma_f32_16x16x32_bf16 v[28:31], v[220:223], v[140:143], v[28:31]
    v_readfirstlane_b32 s92, v252
    ds_read_b64_tr_b16 v[216:217], v117 offset:21664
    v_mfma_f32_16x16x32_bf16 v[84:87], v[220:223], v[144:147], v[84:87]
    ds_read_b64_tr_b16 v[218:219], v117 offset:25248
    buffer_load_dwordx4 v[136:139], v121, s[12:15], s49 offen sc1
    s_waitcnt lgkmcnt(10)
    v_mfma_f32_16x16x32_bf16 v[32:35], v[196:199], v[140:143], v[32:35]
    s_cmp_lt_u32 s92, 27
    s_cbranch_scc1 SP_40s
OK_39:
    ds_read_b64_tr_b16 v[220:221], v117 offset:21696
    v_mfma_f32_16x16x32_bf16 v[88:91], v[196:199], v[144:147], v[88:91]
    ds_read_b64_tr_b16 v[222:223], v117 offset:25280
    s_waitcnt lgkmcnt(10)
    v_mfma_f32_16x16x32_bf16 v[36:39], v[200:203], v[140:143], v[36:39]
    v_add_u32 v251, 1, v251
    ds_write_b32 v250, v251
    ds_read_b64_tr_b16 v[196:197], v118 offset:0
    v_mfma_f32_16x16x32_bf16 v[92:95], v[200:203], v[144:147], v[92:95]
    ds_read_b64_tr_b16 v[198:199], v118 offset:3584
    s_waitcnt lgkmcnt(11)
    v_mfma_f32_16x16x32_bf16 v[40:43], v[204:207], v[140:143], v[40:43]
    ds_read_b64_tr_b16 v[200:201], v118 offset:32
    v_mfma_f32_16x16x32_bf16 v[96:99], v[204:207], v[144:147], v[96:99]
    ds_read_b64_tr_b16 v[202:203], v118 offset:3616
    s_waitcnt lgkmcnt(11)
    v_mfma_f32_16x16x32_bf16 v[44:47], v[208:211], v[140:143], v[44:47]
    ds_read_b64_tr_b16 v[204:205], v118 offset:64
    v_mfma_f32_16x16x32_bf16 v[100:103], v[208:211], v[144:147], v[100:103]
    ds_read_b64_tr_b16 v[206:207], v118 offset:3648
    s_waitcnt lgkmcnt(11)
    v_mfma_f32_16x16x32_bf16 v[48:51], v[212:215], v[140:143], v[48:51]
    ds_read_b64_tr_b16 v[208:209], v118 offset:96
    v_mfma_f32_16x16x32_bf16 v[104:107], v[212:215], v[144:147], v[104:107]
    ds_read_b64_tr_b16 v[210:211], v118 offset:3680
    s_waitcnt lgkmcnt(11)
    v_mfma_f32_16x16x32_bf16 v[52:55], v[216:219], v[140:143], v[52:55]
    ds_read_b64_tr_b16 v[212:213], v118 offset:128
    v_mfma_f32_16x16x32_bf16 v[108:111], v[216:219], v[144:147], v[108:111]
    ds_read_b64_tr_b16 v[214:215], v118 offset:3712
    s_waitcnt lgkmcnt(11)
    v_mfma_f32_16x16x32_bf16 v[56:59], v[220:223], v[140:143], v[56:59]
    ds_read_b64_tr_b16 v[216:217], v118 offset:160
    v_mfma_f32_16x16x32_bf16 v[112:115], v[220:223], v[144:147], v[112:115]
    ds_read_b64_tr_b16 v[218:219], v118 offset:3744
    v_add_u32 v117, 0, v119
    s_waitcnt vmcnt(12) lgkmcnt(10)
    v_mfma_f32_16x16x32_bf16 v[4:7], v[196:199], v[148:151], v[4:7]
    ds_read_b64_tr_b16 v[220:221], v118 offset:192
    v_mfma_f32_16x16x32_bf16 v[60:63], v[196:199], v[152:155], v[60:63]
    ds_read_b64_tr_b16 v[222:223], v118 offset:3776
    s_waitcnt lgkmcnt(10)
    v_mfma_f32_16x16x32_bf16 v[8:11], v[200:203], v[148:151], v[8:11]
    ds_read_b64_tr_b16 v[196:197], v118 offset:7168
    v_mfma_f32_16x16x32_bf16 v[64:67], v[200:203], v[152:155], v[64:67]
    ds_read_b64_tr_b16 v[198:199], v118 offset:10752
    s_waitcnt lgkmcnt(10)
    v_mfma_f32_16x16x32_bf16 v[12:15], v[204:207], v[148:151], v[12:15]
    ds_read_b64_tr_b16 v[200:201], v118 offset:7200
    v_mfma_f32_16x16x32_bf16 v[68:71], v[204:207], v[152:155], v[68:71]
    ds_read_b64_tr_b16 v[202:203], v118 offset:10784
    buffer_load_dwordx4 v[140:143], v120, s[12:15], s49 offen offset:1024 sc1
    s_waitcnt lgkmcnt(10)
    v_mfma_f32_16x16x32_bf16 v[16:19], v[208:211], v[148:151], v[16:19]
    ds_read_b64_tr_b16 v[204:205], v118 offset:7232
    v_mfma_f32_16x16x32_bf16 v[72:75], v[208:211], v[152:155], v[72:75]
    ds_read_b64_tr_b16 v[206:207], v118 offset:10816
    s_waitcnt lgkmcnt(10)
    v_mfma_f32_16x16x32_bf16 v[20:23], v[212:215], v[148:151], v[20:23]
    ds_read_b64_tr_b16 v[208:209], v118 offset:7264
    v_mfma_f32_16x16x32_bf16 v[76:79], v[212:215], v[152:155], v[76:79]
    ds_read_b64_tr_b16 v[210:211], v118 offset:10848
    s_waitcnt lgkmcnt(10)
    v_mfma_f32_16x16x32_bf16 v[24:27], v[216:219], v[148:151], v[24:27]
    ds_read_b64_tr_b16 v[212:213], v118 offset:7296
    v_mfma_f32_16x16x32_bf16 v[80:83], v[216:219], v[152:155], v[80:83]
    ds_read_b64_tr_b16 v[214:215], v118 offset:10880
    s_waitcnt lgkmcnt(10)
    v_mfma_f32_16x16x32_bf16 v[28:31], v[220:223], v[148:151], v[28:31]
    ds_read_b64_tr_b16 v[216:217], v118 offset:7328
    v_mfma_f32_16x16x32_bf16 v[84:87], v[220:223], v[152:155], v[84:87]
    ds_read_b64_tr_b16 v[218:219], v118 offset:10912
    buffer_load_dwordx4 v[144:147], v121, s[12:15], s49 offen offset:1024 sc1
    s_add_u32 s49, s49, s50
    s_waitcnt lgkmcnt(10)
    v_mfma_f32_16x16x32_bf16 v[32:35], v[196:199], v[148:151], v[32:35]
    ds_read_b64_tr_b16 v[220:221], v118 offset:7360
    v_mfma_f32_16x16x32_bf16 v[88:91], v[196:199], v[152:155], v[88:91]
    ds_read_b64_tr_b16 v[222:223], v118 offset:10944
    s_waitcnt lgkmcnt(10)
    v_mfma_f32_16x16x32_bf16 v[36:39], v[200:203], v[148:151], v[36:39]
    ds_read_b64_tr_b16 v[196:197], v118 offset:14336
    v_mfma_f32_16x16x32_bf16 v[92:95], v[200:203], v[152:155], v[92:95]
    ds_read_b64_tr_b16 v[198:199], v118 offset:17920
    s_waitcnt lgkmcnt(10)
    v_mfma_f32_16x16x32_bf16 v[40:43], v[204:207], v[148:151], v[40:43]
    ds_read_b64_tr_b16 v[200:201], v118 offset:14368
    v_mfma_f32_16x16x32_bf16 v[96:99], v[204:207], v[152:155], v[96:99]
    ds_read_b64_tr_b16 v[202:203], v118 offset:17952
    s_waitcnt lgkmcnt(10)
    v_mfma_f32_16x16x32_bf16 v[44:47], v[208:211], v[148:151], v[44:47]
    ds_read_b64_tr_b16 v[204:205], v118 offset:14400
    v_mfma_f32_16x16x32_bf16 v[100:103], v[208:211], v[152:155], v[100:103]
    ds_read_b64_tr_b16 v[206:207], v118 offset:17984
    s_waitcnt lgkmcnt(10)
    v_mfma_f32_16x16x32_bf16 v[48:51], v[212:215], v[148:151], v[48:51]
    ds_read_b64 v[252:253], v254 offset:1024
    ds_read_b64_tr_b16 v[208:209], v118 offset:14432
    v_mfma_f32_16x16x32_bf16 v[104:107], v[212:215], v[152:155], v[104:107]
    ds_read_b64_tr_b16 v[210:211], v118 offset:18016
    s_waitcnt lgkmcnt(11)
    v_mfma_f32_16x16x32_bf16 v[52:55], v[216:219], v[148:151], v[52:55]
    ds_read_b64_tr_b16 v[212:213], v118 offset:14464
    v_mfma_f32_16x16x32_bf16 v[108:111], v[216:219], v[152:155], v[108:111]
    ds_read_b64_tr_b16 v[214:215], v118 offset:18048
    s_waitcnt lgkmcnt(11)
    v_mfma_f32_16x16x32_bf16 v[56:59], v[220:223], v[148:151], v[56:59]
    ds_read_b64_tr_b16 v[216:217], v118 offset:14496
    v_mfma_f32_16x16x32_bf16 v[112:115], v[220:223], v[152:155], v[112:115]
    ds_read_b64_tr_b16 v[218:219], v118 offset:18080
    s_waitcnt vmcnt(12) lgkmcnt(11)
    v_mfma_f32_16x16x32_bf16 v[4:7], v[196:199], v[156:159], v[4:7]
    ds_read_b64_tr_b16 v[220:221], v118 offset:14528
    v_mfma_f32_16x16x32_bf16 v[60:63], v[196:199], v[160:163], v[60:63]
    ds_read_b64_tr_b16 v[222:223], v118 offset:18112
    s_waitcnt lgkmcnt(11)
    v_mfma_f32_16x16x32_bf16 v[8:11], v[200:203], v[156:159], v[8:11]
    ds_read_b64_tr_b16 v[196:197], v118 offset:21504
    v_mfma_f32_16x16x32_bf16 v[64:67], v[200:203], v[160:163], v[64:67]
    ds_read_b64_tr_b16 v[198:199], v118 offset:25088
    s_waitcnt lgkmcnt(11)
    v_mfma_f32_16x16x32_bf16 v[12:15], v[204:207], v[156:159], v[12:15]
    ds_read_b64_tr_b16 v[200:201], v118 offset:21536
    v_mfma_f32_16x16x32_bf16 v[68:71], v[204:207], v[160:163], v[68:71]
    ds_read_b64_tr_b16 v[202:203], v118 offset:25120
    buffer_load_dwordx4 v[148:151], v120, s[12:15], s49 offen sc1
    s_waitcnt lgkmcnt(10)
    v_mfma_f32_16x16x32_bf16 v[16:19], v[208:211], v[156:159], v[16:19]
    ds_read_b64_tr_b16 v[204:205], v118 offset:21568
    v_mfma_f32_16x16x32_bf16 v[72:75], v[208:211], v[160:163], v[72:75]
    ds_read_b64_tr_b16 v[206:207], v118 offset:25152
    s_waitcnt lgkmcnt(10)
    v_mfma_f32_16x16x32_bf16 v[20:23], v[212:215], v[156:159], v[20:23]
    ds_read_b64_tr_b16 v[208:209], v118 offset:21600
    v_mfma_f32_16x16x32_bf16 v[76:79], v[212:215], v[160:163], v[76:79]
    ds_read_b64_tr_b16 v[210:211], v118 offset:25184
    s_waitcnt lgkmcnt(10)
    v_mfma_f32_16x16x32_bf16 v[24:27], v[216:219], v[156:159], v[24:27]
    v_min_u32 v252, v252, v253
    ds_read_b64_tr_b16 v[212:213], v118 offset:21632
    v_mfma_f32_16x16x32_bf16 v[80:83], v[216:219], v[160:163], v[80:83]
    ds_read_b64_tr_b16 v[214:215], v118 offset:25216
    s_waitcnt lgkmcnt(10)
    v_mfma_f32_16x16x32_bf16 v[28:31], v[220:223], v[156:159], v[28:31]
    v_readfirstlane_b32 s92, v252
    ds_read_b64_tr_b16 v[216:217], v118 offset:21664
    v_mfma_f32_16x16x32_bf16 v[84:87], v[220:223], v[160:163], v[84:87]
    ds_read_b64_tr_b16 v[218:219], v118 offset:25248
    buffer_load_dwordx4 v[152:155], v121, s[12:15], s49 offen sc1
    s_waitcnt lgkmcnt(10)
    v_mfma_f32_16x16x32_bf16 v[32:35], v[196:199], v[156:159], v[32:35]
    s_cmp_lt_u32 s92, 28
    s_cbranch_scc1 SP_42s
OK_41:
    ds_read_b64_tr_b16 v[220:221], v118 offset:21696
    v_mfma_f32_16x16x32_bf16 v[88:91], v[196:199], v[160:163], v[88:91]
    ds_read_b64_tr_b16 v[222:223], v118 offset:25280
    s_waitcnt lgkmcnt(10)
    v_mfma_f32_16x16x32_bf16 v[36:39], v[200:203], v[156:159], v[36:39]
    v_add_u32 v251, 1, v251
    ds_write_b32 v250, v251
    ds_read_b64_tr_b16 v[196:197], v117 offset:0
    v_mfma_f32_16x16x32_bf16 v[92:95], v[200:203], v[160:163], v[92:95]
    ds_read_b64_tr_b16 v[198:199], v117 offset:3584
    s_waitcnt lgkmcnt(11)
    v_mfma_f32_16x16x32_bf16 v[40:43], v[204:207], v[156:159], v[40:43]
    ds_read_b64_tr_b16 v[200:201], v117 offset:32
    v_mfma_f32_16x16x32_bf16 v[96:99], v[204:207], v[160:163], v[96:99]
    ds_read_b64_tr_b16 v[202:203], v117 offset:3616
    s_waitcnt lgkmcnt(11)
    v_mfma_f32_16x16x32_bf16 v[44:47], v[208:211], v[156:159], v[44:47]
    ds_read_b64_tr_b16 v[204:205], v117 offset:64
    v_mfma_f32_16x16x32_bf16 v[100:103], v[208:211], v[160:163], v[100:103]
    ds_read_b64_tr_b16 v[206:207], v117 offset:3648
    s_waitcnt lgkmcnt(11)
    v_mfma_f32_16x16x32_bf16 v[48:51], v[212:215], v[156:159], v[48:51]
    ds_read_b64_tr_b16 v[208:209], v117 offset:96
    v_mfma_f32_16x16x32_bf16 v[104:107], v[212:215], v[160:163], v[104:107]
    ds_read_b64_tr_b16 v[210:211], v117 offset:3680
    s_waitcnt lgkmcnt(11)
    v_mfma_f32_16x16x32_bf16 v[52:55], v[216:219], v[156:159], v[52:55]
    ds_read_b64_tr_b16 v[212:213], v117 offset:128
    v_mfma_f32_16x16x32_bf16 v[108:111], v[216:219], v[160:163], v[108:111]
    ds_read_b64_tr_b16 v[214:215], v117 offset:3712
    s_waitcnt lgkmcnt(11)
    v_mfma_f32_16x16x32_bf16 v[56:59], v[220:223], v[156:159], v[56:59]
    ds_read_b64_tr_b16 v[216:217], v117 offset:160
    v_mfma_f32_16x16x32_bf16 v[112:115], v[220:223], v[160:163], v[112:115]
    ds_read_b64_tr_b16 v[218:219], v117 offset:3744
    v_add_u32 v118, 28672, v119
    s_waitcnt vmcnt(12) lgkmcnt(10)
    v_mfma_f32_16x16x32_bf16 v[4:7], v[196:199], v[164:167], v[4:7]
    ds_read_b64_tr_b16 v[220:221], v117 offset:192
    v_mfma_f32_16x16x32_bf16 v[60:63], v[196:199], v[168:171], v[60:63]
    ds_read_b64_tr_b16 v[222:223], v117 offset:3776
    s_waitcnt lgkmcnt(10)
    v_mfma_f32_16x16x32_bf16 v[8:11], v[200:203], v[164:167], v[8:11]
    ds_read_b64_tr_b16 v[196:197], v117 offset:7168
    v_mfma_f32_16x16x32_bf16 v[64:67], v[200:203], v[168:171], v[64:67]
    ds_read_b64_tr_b16 v[198:199], v117 offset:10752
    s_waitcnt lgkmcnt(10)
    v_mfma_f32_16x16x32_bf16 v[12:15], v[204:207], v[164:167], v[12:15]
    ds_read_b64_tr_b16 v[200:201], v117 offset:7200
    v_mfma_f32_16x16x32_bf16 v[68:71], v[204:207], v[168:171], v[68:71]
    ds_read_b64_tr_b16 v[202:203], v117 offset:10784
    buffer_load_dwordx4 v[156:159], v120, s[12:15], s49 offen offset:1024 sc1
    s_waitcnt lgkmcnt(10)
    v_mfma_f32_16x16x32_bf16 v[16:19], v[208:211], v[164:167], v[16:19]
    ds_read_b64_tr_b16 v[204:205], v117 offset:7232
    v_mfma_f32_16x16x32_bf16 v[72:75], v[208:211], v[168:171], v[72:75]
    ds_read_b64_tr_b16 v[206:207], v117 offset:10816
    s_waitcnt lgkmcnt(10)
    v_mfma_f32_16x16x32_bf16 v[20:23], v[212:215], v[164:167], v[20:23]
    ds_read_b64_tr_b16 v[208:209], v117 offset:7264
    v_mfma_f32_16x16x32_bf16 v[76:79], v[212:215], v[168:171], v[76:79]
    ds_read_b64_tr_b16 v[210:211], v117 offset:10848
    s_waitcnt lgkmcnt(10)
    v_mfma_f32_16x16x32_bf16 v[24:27], v[216:219], v[164:167], v[24:27]
    ds_read_b64_tr_b16 v[212:213], v117 offset:7296
    v_mfma_f32_16x16x32_bf16 v[80:83], v[216:219], v[168:171], v[80:83]
    ds_read_b64_tr_b16 v[214:215], v117 offset:10880
    s_waitcnt lgkmcnt(10)
    v_mfma_f32_16x16x32_bf16 v[28:31], v[220:223], v[164:167], v[28:31]
    ds_read_b64_tr_b16 v[216:217], v117 offset:7328
    v_mfma_f32_16x16x32_bf16 v[84:87], v[220:223], v[168:171], v[84:87]
    ds_read_b64_tr_b16 v[218:219], v117 offset:10912
    buffer_load_dwordx4 v[160:163], v121, s[12:15], s49 offen offset:1024 sc1
    s_add_u32 s49, s49, s59
    s_waitcnt lgkmcnt(10)
    v_mfma_f32_16x16x32_bf16 v[32:35], v[196:199], v[164:167], v[32:35]
    ds_read_b64_tr_b16 v[220:221], v117 offset:7360
    v_mfma_f32_16x16x32_bf16 v[88:91], v[196:199], v[168:171], v[88:91]
    ds_read_b64_tr_b16 v[222:223], v117 offset:10944
    s_waitcnt lgkmcnt(10)
    v_mfma_f32_16x16x32_bf16 v[36:39], v[200:203], v[164:167], v[36:39]
    ds_read_b64_tr_b16 v[196:197], v117 offset:14336
    v_mfma_f32_16x16x32_bf16 v[92:95], v[200:203], v[168:171], v[92:95]
    ds_read_b64_tr_b16 v[198:199], v117 offset:17920
    s_waitcnt lgkmcnt(10)
    v_mfma_f32_16x16x32_bf16 v[40:43], v[204:207], v[164:167], v[40:43]
    ds_read_b64_tr_b16 v[200:201], v117 offset:14368
    v_mfma_f32_16x16x32_bf16 v[96:99], v[204:207], v[168:171], v[96:99]
    ds_read_b64_tr_b16 v[202:203], v117 offset:17952
    s_waitcnt lgkmcnt(10)
    v_mfma_f32_16x16x32_bf16 v[44:47], v[208:211], v[164:167], v[44:47]
    ds_read_b64_tr_b16 v[204:205], v117 offset:14400
    v_mfma_f32_16x16x32_bf16 v[100:103], v[208:211], v[168:171], v[100:103]
    ds_read_b64_tr_b16 v[206:207], v117 offset:17984
    s_waitcnt lgkmcnt(10)
    v_mfma_f32_16x16x32_bf16 v[48:51], v[212:215], v[164:167], v[48:51]
    ds_read_b64 v[252:253], v254 offset:1024
    ds_read_b64_tr_b16 v[208:209], v117 offset:14432
    v_mfma_f32_16x16x32_bf16 v[104:107], v[212:215], v[168:171], v[104:107]
    ds_read_b64_tr_b16 v[210:211], v117 offset:18016
    s_waitcnt lgkmcnt(11)
    v_mfma_f32_16x16x32_bf16 v[52:55], v[216:219], v[164:167], v[52:55]
    ds_read_b64_tr_b16 v[212:213], v117 offset:14464
    v_mfma_f32_16x16x32_bf16 v[108:111], v[216:219], v[168:171], v[108:111]
    ds_read_b64_tr_b16 v[214:215], v117 offset:18048
    s_waitcnt lgkmcnt(11)
    v_mfma_f32_16x16x32_bf16 v[56:59], v[220:223], v[164:167], v[56:59]
    ds_read_b64_tr_b16 v[216:217], v117 offset:14496
    v_mfma_f32_16x16x32_bf16 v[112:115], v[220:223], v[168:171], v[112:115]
    ds_read_b64_tr_b16 v[218:219], v117 offset:18080
    s_waitcnt vmcnt(12) lgkmcnt(11)
    v_mfma_f32_16x16x32_bf16 v[4:7], v[196:199], v[172:175], v[4:7]
    ds_read_b64_tr_b16 v[220:221], v117 offset:14528
    v_mfma_f32_16x16x32_bf16 v[60:63], v[196:199], v[176:179], v[60:63]
    ds_read_b64_tr_b16 v[222:223], v117 offset:18112
    s_waitcnt lgkmcnt(11)
    v_mfma_f32_16x16x32_bf16 v[8:11], v[200:203], v[172:175], v[8:11]
    ds_read_b64_tr_b16 v[196:197], v117 offset:21504
    v_mfma_f32_16x16x32_bf16 v[64:67], v[200:203], v[176:179], v[64:67]
    ds_read_b64_tr_b16 v[198:199], v117 offset:25088
    s_waitcnt lgkmcnt(11)
    v_mfma_f32_16x16x32_bf16 v[12:15], v[204:207], v[172:175], v[12:15]
    ds_read_b64_tr_b16 v[200:201], v117 offset:21536
    v_mfma_f32_16x16x32_bf16 v[68:71], v[204:207], v[176:179], v[68:71]
    ds_read_b64_tr_b16 v[202:203], v117 offset:25120
    s_waitcnt lgkmcnt(10)
    v_mfma_f32_16x16x32_bf16 v[16:19], v[208:211], v[172:175], v[16:19]
    ds_read_b64_tr_b16 v[204:205], v117 offset:21568
    v_mfma_f32_16x16x32_bf16 v[72:75], v[208:211], v[176:179], v[72:75]
    ds_read_b64_tr_b16 v[206:207], v117 offset:25152
    s_waitcnt lgkmcnt(10)
    v_mfma_f32_16x16x32_bf16 v[20:23], v[212:215], v[172:175], v[20:23]
    ds_read_b64_tr_b16 v[208:209], v117 offset:21600
    v_mfma_f32_16x16x32_bf16 v[76:79], v[212:215], v[176:179], v[76:79]
    ds_read_b64_tr_b16 v[210:211], v117 offset:25184
    s_waitcnt lgkmcnt(10)
    v_mfma_f32_16x16x32_bf16 v[24:27], v[216:219], v[172:175], v[24:27]
    v_min_u32 v252, v252, v253
    ds_read_b64_tr_b16 v[212:213], v117 offset:21632
    v_mfma_f32_16x16x32_bf16 v[80:83], v[216:219], v[176:179], v[80:83]
    ds_read_b64_tr_b16 v[214:215], v117 offset:25216
    s_waitcnt lgkmcnt(10)
    v_mfma_f32_16x16x32_bf16 v[28:31], v[220:223], v[172:175], v[28:31]
    v_readfirstlane_b32 s92, v252
    ds_read_b64_tr_b16 v[216:217], v117 offset:21664
    v_mfma_f32_16x16x32_bf16 v[84:87], v[220:223], v[176:179], v[84:87]
    ds_read_b64_tr_b16 v[218:219], v117 offset:25248
    s_waitcnt lgkmcnt(10)
    v_mfma_f32_16x16x32_bf16 v[32:35], v[196:199], v[172:175], v[32:35]
    s_cmp_lt_u32 s92, 29
    s_cbranch_scc1 SP_44s
OK_43:
    ds_read_b64_tr_b16 v[220:221], v117 offset:21696
    v_mfma_f32_16x16x32_bf16 v[88:91], v[196:199], v[176:179], v[88:91]
    ds_read_b64_tr_b16 v[222:223], v117 offset:25280
    s_waitcnt lgkmcnt(10)
    v_mfma_f32_16x16x32_bf16 v[36:39], v[200:203], v[172:175], v[36:39]
    v_add_u32 v251, 1, v251
    ds_write_b32 v250, v251
    ds_read_b64_tr_b16 v[196:197], v118 offset:0
    v_mfma_f32_16x16x32_bf16 v[92:95], v[200:203], v[176:179], v[92:95]
    ds_read_b64_tr_b16 v[198:199], v118 offset:3584
    s_waitcnt lgkmcnt(11)
    v_mfma_f32_16x16x32_bf16 v[40:43], v[204:207], v[172:175], v[40:43]
    ds_read_b64_tr_b16 v[200:201], v118 offset:32
    v_mfma_f32_16x16x32_bf16 v[96:99], v[204:207], v[176:179], v[96:99]
    ds_read_b64_tr_b16 v[202:203], v118 offset:3616
    s_waitcnt lgkmcnt(11)
    v_mfma_f32_16x16x32_bf16 v[44:47], v[208:211], v[172:175], v[44:47]
    ds_read_b64_tr_b16 v[204:205], v118 offset:64
    v_mfma_f32_16x16x32_bf16 v[100:103], v[208:211], v[176:179], v[100:103]
    ds_read_b64_tr_b16 v[206:207], v118 offset:3648
    s_waitcnt lgkmcnt(11)
    v_mfma_f32_16x16x32_bf16 v[48:51], v[212:215], v[172:175], v[48:51]
    ds_read_b64_tr_b16 v[208:209], v118 offset:96
    v_mfma_f32_16x16x32_bf16 v[104:107], v[212:215], v[176:179], v[104:107]
    ds_read_b64_tr_b16 v[210:211], v118 offset:3680
    s_waitcnt lgkmcnt(11)
    v_mfma_f32_16x16x32_bf16 v[52:55], v[216:219], v[172:175], v[52:55]
    ds_read_b64_tr_b16 v[212:213], v118 offset:128
    v_mfma_f32_16x16x32_bf16 v[108:111], v[216:219], v[176:179], v[108:111]
    ds_read_b64_tr_b16 v[214:215], v118 offset:3712
    s_waitcnt lgkmcnt(11)
    v_mfma_f32_16x16x32_bf16 v[56:59], v[220:223], v[172:175], v[56:59]
    ds_read_b64_tr_b16 v[216:217], v118 offset:160
    v_mfma_f32_16x16x32_bf16 v[112:115], v[220:223], v[176:179], v[112:115]
    ds_read_b64_tr_b16 v[218:219], v118 offset:3744
    v_add_u32 v117, 57344, v119
    s_waitcnt vmcnt(10) lgkmcnt(10)
    v_mfma_f32_16x16x32_bf16 v[4:7], v[196:199], v[180:183], v[4:7]
    ds_read_b64_tr_b16 v[220:221], v118 offset:192
    v_mfma_f32_16x16x32_bf16 v[60:63], v[196:199], v[184:187], v[60:63]
    ds_read_b64_tr_b16 v[222:223], v118 offset:3776
    s_waitcnt lgkmcnt(10)
    v_mfma_f32_16x16x32_bf16 v[8:11], v[200:203], v[180:183], v[8:11]
    ds_read_b64_tr_b16 v[196:197], v118 offset:7168
    v_mfma_f32_16x16x32_bf16 v[64:67], v[200:203], v[184:187], v[64:67]
    ds_read_b64_tr_b16 v[198:199], v118 offset:10752
    s_waitcnt lgkmcnt(10)
    v_mfma_f32_16x16x32_bf16 v[12:15], v[204:207], v[180:183], v[12:15]
    ds_read_b64_tr_b16 v[200:201], v118 offset:7200
    v_mfma_f32_16x16x32_bf16 v[68:71], v[204:207], v[184:187], v[68:71]
    ds_read_b64_tr_b16 v[202:203], v118 offset:10784
    s_waitcnt lgkmcnt(10)
    v_mfma_f32_16x16x32_bf16 v[16:19], v[208:211], v[180:183], v[16:19]
    ds_read_b64_tr_b16 v[204:205], v118 offset:7232
    v_mfma_f32_16x16x32_bf16 v[72:75], v[208:211], v[184:187], v[72:75]
    ds_read_b64_tr_b16 v[206:207], v118 offset:10816
    s_waitcnt lgkmcnt(10)
    v_mfma_f32_16x16x32_bf16 v[20:23], v[212:215], v[180:183], v[20:23]
    ds_read_b64_tr_b16 v[208:209], v118 offset:7264
    v_mfma_f32_16x16x32_bf16 v[76:79], v[212:215], v[184:187], v[76:79]
    ds_read_b64_tr_b16 v[210:211], v118 offset:10848
    s_waitcnt lgkmcnt(10)
    v_mfma_f32_16x16x32_bf16 v[24:27], v[216:219], v[180:183], v[24:27]
    ds_read_b64_tr_b16 v[212:213], v118 offset:7296
    v_mfma_f32_16x16x32_bf16 v[80:83], v[216:219], v[184:187], v[80:83]
    ds_read_b64_tr_b16 v[214:215], v118 offset:10880
    s_waitcnt lgkmcnt(10)
    v_mfma_f32_16x16x32_bf16 v[28:31], v[220:223], v[180:183], v[28:31]
    ds_read_b64_tr_b16 v[216:217], v118 offset:7328
    v_mfma_f32_16x16x32_bf16 v[84:87], v[220:223], v[184:187], v[84:87]
    ds_read_b64_tr_b16 v[218:219], v118 offset:10912
    s_waitcnt lgkmcnt(10)
    v_mfma_f32_16x16x32_bf16 v[32:35], v[196:199], v[180:183], v[32:35]
    ds_read_b64_tr_b16 v[220:221], v118 offset:7360
    v_mfma_f32_16x16x32_bf16 v[88:91], v[196:199], v[184:187], v[88:91]
    ds_read_b64_tr_b16 v[222:223], v118 offset:10944
    s_waitcnt lgkmcnt(10)
    v_mfma_f32_16x16x32_bf16 v[36:39], v[200:203], v[180:183], v[36:39]
    ds_read_b64_tr_b16 v[196:197], v118 offset:14336
    v_mfma_f32_16x16x32_bf16 v[92:95], v[200:203], v[184:187], v[92:95]
    ds_read_b64_tr_b16 v[198:199], v118 offset:17920
    s_waitcnt lgkmcnt(10)
    v_mfma_f32_16x16x32_bf16 v[40:43], v[204:207], v[180:183], v[40:43]
    ds_read_b64_tr_b16 v[200:201], v118 offset:14368
    v_mfma_f32_16x16x32_bf16 v[96:99], v[204:207], v[184:187], v[96:99]
    ds_read_b64_tr_b16 v[202:203], v118 offset:17952
    s_waitcnt lgkmcnt(10)
    v_mfma_f32_16x16x32_bf16 v[44:47], v[208:211], v[180:183], v[44:47]
    ds_read_b64_tr_b16 v[204:205], v118 offset:14400
    v_mfma_f32_16x16x32_bf16 v[100:103], v[208:211], v[184:187], v[100:103]
    ds_read_b64_tr_b16 v[206:207], v118 offset:17984
    s_waitcnt lgkmcnt(10)
    v_mfma_f32_16x16x32_bf16 v[48:51], v[212:215], v[180:183], v[48:51]
    ds_read_b64 v[252:253], v254 offset:1024
    ds_read_b64_tr_b16 v[208:209], v118 offset:14432
    v_mfma_f32_16x16x32_bf16 v[104:107], v[212:215], v[184:187], v[104:107]
    ds_read_b64_tr_b16 v[210:211], v118 offset:18016
    s_waitcnt lgkmcnt(11)
    v_mfma_f32_16x16x32_bf16 v[52:55], v[216:219], v[180:183], v[52:55]
    ds_read_b64_tr_b16 v[212:213], v118 offset:14464
    v_mfma_f32_16x16x32_bf16 v[108:111], v[216:219], v[184:187], v[108:111]
    ds_read_b64_tr_b16 v[214:215], v118 offset:18048
    s_waitcnt lgkmcnt(11)
    v_mfma_f32_16x16x32_bf16 v[56:59], v[220:223], v[180:183], v[56:59]
    ds_read_b64_tr_b16 v[216:217], v118 offset:14496
    v_mfma_f32_16x16x32_bf16 v[112:115], v[220:223], v[184:187], v[112:115]
    ds_read_b64_tr_b16 v[218:219], v118 offset:18080
    s_waitcnt vmcnt(8) lgkmcnt(11)
    v_mfma_f32_16x16x32_bf16 v[4:7], v[196:199], v[188:191], v[4:7]
    ds_read_b64_tr_b16 v[220:221], v118 offset:14528
    v_mfma_f32_16x16x32_bf16 v[60:63], v[196:199], v[192:195], v[60:63]
    ds_read_b64_tr_b16 v[222:223], v118 offset:18112
    s_waitcnt lgkmcnt(11)
    v_mfma_f32_16x16x32_bf16 v[8:11], v[200:203], v[188:191], v[8:11]
    ds_read_b64_tr_b16 v[196:197], v118 offset:21504
    v_mfma_f32_16x16x32_bf16 v[64:67], v[200:203], v[192:195], v[64:67]
    ds_read_b64_tr_b16 v[198:199], v118 offset:25088
    s_waitcnt lgkmcnt(11)
    v_mfma_f32_16x16x32_bf16 v[12:15], v[204:207], v[188:191], v[12:15]
    ds_read_b64_tr_b16 v[200:201], v118 offset:21536
    v_mfma_f32_16x16x32_bf16 v[68:71], v[204:207], v[192:195], v[68:71]
    ds_read_b64_tr_b16 v[202:203], v118 offset:25120
    s_waitcnt lgkmcnt(10)
    v_mfma_f32_16x16x32_bf16 v[16:19], v[208:211], v[188:191], v[16:19]
    ds_read_b64_tr_b16 v[204:205], v118 offset:21568
    v_mfma_f32_16x16x32_bf16 v[72:75], v[208:211], v[192:195], v[72:75]
    ds_read_b64_tr_b16 v[206:207], v118 offset:25152
    s_waitcnt lgkmcnt(10)
    v_mfma_f32_16x16x32_bf16 v[20:23], v[212:215], v[188:191], v[20:23]
    ds_read_b64_tr_b16 v[208:209], v118 offset:21600
    v_mfma_f32_16x16x32_bf16 v[76:79], v[212:215], v[192:195], v[76:79]
    ds_read_b64_tr_b16 v[210:211], v118 offset:25184
    s_waitcnt lgkmcnt(10)
    v_mfma_f32_16x16x32_bf16 v[24:27], v[216:219], v[188:191], v[24:27]
    v_min_u32 v252, v252, v253
    ds_read_b64_tr_b16 v[212:213], v118 offset:21632
    v_mfma_f32_16x16x32_bf16 v[80:83], v[216:219], v[192:195], v[80:83]
    ds_read_b64_tr_b16 v[214:215], v118 offset:25216
    s_waitcnt lgkmcnt(10)
    v_mfma_f32_16x16x32_bf16 v[28:31], v[220:223], v[188:191], v[28:31]
    v_readfirstlane_b32 s92, v252
    ds_read_b64_tr_b16 v[216:217], v118 offset:21664
    v_mfma_f32_16x16x32_bf16 v[84:87], v[220:223], v[192:195], v[84:87]
    ds_read_b64_tr_b16 v[218:219], v118 offset:25248
    s_waitcnt lgkmcnt(10)
    v_mfma_f32_16x16x32_bf16 v[32:35], v[196:199], v[188:191], v[32:35]
    s_cmp_lt_u32 s92, 30
    s_cbranch_scc1 SP_46s
OK_45:
    ds_read_b64_tr_b16 v[220:221], v118 offset:21696
    v_mfma_f32_16x16x32_bf16 v[88:91], v[196:199], v[192:195], v[88:91]
    ds_read_b64_tr_b16 v[222:223], v118 offset:25280
    s_waitcnt lgkmcnt(10)
    v_mfma_f32_16x16x32_bf16 v[36:39], v[200:203], v[188:191], v[36:39]
    v_add_u32 v251, 1, v251
    ds_write_b32 v250, v251
    ds_read_b64_tr_b16 v[196:197], v117 offset:0
    v_mfma_f32_16x16x32_bf16 v[92:95], v[200:203], v[192:195], v[92:95]
    ds_read_b64_tr_b16 v[198:199], v117 offset:3584
    s_waitcnt lgkmcnt(11)
    v_mfma_f32_16x16x32_bf16 v[40:43], v[204:207], v[188:191], v[40:43]
    ds_read_b64_tr_b16 v[200:201], v117 offset:32
    v_mfma_f32_16x16x32_bf16 v[96:99], v[204:207], v[192:195], v[96:99]
    ds_read_b64_tr_b16 v[202:203], v117 offset:3616
    s_waitcnt lgkmcnt(11)
    v_mfma_f32_16x16x32_bf16 v[44:47], v[208:211], v[188:191], v[44:47]
    ds_read_b64_tr_b16 v[204:205], v117 offset:64
    v_mfma_f32_16x16x32_bf16 v[100:103], v[208:211], v[192:195], v[100:103]
    ds_read_b64_tr_b16 v[206:207], v117 offset:3648
    s_waitcnt lgkmcnt(11)
    v_mfma_f32_16x16x32_bf16 v[48:51], v[212:215], v[188:191], v[48:51]
    ds_read_b64_tr_b16 v[208:209], v117 offset:96
    v_mfma_f32_16x16x32_bf16 v[104:107], v[212:215], v[192:195], v[104:107]
    ds_read_b64_tr_b16 v[210:211], v117 offset:3680
    s_waitcnt lgkmcnt(11)
    v_mfma_f32_16x16x32_bf16 v[52:55], v[216:219], v[188:191], v[52:55]
    ds_read_b64_tr_b16 v[212:213], v117 offset:128
    v_mfma_f32_16x16x32_bf16 v[108:111], v[216:219], v[192:195], v[108:111]
    ds_read_b64_tr_b16 v[214:215], v117 offset:3712
    s_waitcnt lgkmcnt(11)
    v_mfma_f32_16x16x32_bf16 v[56:59], v[220:223], v[188:191], v[56:59]
    ds_read_b64_tr_b16 v[216:217], v117 offset:160
    v_mfma_f32_16x16x32_bf16 v[112:115], v[220:223], v[192:195], v[112:115]
    ds_read_b64_tr_b16 v[218:219], v117 offset:3744
    v_add_u32 v118, 86016, v119
    s_waitcnt vmcnt(6) lgkmcnt(10)
    v_mfma_f32_16x16x32_bf16 v[4:7], v[196:199], v[132:135], v[4:7]
    ds_read_b64_tr_b16 v[220:221], v117 offset:192
    v_mfma_f32_16x16x32_bf16 v[60:63], v[196:199], v[136:139], v[60:63]
    ds_read_b64_tr_b16 v[222:223], v117 offset:3776
    s_waitcnt lgkmcnt(10)
    v_mfma_f32_16x16x32_bf16 v[8:11], v[200:203], v[132:135], v[8:11]
    ds_read_b64_tr_b16 v[196:197], v117 offset:7168
    v_mfma_f32_16x16x32_bf16 v[64:67], v[200:203], v[136:139], v[64:67]
    ds_read_b64_tr_b16 v[198:199], v117 offset:10752
    s_waitcnt lgkmcnt(10)
    v_mfma_f32_16x16x32_bf16 v[12:15], v[204:207], v[132:135], v[12:15]
    ds_read_b64_tr_b16 v[200:201], v117 offset:7200
    v_mfma_f32_16x16x32_bf16 v[68:71], v[204:207], v[136:139], v[68:71]
    ds_read_b64_tr_b16 v[202:203], v117 offset:10784
    s_waitcnt lgkmcnt(10)
    v_mfma_f32_16x16x32_bf16 v[16:19], v[208:211], v[132:135], v[16:19]
    ds_read_b64_tr_b16 v[204:205], v117 offset:7232
    v_mfma_f32_16x16x32_bf16 v[72:75], v[208:211], v[136:139], v[72:75]
    ds_read_b64_tr_b16 v[206:207], v117 offset:10816
    s_waitcnt lgkmcnt(10)
    v_mfma_f32_16x16x32_bf16 v[20:23], v[212:215], v[132:135], v[20:23]
    ds_read_b64_tr_b16 v[208:209], v117 offset:7264
    v_mfma_f32_16x16x32_bf16 v[76:79], v[212:215], v[136:139], v[76:79]
    ds_read_b64_tr_b16 v[210:211], v117 offset:10848
    s_waitcnt lgkmcnt(10)
    v_mfma_f32_16x16x32_bf16 v[24:27], v[216:219], v[132:135], v[24:27]
    ds_read_b64_tr_b16 v[212:213], v117 offset:7296
    v_mfma_f32_16x16x32_bf16 v[80:83], v[216:219], v[136:139], v[80:83]
    ds_read_b64_tr_b16 v[214:215], v117 offset:10880
    s_waitcnt lgkmcnt(10)
    v_mfma_f32_16x16x32_bf16 v[28:31], v[220:223], v[132:135], v[28:31]
    ds_read_b64_tr_b16 v[216:217], v117 offset:7328
    v_mfma_f32_16x16x32_bf16 v[84:87], v[220:223], v[136:139], v[84:87]
    ds_read_b64_tr_b16 v[218:219], v117 offset:10912
    s_waitcnt lgkmcnt(10)
    v_mfma_f32_16x16x32_bf16 v[32:35], v[196:199], v[132:135], v[32:35]
    ds_read_b64_tr_b16 v[220:221], v117 offset:7360
    v_mfma_f32_16x16x32_bf16 v[88:91], v[196:199], v[136:139], v[88:91]
    ds_read_b64_tr_b16 v[222:223], v117 offset:10944
    s_waitcnt lgkmcnt(10)
    v_mfma_f32_16x16x32_bf16 v[36:39], v[200:203], v[132:135], v[36:39]
    ds_read_b64_tr_b16 v[196:197], v117 offset:14336
    v_mfma_f32_16x16x32_bf16 v[92:95], v[200:203], v[136:139], v[92:95]
    ds_read_b64_tr_b16 v[198:199], v117 offset:17920
    s_waitcnt lgkmcnt(10)
    v_mfma_f32_16x16x32_bf16 v[40:43], v[204:207], v[132:135], v[40:43]
    ds_read_b64_tr_b16 v[200:201], v117 offset:14368
    v_mfma_f32_16x16x32_bf16 v[96:99], v[204:207], v[136:139], v[96:99]
    ds_read_b64_tr_b16 v[202:203], v117 offset:17952
    s_waitcnt lgkmcnt(10)
    v_mfma_f32_16x16x32_bf16 v[44:47], v[208:211], v[132:135], v[44:47]
    ds_read_b64_tr_b16 v[204:205], v117 offset:14400
    v_mfma_f32_16x16x32_bf16 v[100:103], v[208:211], v[136:139], v[100:103]
    ds_read_b64_tr_b16 v[206:207], v117 offset:17984
    s_waitcnt lgkmcnt(10)
    v_mfma_f32_16x16x32_bf16 v[48:51], v[212:215], v[132:135], v[48:51]
    ds_read_b64 v[252:253], v254 offset:1024
    ds_read_b64_tr_b16 v[208:209], v117 offset:14432
    v_mfma_f32_16x16x32_bf16 v[104:107], v[212:215], v[136:139], v[104:107]
    ds_read_b64_tr_b16 v[210:211], v117 offset:18016
    s_waitcnt lgkmcnt(11)
    v_mfma_f32_16x16x32_bf16 v[52:55], v[216:219], v[132:135], v[52:55]
    ds_read_b64_tr_b16 v[212:213], v117 offset:14464
    v_mfma_f32_16x16x32_bf16 v[108:111], v[216:219], v[136:139], v[108:111]
    ds_read_b64_tr_b16 v[214:215], v117 offset:18048
    s_waitcnt lgkmcnt(11)
    v_mfma_f32_16x16x32_bf16 v[56:59], v[220:223], v[132:135], v[56:59]
    ds_read_b64_tr_b16 v[216:217], v117 offset:14496
    v_mfma_f32_16x16x32_bf16 v[112:115], v[220:223], v[136:139], v[112:115]
    ds_read_b64_tr_b16 v[218:219], v117 offset:18080
    s_waitcnt vmcnt(4) lgkmcnt(11)
    v_mfma_f32_16x16x32_bf16 v[4:7], v[196:199], v[140:143], v[4:7]
    ds_read_b64_tr_b16 v[220:221], v117 offset:14528
    v_mfma_f32_16x16x32_bf16 v[60:63], v[196:199], v[144:147], v[60:63]
    ds_read_b64_tr_b16 v[222:223], v117 offset:18112
    s_waitcnt lgkmcnt(11)
    v_mfma_f32_16x16x32_bf16 v[8:11], v[200:203], v[140:143], v[8:11]
    ds_read_b64_tr_b16 v[196:197], v117 offset:21504
    v_mfma_f32_16x16x32_bf16 v[64:67], v[200:203], v[144:147], v[64:67]
    ds_read_b64_tr_b16 v[198:199], v117 offset:25088
    s_waitcnt lgkmcnt(11)
    v_mfma_f32_16x16x32_bf16 v[12:15], v[204:207], v[140:143], v[12:15]
    ds_read_b64_tr_b16 v[200:201], v117 offset:21536
    v_mfma_f32_16x16x32_bf16 v[68:71], v[204:207], v[144:147], v[68:71]
    ds_read_b64_tr_b16 v[202:203], v117 offset:25120
    s_waitcnt lgkmcnt(10)
    v_mfma_f32_16x16x32_bf16 v[16:19], v[208:211], v[140:143], v[16:19]
    ds_read_b64_tr_b16 v[204:205], v117 offset:21568
    v_mfma_f32_16x16x32_bf16 v[72:75], v[208:211], v[144:147], v[72:75]
    ds_read_b64_tr_b16 v[206:207], v117 offset:25152
    s_waitcnt lgkmcnt(10)
    v_mfma_f32_16x16x32_bf16 v[20:23], v[212:215], v[140:143], v[20:23]
    ds_read_b64_tr_b16 v[208:209], v117 offset:21600
    v_mfma_f32_16x16x32_bf16 v[76:79], v[212:215], v[144:147], v[76:79]
    ds_read_b64_tr_b16 v[210:211], v117 offset:25184
    s_waitcnt lgkmcnt(10)
    v_mfma_f32_16x16x32_bf16 v[24:27], v[216:219], v[140:143], v[24:27]
    v_min_u32 v252, v252, v253
    ds_read_b64_tr_b16 v[212:213], v117 offset:21632
    v_mfma_f32_16x16x32_bf16 v[80:83], v[216:219], v[144:147], v[80:83]
    ds_read_b64_tr_b16 v[214:215], v117 offset:25216
    s_waitcnt lgkmcnt(10)
    v_mfma_f32_16x16x32_bf16 v[28:31], v[220:223], v[140:143], v[28:31]
    v_readfirstlane_b32 s92, v252
    ds_read_b64_tr_b16 v[216:217], v117 offset:21664
    v_mfma_f32_16x16x32_bf16 v[84:87], v[220:223], v[144:147], v[84:87]
    ds_read_b64_tr_b16 v[218:219], v117 offset:25248
    s_waitcnt lgkmcnt(10)
    v_mfma_f32_16x16x32_bf16 v[32:35], v[196:199], v[140:143], v[32:35]
    s_cmp_lt_u32 s92, 31
    s_cbranch_scc1 SP_48s
OK_47:
    ds_read_b64_tr_b16 v[220:221], v117 offset:21696
    v_mfma_f32_16x16x32_bf16 v[88:91], v[196:199], v[144:147], v[88:91]
    ds_read_b64_tr_b16 v[222:223], v117 offset:25280
    s_waitcnt lgkmcnt(10)
    v_mfma_f32_16x16x32_bf16 v[36:39], v[200:203], v[140:143], v[36:39]
    v_add_u32 v251, 1, v251
    ds_write_b32 v250, v251
    ds_read_b64_tr_b16 v[196:197], v118 offset:0
    v_mfma_f32_16x16x32_bf16 v[92:95], v[200:203], v[144:147], v[92:95]
    ds_read_b64_tr_b16 v[198:199], v118 offset:3584
    s_waitcnt lgkmcnt(11)
    v_mfma_f32_16x16x32_bf16 v[40:43], v[204:207], v[140:143], v[40:43]
    ds_read_b64_tr_b16 v[200:201], v118 offset:32
    v_mfma_f32_16x16x32_bf16 v[96:99], v[204:207], v[144:147], v[96:99]
    ds_read_b64_tr_b16 v[202:203], v118 offset:3616
    s_waitcnt lgkmcnt(11)
    v_mfma_f32_16x16x32_bf16 v[44:47], v[208:211], v[140:143], v[44:47]
    ds_read_b64_tr_b16 v[204:205], v118 offset:64
    v_mfma_f32_16x16x32_bf16 v[100:103], v[208:211], v[144:147], v[100:103]
    ds_read_b64_tr_b16 v[206:207], v118 offset:3648
    s_waitcnt lgkmcnt(11)
    v_mfma_f32_16x16x32_bf16 v[48:51], v[212:215], v[140:143], v[48:51]
    ds_read_b64_tr_b16 v[208:209], v118 offset:96
    v_mfma_f32_16x16x32_bf16 v[104:107], v[212:215], v[144:147], v[104:107]
    ds_read_b64_tr_b16 v[210:211], v118 offset:3680
    s_waitcnt lgkmcnt(11)
    v_mfma_f32_16x16x32_bf16 v[52:55], v[216:219], v[140:143], v[52:55]
    ds_read_b64_tr_b16 v[212:213], v118 offset:128
    v_mfma_f32_16x16x32_bf16 v[108:111], v[216:219], v[144:147], v[108:111]
    ds_read_b64_tr_b16 v[214:215], v118 offset:3712
    s_waitcnt lgkmcnt(11)
    v_mfma_f32_16x16x32_bf16 v[56:59], v[220:223], v[140:143], v[56:59]
    ds_read_b64_tr_b16 v[216:217], v118 offset:160
    v_mfma_f32_16x16x32_bf16 v[112:115], v[220:223], v[144:147], v[112:115]
    ds_read_b64_tr_b16 v[218:219], v118 offset:3744
    s_waitcnt vmcnt(2) lgkmcnt(10)
    v_mfma_f32_16x16x32_bf16 v[4:7], v[196:199], v[148:151], v[4:7]
    ds_read_b64_tr_b16 v[220:221], v118 offset:192
    v_mfma_f32_16x16x32_bf16 v[60:63], v[196:199], v[152:155], v[60:63]
    ds_read_b64_tr_b16 v[222:223], v118 offset:3776
    s_waitcnt lgkmcnt(10)
    v_mfma_f32_16x16x32_bf16 v[8:11], v[200:203], v[148:151], v[8:11]
    ds_read_b64_tr_b16 v[196:197], v118 offset:7168
    v_mfma_f32_16x16x32_bf16 v[64:67], v[200:203], v[152:155], v[64:67]
    ds_read_b64_tr_b16 v[198:199], v118 offset:10752
    v_lshrrev_b32 v1, 5, v0
    v_lshlrev_b32 v1, 8, v1
    v_and_b32 v224, 15, v0
    v_lshl_add_u32 v224, v224, 4, v1
    s_waitcnt lgkmcnt(10)
    v_mfma_f32_16x16x32_bf16 v[12:15], v[204:207], v[148:151], v[12:15]
    ds_read_b64_tr_b16 v[200:201], v118 offset:7200
    v_mfma_f32_16x16x32_bf16 v[68:71], v[204:207], v[152:155], v[68:71]
    ds_read_b64_tr_b16 v[202:203], v118 offset:10784
    s_waitcnt lgkmcnt(10)
    v_mfma_f32_16x16x32_bf16 v[16:19], v[208:211], v[148:151], v[16:19]
    ds_read_b64_tr_b16 v[204:205], v118 offset:7232
    v_mfma_f32_16x16x32_bf16 v[72:75], v[208:211], v[152:155], v[72:75]
    ds_read_b64_tr_b16 v[206:207], v118 offset:10816
    v_lshrrev_b32 v1, 4, v0
    v_lshlrev_b32 v1, 4, v1
    s_waitcnt lgkmcnt(10)
    v_mfma_f32_16x16x32_bf16 v[20:23], v[212:215], v[148:151], v[20:23]
    ds_read_b64_tr_b16 v[208:209], v118 offset:7264
    v_mfma_f32_16x16x32_bf16 v[76:79], v[212:215], v[152:155], v[76:79]
    ds_read_b64_tr_b16 v[210:211], v118 offset:10848
    v_add_u32 v1, 143360, v1
    s_mul_i32 s47, s46, 55296
    s_add_u32 s47, s47, 0x500000
    s_add_u32 s48, s47, 55296
    s_lshr_b32 s53, s42, 1
    s_and_b32 s52, s42, 1
    s_waitcnt lgkmcnt(10)
    v_mfma_f32_16x16x32_bf16 v[24:27], v[216:219], v[148:151], v[24:27]
    ds_read_b64_tr_b16 v[212:213], v118 offset:7296
    v_mfma_f32_16x16x32_bf16 v[80:83], v[216:219], v[152:155], v[80:83]
    ds_read_b64_tr_b16 v[214:215], v118 offset:10880
    ds_read_b32 v252, v254 offset:1036
    s_waitcnt lgkmcnt(11)
    v_mfma_f32_16x16x32_bf16 v[28:31], v[220:223], v[148:151], v[28:31]
    ds_read_b64_tr_b16 v[216:217], v118 offset:7328
    v_mfma_f32_16x16x32_bf16 v[84:87], v[220:223], v[152:155], v[84:87]
    ds_read_b64_tr_b16 v[218:219], v118 offset:10912
    s_waitcnt lgkmcnt(11)
    v_mfma_f32_16x16x32_bf16 v[32:35], v[196:199], v[148:151], v[32:35]
    ds_read_b64_tr_b16 v[220:221], v118 offset:7360
    v_mfma_f32_16x16x32_bf16 v[88:91], v[196:199], v[152:155], v[88:91]
    ds_read_b64_tr_b16 v[222:223], v118 offset:10944
    v_add_u32 v120, s47, v116
    v_add_u32 v121, s48, v116
    s_lshl_b32 s60, s42, 11
    s_add_u32 s61, s60, 1024
    s_mul_i32 s63, s53, 3072
    s_waitcnt lgkmcnt(11)
    v_mfma_f32_16x16x32_bf16 v[36:39], v[200:203], v[148:151], v[36:39]
    ds_read_b64_tr_b16 v[196:197], v118 offset:14336
    v_mfma_f32_16x16x32_bf16 v[92:95], v[200:203], v[152:155], v[92:95]
    ds_read_b64_tr_b16 v[198:199], v118 offset:17920
    v_add_u32 v119, s47, v224
    v_add_u32 v2, s48, v224
    s_lshl_b32 s62, s52, 11
    s_add_u32 s62, s62, s63
    s_add_u32 s62, s62, 31744
    s_waitcnt lgkmcnt(11)
    v_mfma_f32_16x16x32_bf16 v[40:43], v[204:207], v[148:151], v[40:43]
    ds_read_b64_tr_b16 v[200:201], v118 offset:14368
    v_mfma_f32_16x16x32_bf16 v[96:99], v[204:207], v[152:155], v[96:99]
    ds_read_b64_tr_b16 v[202:203], v118 offset:17952
    s_lshl_b32 s52, s52, 9
    s_add_u32 s63, s63, s52
    s_add_u32 s63, s63, 32768
    s_cmp_eq_u32 s42, 15
    s_cselect_b32 s61, 0x7f000000, s61
    s_cselect_b32 s62, 0x7f000000, s62
    s_waitcnt lgkmcnt(11)
    v_mfma_f32_16x16x32_bf16 v[44:47], v[208:211], v[148:151], v[44:47]
    ds_read_b64_tr_b16 v[204:205], v118 offset:14400
    v_mfma_f32_16x16x32_bf16 v[100:103], v[208:211], v[152:155], v[100:103]
    ds_read_b64_tr_b16 v[206:207], v118 offset:17984
    s_waitcnt lgkmcnt(11)
    v_mfma_f32_16x16x32_bf16 v[48:51], v[212:215], v[148:151], v[48:51]
    ds_read_b64_tr_b16 v[208:209], v118 offset:14432
    v_mfma_f32_16x16x32_bf16 v[104:107], v[212:215], v[152:155], v[104:107]
    ds_read_b64_tr_b16 v[210:211], v118 offset:18016
    s_waitcnt lgkmcnt(12)
    s_waitcnt lgkmcnt(10)
    v_mfma_f32_16x16x32_bf16 v[52:55], v[216:219], v[148:151], v[52:55]
    ds_read_b64_tr_b16 v[212:213], v118 offset:14464
    v_mfma_f32_16x16x32_bf16 v[108:111], v[216:219], v[152:155], v[108:111]
    ds_read_b64_tr_b16 v[214:215], v118 offset:18048
    v_readfirstlane_b32 s92, v252
    s_waitcnt lgkmcnt(10)
    v_mfma_f32_16x16x32_bf16 v[56:59], v[220:223], v[148:151], v[56:59]
    ds_read_b64_tr_b16 v[216:217], v118 offset:14496
    v_mfma_f32_16x16x32_bf16 v[112:115], v[220:223], v[152:155], v[112:115]
    ds_read_b64_tr_b16 v[218:219], v118 offset:18080
    s_cmp_lt_u32 s92, 2
    s_cbranch_scc1 SP_50s
OK_49:
    s_waitcnt vmcnt(0) lgkmcnt(10)
    v_mfma_f32_16x16x32_bf16 v[4:7], v[196:199], v[156:159], v[4:7]
    ds_read_b64_tr_b16 v[220:221], v118 offset:14528
    v_mfma_f32_16x16x32_bf16 v[60:63], v[196:199], v[160:163], v[60:63]
    ds_read_b64_tr_b16 v[222:223], v118 offset:18112
    ds_read_b128 v[164:167], v1 offset:0
    s_waitcnt lgkmcnt(11)
    v_mfma_f32_16x16x32_bf16 v[8:11], v[200:203], v[156:159], v[8:11]
    ds_read_b64_tr_b16 v[196:197], v118 offset:21504
    v_mfma_f32_16x16x32_bf16 v[64:67], v[200:203], v[160:163], v[64:67]
    ds_read_b64_tr_b16 v[198:199], v118 offset:25088
    ds_read_b128 v[192:195], v1 offset:448
    s_waitcnt lgkmcnt(12)
    v_mfma_f32_16x16x32_bf16 v[12:15], v[204:207], v[156:159], v[12:15]
    ds_read_b64_tr_b16 v[200:201], v118 offset:21536
    v_mfma_f32_16x16x32_bf16 v[68:71], v[204:207], v[160:163], v[68:71]
    ds_read_b64_tr_b16 v[202:203], v118 offset:25120
    ds_read_b128 v[168:171], v1 offset:64
    s_waitcnt lgkmcnt(13)
    v_mfma_f32_16x16x32_bf16 v[16:19], v[208:211], v[156:159], v[16:19]
    ds_read_b64_tr_b16 v[204:205], v118 offset:21568
    v_mfma_f32_16x16x32_bf16 v[72:75], v[208:211], v[160:163], v[72:75]
    ds_read_b64_tr_b16 v[206:207], v118 offset:25152
    ds_read_b128 v[132:135], v1 offset:512
    s_waitcnt lgkmcnt(14)
    v_mfma_f32_16x16x32_bf16 v[20:23], v[212:215], v[156:159], v[20:23]
    ds_read_b64_tr_b16 v[208:209], v118 offset:21600
    v_mfma_f32_16x16x32_bf16 v[76:79], v[212:215], v[160:163], v[76:79]
    ds_read_b64_tr_b16 v[210:211], v118 offset:25184
    ds_read_b128 v[172:175], v1 offset:128
    s_waitcnt lgkmcnt(15)
    v_mfma_f32_16x16x32_bf16 v[24:27], v[216:219], v[156:159], v[24:27]
    ds_read_b64_tr_b16 v[212:213], v118 offset:21632
    v_mfma_f32_16x16x32_bf16 v[80:83], v[216:219], v[160:163], v[80:83]
    ds_read_b64_tr_b16 v[214:215], v118 offset:25216
    ds_read_b128 v[136:139], v1 offset:576
    s_waitcnt lgkmcnt(15)
    v_mfma_f32_16x16x32_bf16 v[28:31], v[220:223], v[156:159], v[28:31]
    ds_read_b64_tr_b16 v[216:217], v118 offset:21664
    v_mfma_f32_16x16x32_bf16 v[84:87], v[220:223], v[160:163], v[84:87]
    ds_read_b64_tr_b16 v[218:219], v118 offset:25248
    ds_read_b128 v[176:179], v1 offset:192
    s_waitcnt lgkmcnt(15)
    v_mfma_f32_16x16x32_bf16 v[32:35], v[196:199], v[156:159], v[32:35]
    ds_read_b64_tr_b16 v[220:221], v118 offset:21696
    v_mfma_f32_16x16x32_bf16 v[88:91], v[196:199], v[160:163], v[88:91]
    ds_read_b64_tr_b16 v[222:223], v118 offset:25280
    ds_read_b128 v[140:143], v1 offset:640
    s_waitcnt lgkmcnt(15)
    v_mfma_f32_16x16x32_bf16 v[36:39], v[200:203], v[156:159], v[36:39]
    v_add_u32 v251, 1, v251
    ds_write_b32 v250, v251
    v_mfma_f32_16x16x32_bf16 v[92:95], v[200:203], v[160:163], v[92:95]
    ds_read_b128 v[180:183], v1 offset:256
    s_waitcnt lgkmcnt(15)
    v_mfma_f32_16x16x32_bf16 v[40:43], v[204:207], v[156:159], v[40:43]
    v_mfma_f32_16x16x32_bf16 v[96:99], v[204:207], v[160:163], v[96:99]
    ds_read_b128 v[144:147], v1 offset:704
    s_waitcnt lgkmcnt(13)
    v_mfma_f32_16x16x32_bf16 v[44:47], v[208:211], v[156:159], v[44:47]
    v_mfma_f32_16x16x32_bf16 v[100:103], v[208:211], v[160:163], v[100:103]
    ds_read_b128 v[184:187], v1 offset:320
    s_waitcnt lgkmcnt(11)
    v_mfma_f32_16x16x32_bf16 v[48:51], v[212:215], v[156:159], v[48:51]
    v_mfma_f32_16x16x32_bf16 v[104:107], v[212:215], v[160:163], v[104:107]
    ds_read_b128 v[148:151], v1 offset:768
    s_waitcnt lgkmcnt(9)
    v_mfma_f32_16x16x32_bf16 v[52:55], v[216:219], v[156:159], v[52:55]
    v_mfma_f32_16x16x32_bf16 v[108:111], v[216:219], v[160:163], v[108:111]
    ds_read_b128 v[188:191], v1 offset:384
    s_waitcnt lgkmcnt(7)
    v_mfma_f32_16x16x32_bf16 v[56:59], v[220:223], v[156:159], v[56:59]
    v_mfma_f32_16x16x32_bf16 v[112:115], v[220:223], v[160:163], v[112:115]
    ds_read_b128 v[152:155], v1 offset:832
    s_waitcnt lgkmcnt(0)
    v_pk_fma_f32 v[4:5], v[164:165], v[124:125], v[4:5] op_sel_hi:[1,0,1]
    v_pk_fma_f32 v[6:7], v[166:167], v[124:125], v[6:7] op_sel_hi:[1,0,1]
    v_pk_mul_f32 v[196:197], v[4:5], v[124:125] op_sel:[0,1]
    v_pk_mul_f32 v[198:199], v[6:7], v[124:125] op_sel:[0,1]
    v_exp_f32 v196, v196
    v_pk_fma_f32 v[32:33], v[192:193], v[124:125], v[32:33] op_sel_hi:[1,0,1]
    v_exp_f32 v197, v197
    v_pk_fma_f32 v[34:35], v[194:195], v[124:125], v[34:35] op_sel_hi:[1,0,1]
    v_exp_f32 v198, v198
    v_pk_mul_f32 v[4:5], v[4:5], v[32:33]
    v_exp_f32 v199, v199
    v_pk_mul_f32 v[6:7], v[6:7], v[34:35]
    v_pk_fma_f32 v[196:197], v[196:197], v[126:127], v[126:127] op_sel_hi:[1,0,0]
    v_pk_fma_f32 v[198:199], v[198:199], v[126:127], v[126:127] op_sel_hi:[1,0,0]
    v_rcp_f32 v196, v196
    v_pk_fma_f32 v[8:9], v[168:169], v[124:125], v[8:9] op_sel_hi:[1,0,1]
    v_rcp_f32 v197, v197
    v_pk_fma_f32 v[10:11], v[170:171], v[124:125], v[10:11] op_sel_hi:[1,0,1]
    v_rcp_f32 v198, v198
    v_pk_mul_f32 v[200:201], v[8:9], v[124:125] op_sel:[0,1]
    v_rcp_f32 v199, v199
    v_pk_mul_f32 v[202:203], v[10:11], v[124:125] op_sel:[0,1]
    v_pk_mul_f32 v[4:5], v[4:5], v[196:197]
    v_pk_mul_f32 v[6:7], v[6:7], v[198:199]
    v_cvt_pk_bf16_f32 v32, v4, v5
    v_cvt_pk_bf16_f32 v33, v6, v7
    v_exp_f32 v200, v200
    v_pk_fma_f32 v[36:37], v[132:133], v[124:125], v[36:37] op_sel_hi:[1,0,1]
    v_exp_f32 v201, v201
    v_pk_fma_f32 v[38:39], v[134:135], v[124:125], v[38:39] op_sel_hi:[1,0,1]
    v_exp_f32 v202, v202
    v_pk_mul_f32 v[8:9], v[8:9], v[36:37]
    v_exp_f32 v203, v203
    v_pk_mul_f32 v[10:11], v[10:11], v[38:39]
    v_pk_fma_f32 v[200:201], v[200:201], v[126:127], v[126:127] op_sel_hi:[1,0,0]
    v_pk_fma_f32 v[202:203], v[202:203], v[126:127], v[126:127] op_sel_hi:[1,0,0]
    v_rcp_f32 v200, v200
    v_pk_fma_f32 v[12:13], v[172:173], v[124:125], v[12:13] op_sel_hi:[1,0,1]
    v_rcp_f32 v201, v201
    v_pk_fma_f32 v[14:15], v[174:175], v[124:125], v[14:15] op_sel_hi:[1,0,1]
    v_rcp_f32 v202, v202
    v_pk_mul_f32 v[196:197], v[12:13], v[124:125] op_sel:[0,1]
    v_rcp_f32 v203, v203
    v_pk_mul_f32 v[198:199], v[14:15], v[124:125] op_sel:[0,1]
    v_pk_mul_f32 v[8:9], v[8:9], v[200:201]
    v_pk_mul_f32 v[10:11], v[10:11], v[202:203]
    v_cvt_pk_bf16_f32 v34, v8, v9
    v_cvt_pk_bf16_f32 v35, v10, v11
    buffer_store_dwordx4 v[32:35], v120, s[12:15], s60 offen sc1
    v_exp_f32 v196, v196
    v_pk_fma_f32 v[40:41], v[136:137], v[124:125], v[40:41] op_sel_hi:[1,0,1]
    v_exp_f32 v197, v197
    v_pk_fma_f32 v[42:43], v[138:139], v[124:125], v[42:43] op_sel_hi:[1,0,1]
    v_exp_f32 v198, v198
    v_pk_mul_f32 v[12:13], v[12:13], v[40:41]
    v_exp_f32 v199, v199
    v_pk_mul_f32 v[14:15], v[14:15], v[42:43]
    v_pk_fma_f32 v[196:197], v[196:197], v[126:127], v[126:127] op_sel_hi:[1,0,0]
    v_pk_fma_f32 v[198:199], v[198:199], v[126:127], v[126:127] op_sel_hi:[1,0,0]
    v_rcp_f32 v196, v196
    v_pk_fma_f32 v[16:17], v[176:177], v[124:125], v[16:17] op_sel_hi:[1,0,1]
    v_rcp_f32 v197, v197
    v_pk_fma_f32 v[18:19], v[178:179], v[124:125], v[18:19] op_sel_hi:[1,0,1]
    v_rcp_f32 v198, v198
    v_pk_mul_f32 v[200:201], v[16:17], v[124:125] op_sel:[0,1]
    v_rcp_f32 v199, v199
    v_pk_mul_f32 v[202:203], v[18:19], v[124:125] op_sel:[0,1]
    v_pk_mul_f32 v[12:13], v[12:13], v[196:197]
    v_pk_mul_f32 v[14:15], v[14:15], v[198:199]
    v_cvt_pk_bf16_f32 v40, v12, v13
    v_cvt_pk_bf16_f32 v41, v14, v15
    v_exp_f32 v200, v200
    v_pk_fma_f32 v[44:45], v[140:141], v[124:125], v[44:45] op_sel_hi:[1,0,1]
    v_exp_f32 v201, v201
    v_pk_fma_f32 v[46:47], v[142:143], v[124:125], v[46:47] op_sel_hi:[1,0,1]
    v_exp_f32 v202, v202
    v_pk_mul_f32 v[16:17], v[16:17], v[44:45]
    v_exp_f32 v203, v203
    v_pk_mul_f32 v[18:19], v[18:19], v[46:47]
    v_pk_fma_f32 v[200:201], v[200:201], v[126:127], v[126:127] op_sel_hi:[1,0,0]
    v_pk_fma_f32 v[202:203], v[202:203], v[126:127], v[126:127] op_sel_hi:[1,0,0]
    v_rcp_f32 v200, v200
    v_pk_fma_f32 v[60:61], v[164:165], v[128:129], v[60:61] op_sel_hi:[1,0,1]
    v_rcp_f32 v201, v201
    v_pk_fma_f32 v[62:63], v[166:167], v[128:129], v[62:63] op_sel_hi:[1,0,1]
    v_rcp_f32 v202, v202
    v_pk_mul_f32 v[196:197], v[60:61], v[128:129] op_sel:[0,1]
    v_rcp_f32 v203, v203
    v_pk_mul_f32 v[198:199], v[62:63], v[128:129] op_sel:[0,1]
    v_pk_mul_f32 v[16:17], v[16:17], v[200:201]
    v_pk_mul_f32 v[18:19], v[18:19], v[202:203]
    v_cvt_pk_bf16_f32 v42, v16, v17
    v_cvt_pk_bf16_f32 v43, v18, v19
    buffer_store_dwordx4 v[40:43], v120, s[12:15], s61 offen sc1
    v_exp_f32 v196, v196
    v_pk_fma_f32 v[88:89], v[192:193], v[128:129], v[88:89] op_sel_hi:[1,0,1]
    v_exp_f32 v197, v197
    v_pk_fma_f32 v[90:91], v[194:195], v[128:129], v[90:91] op_sel_hi:[1,0,1]
    v_exp_f32 v198, v198
    v_pk_mul_f32 v[60:61], v[60:61], v[88:89]
    v_exp_f32 v199, v199
    v_pk_mul_f32 v[62:63], v[62:63], v[90:91]
    v_pk_fma_f32 v[196:197], v[196:197], v[130:131], v[130:131] op_sel_hi:[1,0,0]
    v_pk_fma_f32 v[198:199], v[198:199], v[130:131], v[130:131] op_sel_hi:[1,0,0]
    v_rcp_f32 v196, v196
    v_pk_fma_f32 v[64:65], v[168:169], v[128:129], v[64:65] op_sel_hi:[1,0,1]
    v_rcp_f32 v197, v197
    v_pk_fma_f32 v[66:67], v[170:171], v[128:129], v[66:67] op_sel_hi:[1,0,1]
    v_rcp_f32 v198, v198
    v_pk_mul_f32 v[200:201], v[64:65], v[128:129] op_sel:[0,1]
    v_rcp_f32 v199, v199
    v_pk_mul_f32 v[202:203], v[66:67], v[128:129] op_sel:[0,1]
    v_pk_mul_f32 v[60:61], v[60:61], v[196:197]
    v_pk_mul_f32 v[62:63], v[62:63], v[198:199]
    v_cvt_pk_bf16_f32 v88, v60, v61
    v_cvt_pk_bf16_f32 v89, v62, v63
    v_exp_f32 v200, v200
    v_pk_fma_f32 v[92:93], v[132:133], v[128:129], v[92:93] op_sel_hi:[1,0,1]
    v_exp_f32 v201, v201
    v_pk_fma_f32 v[94:95], v[134:135], v[128:129], v[94:95] op_sel_hi:[1,0,1]
    v_exp_f32 v202, v202
    v_pk_mul_f32 v[64:65], v[64:65], v[92:93]
    v_exp_f32 v203, v203
    v_pk_mul_f32 v[66:67], v[66:67], v[94:95]
    v_pk_fma_f32 v[200:201], v[200:201], v[130:131], v[130:131] op_sel_hi:[1,0,0]
    v_pk_fma_f32 v[202:203], v[202:203], v[130:131], v[130:131] op_sel_hi:[1,0,0]
    v_rcp_f32 v200, v200
    v_pk_fma_f32 v[68:69], v[172:173], v[128:129], v[68:69] op_sel_hi:[1,0,1]
    v_rcp_f32 v201, v201
    v_pk_fma_f32 v[70:71], v[174:175], v[128:129], v[70:71] op_sel_hi:[1,0,1]
    v_rcp_f32 v202, v202
    v_pk_mul_f32 v[196:197], v[68:69], v[128:129] op_sel:[0,1]
    v_rcp_f32 v203, v203
    v_pk_mul_f32 v[198:199], v[70:71], v[128:129] op_sel:[0,1]
    v_pk_mul_f32 v[64:65], v[64:65], v[200:201]
    v_pk_mul_f32 v[66:67], v[66:67], v[202:203]
    v_cvt_pk_bf16_f32 v90, v64, v65
    v_cvt_pk_bf16_f32 v91, v66, v67
    buffer_store_dwordx4 v[88:91], v121, s[12:15], s60 offen sc1
    v_exp_f32 v196, v196
    v_pk_fma_f32 v[96:97], v[136:137], v[128:129], v[96:97] op_sel_hi:[1,0,1]
    v_exp_f32 v197, v197
    v_pk_fma_f32 v[98:99], v[138:139], v[128:129], v[98:99] op_sel_hi:[1,0,1]
    v_exp_f32 v198, v198
    v_pk_mul_f32 v[68:69], v[68:69], v[96:97]
    v_exp_f32 v199, v199
    v_pk_mul_f32 v[70:71], v[70:71], v[98:99]
    v_pk_fma_f32 v[196:197], v[196:197], v[130:131], v[130:131] op_sel_hi:[1,0,0]
    v_pk_fma_f32 v[198:199], v[198:199], v[130:131], v[130:131] op_sel_hi:[1,0,0]
    v_rcp_f32 v196, v196
    v_pk_fma_f32 v[72:73], v[176:177], v[128:129], v[72:73] op_sel_hi:[1,0,1]
    v_rcp_f32 v197, v197
    v_pk_fma_f32 v[74:75], v[178:179], v[128:129], v[74:75] op_sel_hi:[1,0,1]
    v_rcp_f32 v198, v198
    v_pk_mul_f32 v[200:201], v[72:73], v[128:129] op_sel:[0,1]
    v_rcp_f32 v199, v199
    v_pk_mul_f32 v[202:203], v[74:75], v[128:129] op_sel:[0,1]
    v_pk_mul_f32 v[68:69], v[68:69], v[196:197]
    v_pk_mul_f32 v[70:71], v[70:71], v[198:199]
    v_cvt_pk_bf16_f32 v96, v68, v69
    v_cvt_pk_bf16_f32 v97, v70, v71
    v_exp_f32 v200, v200
    v_pk_fma_f32 v[100:101], v[140:141], v[128:129], v[100:101] op_sel_hi:[1,0,1]
    v_exp_f32 v201, v201
    v_pk_fma_f32 v[102:103], v[142:143], v[128:129], v[102:103] op_sel_hi:[1,0,1]
    v_exp_f32 v202, v202
    v_pk_mul_f32 v[72:73], v[72:73], v[100:101]
    v_exp_f32 v203, v203
    v_pk_mul_f32 v[74:75], v[74:75], v[102:103]
    v_pk_fma_f32 v[200:201], v[200:201], v[130:131], v[130:131] op_sel_hi:[1,0,0]
    v_pk_fma_f32 v[202:203], v[202:203], v[130:131], v[130:131] op_sel_hi:[1,0,0]
    v_rcp_f32 v200, v200
    v_pk_fma_f32 v[20:21], v[180:181], v[124:125], v[20:21] op_sel_hi:[1,0,1]
    v_rcp_f32 v201, v201
    v_pk_fma_f32 v[22:23], v[182:183], v[124:125], v[22:23] op_sel_hi:[1,0,1]
    v_rcp_f32 v202, v202
    v_pk_mul_f32 v[196:197], v[20:21], v[124:125] op_sel:[0,1]
    v_rcp_f32 v203, v203
    v_pk_mul_f32 v[198:199], v[22:23], v[124:125] op_sel:[0,1]
    v_pk_mul_f32 v[72:73], v[72:73], v[200:201]
    v_pk_mul_f32 v[74:75], v[74:75], v[202:203]
    v_cvt_pk_bf16_f32 v98, v72, v73
    v_cvt_pk_bf16_f32 v99, v74, v75
    buffer_store_dwordx4 v[96:99], v121, s[12:15], s61 offen sc1
    v_exp_f32 v196, v196
    v_pk_fma_f32 v[48:49], v[144:145], v[124:125], v[48:49] op_sel_hi:[1,0,1]
    v_exp_f32 v197, v197
    v_pk_fma_f32 v[50:51], v[146:147], v[124:125], v[50:51] op_sel_hi:[1,0,1]
    v_exp_f32 v198, v198
    v_pk_mul_f32 v[20:21], v[20:21], v[48:49]
    v_exp_f32 v199, v199
    v_pk_mul_f32 v[22:23], v[22:23], v[50:51]
    v_pk_fma_f32 v[196:197], v[196:197], v[126:127], v[126:127] op_sel_hi:[1,0,0]
    v_pk_fma_f32 v[198:199], v[198:199], v[126:127], v[126:127] op_sel_hi:[1,0,0]
    v_rcp_f32 v196, v196
    v_pk_fma_f32 v[24:25], v[184:185], v[124:125], v[24:25] op_sel_hi:[1,0,1]
    v_rcp_f32 v197, v197
    v_pk_fma_f32 v[26:27], v[186:187], v[124:125], v[26:27] op_sel_hi:[1,0,1]
    v_rcp_f32 v198, v198
    v_pk_mul_f32 v[200:201], v[24:25], v[124:125] op_sel:[0,1]
    v_rcp_f32 v199, v199
    v_pk_mul_f32 v[202:203], v[26:27], v[124:125] op_sel:[0,1]
    v_pk_mul_f32 v[20:21], v[20:21], v[196:197]
    v_pk_mul_f32 v[22:23], v[22:23], v[198:199]
    v_cvt_pk_bf16_f32 v48, v20, v21
    v_cvt_pk_bf16_f32 v49, v22, v23
    v_exp_f32 v200, v200
    v_pk_fma_f32 v[52:53], v[148:149], v[124:125], v[52:53] op_sel_hi:[1,0,1]
    v_exp_f32 v201, v201
    v_pk_fma_f32 v[54:55], v[150:151], v[124:125], v[54:55] op_sel_hi:[1,0,1]
    v_exp_f32 v202, v202
    v_pk_mul_f32 v[24:25], v[24:25], v[52:53]
    v_exp_f32 v203, v203
    v_pk_mul_f32 v[26:27], v[26:27], v[54:55]
    v_pk_fma_f32 v[200:201], v[200:201], v[126:127], v[126:127] op_sel_hi:[1,0,0]
    v_pk_fma_f32 v[202:203], v[202:203], v[126:127], v[126:127] op_sel_hi:[1,0,0]
    v_rcp_f32 v200, v200
    v_pk_fma_f32 v[28:29], v[188:189], v[124:125], v[28:29] op_sel_hi:[1,0,1]
    v_rcp_f32 v201, v201
    v_pk_fma_f32 v[30:31], v[190:191], v[124:125], v[30:31] op_sel_hi:[1,0,1]
    v_rcp_f32 v202, v202
    v_pk_mul_f32 v[196:197], v[28:29], v[124:125] op_sel:[0,1]
    v_rcp_f32 v203, v203
    v_pk_mul_f32 v[198:199], v[30:31], v[124:125] op_sel:[0,1]
    v_pk_mul_f32 v[24:25], v[24:25], v[200:201]
    v_pk_mul_f32 v[26:27], v[26:27], v[202:203]
    v_cvt_pk_bf16_f32 v50, v24, v25
    v_cvt_pk_bf16_f32 v51, v26, v27
    buffer_store_dwordx4 v[48:51], v120, s[12:15], s62 offen sc1
    v_exp_f32 v196, v196
    v_pk_fma_f32 v[56:57], v[152:153], v[124:125], v[56:57] op_sel_hi:[1,0,1]
    v_exp_f32 v197, v197
    v_pk_fma_f32 v[58:59], v[154:155], v[124:125], v[58:59] op_sel_hi:[1,0,1]
    v_exp_f32 v198, v198
    v_pk_mul_f32 v[28:29], v[28:29], v[56:57]
    v_exp_f32 v199, v199
    v_pk_mul_f32 v[30:31], v[30:31], v[58:59]
    v_pk_fma_f32 v[196:197], v[196:197], v[126:127], v[126:127] op_sel_hi:[1,0,0]
    v_pk_fma_f32 v[198:199], v[198:199], v[126:127], v[126:127] op_sel_hi:[1,0,0]
    v_rcp_f32 v196, v196
    v_pk_fma_f32 v[76:77], v[180:181], v[128:129], v[76:77] op_sel_hi:[1,0,1]
    v_rcp_f32 v197, v197
    v_pk_fma_f32 v[78:79], v[182:183], v[128:129], v[78:79] op_sel_hi:[1,0,1]
    v_rcp_f32 v198, v198
    v_pk_mul_f32 v[200:201], v[76:77], v[128:129] op_sel:[0,1]
    v_rcp_f32 v199, v199
    v_pk_mul_f32 v[202:203], v[78:79], v[128:129] op_sel:[0,1]
    v_pk_mul_f32 v[28:29], v[28:29], v[196:197]
    v_pk_mul_f32 v[30:31], v[30:31], v[198:199]
    v_cvt_pk_bf16_f32 v56, v28, v29
    v_cvt_pk_bf16_f32 v57, v30, v31
    v_mov_b32 v58, v56
    v_mov_b32 v59, v57
    s_nop 0
    v_permlane16_swap_b32 v56, v58
    v_permlane16_swap_b32 v57, v59
    s_mov_b32 exec_lo, 0xffff
    s_mov_b32 exec_hi, 0xffff
    buffer_store_dwordx4 v[56:59], v119, s[12:15], s63 offen sc1
    s_mov_b64 exec, -1
    v_exp_f32 v200, v200
    v_pk_fma_f32 v[104:105], v[144:145], v[128:129], v[104:105] op_sel_hi:[1,0,1]
    v_exp_f32 v201, v201
    v_pk_fma_f32 v[106:107], v[146:147], v[128:129], v[106:107] op_sel_hi:[1,0,1]
    v_exp_f32 v202, v202
    v_pk_mul_f32 v[76:77], v[76:77], v[104:105]
    v_exp_f32 v203, v203
    v_pk_mul_f32 v[78:79], v[78:79], v[106:107]
    v_pk_fma_f32 v[200:201], v[200:201], v[130:131], v[130:131] op_sel_hi:[1,0,0]
    v_pk_fma_f32 v[202:203], v[202:203], v[130:131], v[130:131] op_sel_hi:[1,0,0]
    v_rcp_f32 v200, v200
    v_pk_fma_f32 v[80:81], v[184:185], v[128:129], v[80:81] op_sel_hi:[1,0,1]
    v_rcp_f32 v201, v201
    v_pk_fma_f32 v[82:83], v[186:187], v[128:129], v[82:83] op_sel_hi:[1,0,1]
    v_rcp_f32 v202, v202
    v_pk_mul_f32 v[196:197], v[80:81], v[128:129] op_sel:[0,1]
    v_rcp_f32 v203, v203
    v_pk_mul_f32 v[198:199], v[82:83], v[128:129] op_sel:[0,1]
    v_pk_mul_f32 v[76:77], v[76:77], v[200:201]
    v_pk_mul_f32 v[78:79], v[78:79], v[202:203]
    v_cvt_pk_bf16_f32 v104, v76, v77
    v_cvt_pk_bf16_f32 v105, v78, v79
    v_exp_f32 v196, v196
    v_pk_fma_f32 v[108:109], v[148:149], v[128:129], v[108:109] op_sel_hi:[1,0,1]
    v_exp_f32 v197, v197
    v_pk_fma_f32 v[110:111], v[150:151], v[128:129], v[110:111] op_sel_hi:[1,0,1]
    v_exp_f32 v198, v198
    v_pk_mul_f32 v[80:81], v[80:81], v[108:109]
    v_exp_f32 v199, v199
    v_pk_mul_f32 v[82:83], v[82:83], v[110:111]
    v_pk_fma_f32 v[196:197], v[196:197], v[130:131], v[130:131] op_sel_hi:[1,0,0]
    v_pk_fma_f32 v[198:199], v[198:199], v[130:131], v[130:131] op_sel_hi:[1,0,0]
    v_rcp_f32 v196, v196
    v_pk_fma_f32 v[84:85], v[188:189], v[128:129], v[84:85] op_sel_hi:[1,0,1]
    v_rcp_f32 v197, v197
    v_pk_fma_f32 v[86:87], v[190:191], v[128:129], v[86:87] op_sel_hi:[1,0,1]
    v_rcp_f32 v198, v198
    v_pk_mul_f32 v[200:201], v[84:85], v[128:129] op_sel:[0,1]
    v_rcp_f32 v199, v199
    v_pk_mul_f32 v[202:203], v[86:87], v[128:129] op_sel:[0,1]
    v_pk_mul_f32 v[80:81], v[80:81], v[196:197]
    v_pk_mul_f32 v[82:83], v[82:83], v[198:199]
    v_cvt_pk_bf16_f32 v106, v80, v81
    v_cvt_pk_bf16_f32 v107, v82, v83
    buffer_store_dwordx4 v[104:107], v121, s[12:15], s62 offen sc1
    v_mov_b32 v252, 3
    v_mov_b32 v253, 0
    s_waitcnt vmcnt(3)
    s_mov_b64 exec, 1
    buffer_store_dword v252, v253, s[12:15], s45 offen
    s_mov_b64 exec, -1
    v_exp_f32 v200, v200
    v_pk_fma_f32 v[112:113], v[152:153], v[128:129], v[112:113] op_sel_hi:[1,0,1]
    v_exp_f32 v201, v201
    v_pk_fma_f32 v[114:115], v[154:155], v[128:129], v[114:115] op_sel_hi:[1,0,1]
    v_exp_f32 v202, v202
    v_pk_mul_f32 v[84:85], v[84:85], v[112:113]
    v_exp_f32 v203, v203
    v_pk_mul_f32 v[86:87], v[86:87], v[114:115]
    v_pk_fma_f32 v[200:201], v[200:201], v[130:131], v[130:131] op_sel_hi:[1,0,0]
    v_pk_fma_f32 v[202:203], v[202:203], v[130:131], v[130:131] op_sel_hi:[1,0,0]
    v_rcp_f32 v200, v200
    v_rcp_f32 v201, v201
    v_rcp_f32 v202, v202
    v_rcp_f32 v203, v203
    v_pk_mul_f32 v[84:85], v[84:85], v[200:201]
    v_pk_mul_f32 v[86:87], v[86:87], v[202:203]
    v_cvt_pk_bf16_f32 v112, v84, v85
    v_cvt_pk_bf16_f32 v113, v86, v87
    v_mov_b32 v114, v112
    v_mov_b32 v115, v113
    s_nop 0
    v_permlane16_swap_b32 v112, v114
    v_permlane16_swap_b32 v113, v115
    s_mov_b32 exec_lo, 0xffff
    s_mov_b32 exec_hi, 0xffff
    buffer_store_dwordx4 v[112:115], v2, s[12:15], s63 offen sc1
    s_mov_b64 exec, -1
    s_lshl_b32 s46, s43, 2
    s_add_u32 s46, s46, s40
    s_mul_i32 s47, s46, 55296
    s_xor_b32 s49, s46, 1
    s_mul_i32 s48, s49, 55296
    s_and_b32 s52, s40, 1
    s_lshl_b32 s49, s52, 10
    s_add_u32 s49, s49, 0x500000
    s_add_u32 s47, s47, s49
    s_add_u32 s48, s48, s49
    s_mul_i32 s53, s46, 20480
    s_mul_i32 s51, s44, 160
    s_add_u32 s53, s53, s51
    s_add_u32 s54, s53, 7680
    s_add_u32 s55, s53, 15360
    s_mul_i32 s52, s52, 5120
    s_mul_i32 s56, s44, 0
    s_lshr_b32 s56, s56, 3
    s_lshl_b32 s56, s56, 11
    s_mul_i32 s50, s40, 2816
    s_add_u32 s50, s50, 145664
    s_mov_b32 s4, s30
    s_mov_b32 s5, s31
    s_mov_b32 s6, 0x280000
    s_mov_b32 s7, 0x20000
    v_lshlrev_b32 v46, 4, v0
    v_add_u32 v44, s47, v46
    v_add_u32 v45, s48, v46
    v_add_u32 v47, s52, v46
    v_add_u32 v48, 61440, v47
    v_add_u32 v49, 122880, v47
    v_and_b32 v50, 7, v0
    v_bfe_u32 v51, v0, 3, 1
    v_lshl_add_u32 v50, v50, 1, v51
    v_mul_u32_u24 v50, 176, v50
    v_lshrrev_b32 v51, 4, v0
    v_lshlrev_b32 v51, 3, v51
    v_add3_u32 v174, v50, v51, s50
    v_mul_u32_u24 v51, 205, v0
    v_lshrrev_b32 v51, 11, v51
    v_mul_u32_u24 v52, 1120, v51
    v_lshl_add_u32 v176, v0, 4, v52
    v_mul_u32_u24 v52, 16, v51
    v_add3_u32 v175, v52, v46, s50
    s_mul_i32 s49, s40, 5120
    s_add_u32 s49, s49, 102400
    v_add_u32 v55, s49, v46
    s_xor_b32 s49, s40, 1
    s_mul_i32 s49, s49, 5120
    s_add_u32 s49, s49, 102400
    v_add_u32 v56, s49, v46
    v_and_b32 v54, 3, v0
    v_lshlrev_b32 v54, 8, v54
    v_add_u32 v54, 144384, v54
    v_lshlrev_b32 v4, 16, v240
    v_and_b32 v5, 0xffff0000, v240
    v_lshlrev_b32 v6, 16, v241
    v_and_b32 v7, 0xffff0000, v241
    v_lshlrev_b32 v8, 16, v242
    v_and_b32 v9, 0xffff0000, v242
    v_lshlrev_b32 v10, 16, v243
    v_and_b32 v11, 0xffff0000, v243
    v_lshlrev_b32 v12, 16, v244
    v_and_b32 v13, 0xffff0000, v244
    v_lshlrev_b32 v14, 16, v245
    v_and_b32 v15, 0xffff0000, v245
    v_lshlrev_b32 v16, 16, v246
    v_and_b32 v17, 0xffff0000, v246
    v_lshlrev_b32 v18, 16, v247
    v_and_b32 v19, 0xffff0000, v247
    v_lshlrev_b32 v20, 16, v248
    v_and_b32 v21, 0xffff0000, v248
    v_lshlrev_b32 v22, 16, v249
    v_and_b32 v23, 0xffff0000, v249
    s_mov_b32 s91, 0
SP_52:
    ds_read_b64 v[252:253], v254 offset:1024
    s_add_u32 s91, s91, 1
    s_waitcnt lgkmcnt(0)
    v_min_u32 v252, v252, v253
    s_nop 0
    v_readfirstlane_b32 s92, v252
    s_cmp_ge_u32 s91, 400000
    s_cbranch_scc1 OK_51
    s_cmp_lt_u32 s92, 34
    s_cbranch_scc1 SP_52
OK_51:
    ds_read_b128 v[124:127], v49 offset:0
    ds_read_b128 v[128:131], v49 offset:1024
    ds_read_b128 v[132:135], v49 offset:2048
    ds_read_b128 v[136:139], v49 offset:3072
    ds_read_b128 v[140:143], v49 offset:4096
    ds_read_b128 v[144:147], v49 offset:10240
    ds_read_b128 v[148:151], v49 offset:11264
    ds_read_b128 v[152:155], v49 offset:12288
    ds_read_b128 v[156:159], v49 offset:13312
    v_mov_b32 v252, 4
    v_mov_b32 v253, 0
    s_waitcnt lgkmcnt(0)
    v_lshlrev_b32 v52, 2, v0
    s_and_b32 s49, s43, 1
    s_lshl_b32 s49, s49, 1
    s_lshr_b32 s91, s40, 1
    s_add_u32 s49, s49, s91
    s_lshl_b32 exec_lo, 0x11111111, s49
    s_lshl_b32 exec_hi, 0x11111111, s49
    s_and_b32 s49, s45, 0xffffff00
    s_mov_b32 s91, 0
    buffer_load_dword v239, v52, s[12:15], s49 offen sc1
    s_waitcnt vmcnt(0)
    v_cmp_le_u32 vcc, 3, v239
    s_mov_b64 s[58:59], exec
    s_mov_b64 exec, 1
    buffer_store_dword v252, v253, s[12:15], s45 offen
    s_mov_b64 exec, -1
    v_add_u32 v251, 1, v251
    ds_write_b32 v250, v251
    s_mov_b64 exec, s[58:59]
    s_cmp_eq_u64 vcc, exec
    s_cbranch_scc1 GO_53
    buffer_load_dword v239, v52, s[12:15], s49 offen sc1
GL_54:
    buffer_load_dword v238, v52, s[12:15], s49 offen sc1
    s_waitcnt vmcnt(1)
    v_cmp_le_u32 vcc, 3, v239
    s_add_u32 s91, s91, 1
    s_cmp_eq_u64 vcc, exec
    s_cbranch_scc1 GO_53
    buffer_load_dword v239, v52, s[12:15], s49 offen sc1
    s_waitcnt vmcnt(1)
    v_cmp_le_u32 vcc, 3, v238
    s_cmp_ge_u32 s91, 80000
    s_cbranch_scc1 GO_53
    s_cmp_lg_u64 vcc, exec
    s_cbranch_scc1 GL_54
GO_53:
    s_mov_b64 exec, -1
    buffer_load_dwordx4 v[60:63], v44, s[12:15], s56 offen sc1
    buffer_load_dwordx4 v[64:67], v45, s[12:15], s56 offen sc1
    s_add_u32 s56, s56, 2048
    s_cmp_eq_u32 s56, 55296
    s_cselect_b32 s56, 0, s56
    buffer_load_dwordx4 v[68:71], v44, s[12:15], s56 offen sc1
    buffer_load_dwordx4 v[72:75], v45, s[12:15], s56 offen sc1
    s_add_u32 s56, s56, 2048
    s_cmp_eq_u32 s56, 55296
    s_cselect_b32 s56, 0, s56
    buffer_load_dwordx4 v[76:79], v44, s[12:15], s56 offen sc1
    buffer_load_dwordx4 v[80:83], v45, s[12:15], s56 offen sc1
    s_add_u32 s56, s56, 2048
    s_cmp_eq_u32 s56, 55296
    s_cselect_b32 s56, 0, s56
    buffer_load_dwordx4 v[84:87], v44, s[12:15], s56 offen sc1
    buffer_load_dwordx4 v[88:91], v45, s[12:15], s56 offen sc1
    s_add_u32 s56, s56, 2048
    s_cmp_eq_u32 s56, 55296
    s_cselect_b32 s56, 0, s56
    buffer_load_dwordx4 v[92:95], v44, s[12:15], s56 offen sc1
    buffer_load_dwordx4 v[96:99], v45, s[12:15], s56 offen sc1
    s_add_u32 s56, s56, 2048
    s_cmp_eq_u32 s56, 55296
    s_cselect_b32 s56, 0, s56
    buffer_load_dwordx4 v[100:103], v44, s[12:15], s56 offen sc1
    buffer_load_dwordx4 v[104:107], v45, s[12:15], s56 offen sc1
    s_add_u32 s56, s56, 2048
    s_cmp_eq_u32 s56, 55296
    s_cselect_b32 s56, 0, s56
    buffer_load_dwordx4 v[108:111], v44, s[12:15], s56 offen sc1
    buffer_load_dwordx4 v[112:115], v45, s[12:15], s56 offen sc1
    s_add_u32 s56, s56, 2048
    s_cmp_eq_u32 s56, 55296
    s_cselect_b32 s56, 0, s56
    buffer_load_dwordx4 v[116:119], v44, s[12:15], s56 offen sc1
    buffer_load_dwordx4 v[120:123], v45, s[12:15], s56 offen sc1
    s_add_u32 s56, s56, 2048
    s_cmp_eq_u32 s56, 55296
    s_cselect_b32 s56, 0, s56
    v_add_u32 v251, 1, v251
    ds_write_b32 v250, v251
    s_and_b32 s50, s43, 1
    s_lshl_b32 s50, s50, 1
    s_lshr_b32 s62, s40, 1
    s_add_u32 s50, s50, s62
    s_lshl_b32 s60, 0x11111111, s50
    s_mov_b32 s61, s60
    s_and_b32 s62, s45, 0xffffff00
    v_lshlrev_b32 v177, 2, v0
    s_waitcnt vmcnt(14)
    v_mfma_f32_16x16x32_bf16 v[4:7], v[124:127], v[60:63], v[4:7]
    ds_read_b128 v[160:163], v49 offset:14336
    v_mfma_f32_16x16x32_bf16 v[24:27], v[124:127], v[64:67], 0
    ds_read_b64 v[252:253], v254 offset:1024
    v_mfma_f32_16x16x32_bf16 v[8:11], v[128:131], v[60:63], v[8:11]
    ds_read_b128 v[124:127], v47 offset:0
    v_mfma_f32_16x16x32_bf16 v[28:31], v[128:131], v[64:67], 0
    v_mfma_f32_16x16x32_bf16 v[12:15], v[132:135], v[60:63], v[12:15]
    ds_read_b128 v[128:131], v47 offset:1024
    v_mfma_f32_16x16x32_bf16 v[32:35], v[132:135], v[64:67], 0
    v_mfma_f32_16x16x32_bf16 v[16:19], v[136:139], v[60:63], v[16:19]
    s_waitcnt lgkmcnt(2)
    v_min_u32 v252, v252, v253
    ds_read_b128 v[132:135], v47 offset:2048
    v_mfma_f32_16x16x32_bf16 v[36:39], v[136:139], v[64:67], 0
    v_mfma_f32_16x16x32_bf16 v[20:23], v[140:143], v[60:63], v[20:23]
    v_readfirstlane_b32 s92, v252
    ds_read_b128 v[136:139], v47 offset:3072
    v_mfma_f32_16x16x32_bf16 v[40:43], v[140:143], v[64:67], 0
    s_waitcnt vmcnt(12)
    v_mfma_f32_16x16x32_bf16 v[4:7], v[144:147], v[68:71], v[4:7]
    s_cmp_lt_u32 s92, 37
    s_cbranch_scc1 SP_58s
OK_57:
    ds_read_b128 v[140:143], v47 offset:4096
    v_mfma_f32_16x16x32_bf16 v[24:27], v[144:147], v[72:75], v[24:27]
    v_mfma_f32_16x16x32_bf16 v[8:11], v[148:151], v[68:71], v[8:11]
    v_add_u32 v251, 2, v251
    ds_write_b32 v250, v251
    ds_read_b128 v[144:147], v47 offset:10240
    v_mfma_f32_16x16x32_bf16 v[28:31], v[148:151], v[72:75], v[28:31]
    v_mfma_f32_16x16x32_bf16 v[12:15], v[152:155], v[68:71], v[12:15]
    ds_read_b128 v[148:151], v47 offset:11264
    v_mfma_f32_16x16x32_bf16 v[32:35], v[152:155], v[72:75], v[32:35]
    v_mfma_f32_16x16x32_bf16 v[16:19], v[156:159], v[68:71], v[16:19]
    ds_read_b128 v[152:155], v47 offset:12288
    v_mfma_f32_16x16x32_bf16 v[36:39], v[156:159], v[72:75], v[36:39]
    buffer_load_dwordx4 v[60:63], v44, s[12:15], s56 offen sc1
    v_mfma_f32_16x16x32_bf16 v[20:23], v[160:163], v[68:71], v[20:23]
    ds_read_b128 v[156:159], v47 offset:13312
    v_mfma_f32_16x16x32_bf16 v[40:43], v[160:163], v[72:75], v[40:43]
    buffer_load_dwordx4 v[64:67], v45, s[12:15], s56 offen sc1
    s_add_u32 s56, s56, 2048
    s_cmp_eq_u32 s56, 55296
    s_cselect_b32 s56, 0, s56
    s_waitcnt vmcnt(12) lgkmcnt(9)
    v_mfma_f32_16x16x32_bf16 v[4:7], v[124:127], v[76:79], v[4:7]
    ds_read_b128 v[160:163], v47 offset:14336
    v_mfma_f32_16x16x32_bf16 v[24:27], v[124:127], v[80:83], v[24:27]
    ds_read_b64 v[252:253], v254 offset:1024
    s_waitcnt lgkmcnt(10)
    v_mfma_f32_16x16x32_bf16 v[8:11], v[128:131], v[76:79], v[8:11]
    ds_read_b128 v[124:127], v47 offset:20480
    v_mfma_f32_16x16x32_bf16 v[28:31], v[128:131], v[80:83], v[28:31]
    s_waitcnt lgkmcnt(10)
    v_mfma_f32_16x16x32_bf16 v[12:15], v[132:135], v[76:79], v[12:15]
    ds_read_b128 v[128:131], v47 offset:21504
    v_mfma_f32_16x16x32_bf16 v[32:35], v[132:135], v[80:83], v[32:35]
    s_waitcnt lgkmcnt(10)
    v_mfma_f32_16x16x32_bf16 v[16:19], v[136:139], v[76:79], v[16:19]
    ds_read_b128 v[132:135], v47 offset:22528
    v_mfma_f32_16x16x32_bf16 v[36:39], v[136:139], v[80:83], v[36:39]
    buffer_load_dwordx4 v[68:71], v44, s[12:15], s56 offen sc1
    s_waitcnt lgkmcnt(10)
    v_mfma_f32_16x16x32_bf16 v[20:23], v[140:143], v[76:79], v[20:23]
    ds_read_b128 v[136:139], v47 offset:23552
    v_mfma_f32_16x16x32_bf16 v[40:43], v[140:143], v[80:83], v[40:43]
    buffer_load_dwordx4 v[72:75], v45, s[12:15], s56 offen sc1
    s_add_u32 s56, s56, 2048
    s_cmp_eq_u32 s56, 55296
    s_cselect_b32 s56, 0, s56
    s_waitcnt vmcnt(12) lgkmcnt(9)
    v_mfma_f32_16x16x32_bf16 v[4:7], v[144:147], v[84:87], v[4:7]
    ds_read_b128 v[140:143], v47 offset:24576
    v_mfma_f32_16x16x32_bf16 v[24:27], v[144:147], v[88:91], v[24:27]
    s_waitcnt lgkmcnt(9)
    v_mfma_f32_16x16x32_bf16 v[8:11], v[148:151], v[84:87], v[8:11]
    ds_read_b128 v[144:147], v47 offset:30720
    v_mfma_f32_16x16x32_bf16 v[28:31], v[148:151], v[88:91], v[28:31]
    s_waitcnt lgkmcnt(9)
    v_mfma_f32_16x16x32_bf16 v[12:15], v[152:155], v[84:87], v[12:15]
    ds_read_b128 v[148:151], v47 offset:31744
    v_mfma_f32_16x16x32_bf16 v[32:35], v[152:155], v[88:91], v[32:35]
    s_waitcnt lgkmcnt(9)
    v_mfma_f32_16x16x32_bf16 v[16:19], v[156:159], v[84:87], v[16:19]
    s_waitcnt lgkmcnt(7)
    v_min_u32 v252, v252, v253
    ds_read_b128 v[152:155], v47 offset:32768
    v_mfma_f32_16x16x32_bf16 v[36:39], v[156:159], v[88:91], v[36:39]
    buffer_load_dwordx4 v[76:79], v44, s[12:15], s56 offen sc1
    v_mfma_f32_16x16x32_bf16 v[20:23], v[160:163], v[84:87], v[20:23]
    v_readfirstlane_b32 s92, v252
    ds_read_b128 v[156:159], v47 offset:33792
    v_mfma_f32_16x16x32_bf16 v[40:43], v[160:163], v[88:91], v[40:43]
    buffer_load_dwordx4 v[80:83], v45, s[12:15], s56 offen sc1
    s_add_u32 s56, s56, 2048
    s_cmp_eq_u32 s56, 55296
    s_cselect_b32 s56, 0, s56
    s_waitcnt vmcnt(12) lgkmcnt(8)
    v_mfma_f32_16x16x32_bf16 v[4:7], v[124:127], v[92:95], v[4:7]
    s_cmp_lt_u32 s92, 40
    s_cbranch_scc1 SP_60s
OK_59:
    ds_read_b128 v[160:163], v47 offset:34816
    v_mfma_f32_16x16x32_bf16 v[24:27], v[124:127], v[96:99], v[24:27]
    s_waitcnt lgkmcnt(8)
    v_mfma_f32_16x16x32_bf16 v[8:11], v[128:131], v[92:95], v[8:11]
    v_add_u32 v251, 3, v251
    ds_write_b32 v250, v251
    ds_read_b128 v[124:127], v47 offset:40960
    v_mfma_f32_16x16x32_bf16 v[28:31], v[128:131], v[96:99], v[28:31]
    s_waitcnt lgkmcnt(9)
    v_mfma_f32_16x16x32_bf16 v[12:15], v[132:135], v[92:95], v[12:15]
    ds_read_b128 v[128:131], v47 offset:41984
    v_mfma_f32_16x16x32_bf16 v[32:35], v[132:135], v[96:99], v[32:35]
    s_waitcnt lgkmcnt(9)
    v_mfma_f32_16x16x32_bf16 v[16:19], v[136:139], v[92:95], v[16:19]
    ds_read_b128 v[132:135], v47 offset:43008
    v_mfma_f32_16x16x32_bf16 v[36:39], v[136:139], v[96:99], v[36:39]
    buffer_load_dwordx4 v[84:87], v44, s[12:15], s56 offen sc1
    s_waitcnt lgkmcnt(9)
    v_mfma_f32_16x16x32_bf16 v[20:23], v[140:143], v[92:95], v[20:23]
    ds_read_b128 v[136:139], v47 offset:44032
    v_mfma_f32_16x16x32_bf16 v[40:43], v[140:143], v[96:99], v[40:43]
    buffer_load_dwordx4 v[88:91], v45, s[12:15], s56 offen sc1
    s_add_u32 s56, s56, 2048
    s_cmp_eq_u32 s56, 55296
    s_cselect_b32 s56, 0, s56
    s_waitcnt vmcnt(12) lgkmcnt(9)
    v_mfma_f32_16x16x32_bf16 v[4:7], v[144:147], v[100:103], v[4:7]
    ds_read_b128 v[140:143], v47 offset:45056
    v_mfma_f32_16x16x32_bf16 v[24:27], v[144:147], v[104:107], v[24:27]
    ds_read_b64 v[252:253], v254 offset:1024
    s_waitcnt lgkmcnt(10)
    v_mfma_f32_16x16x32_bf16 v[8:11], v[148:151], v[100:103], v[8:11]
    ds_read_b128 v[144:147], v47 offset:51200
    v_mfma_f32_16x16x32_bf16 v[28:31], v[148:151], v[104:107], v[28:31]
    buffer_load_dword v238, v177, s[12:15], s62 offen sc1
    s_waitcnt lgkmcnt(10)
    v_mfma_f32_16x16x32_bf16 v[12:15], v[152:155], v[100:103], v[12:15]
    ds_read_b128 v[148:151], v47 offset:52224
    v_mfma_f32_16x16x32_bf16 v[32:35], v[152:155], v[104:107], v[32:35]
    s_waitcnt lgkmcnt(10)
    v_mfma_f32_16x16x32_bf16 v[16:19], v[156:159], v[100:103], v[16:19]
    ds_read_b128 v[152:155], v47 offset:53248
    v_mfma_f32_16x16x32_bf16 v[36:39], v[156:159], v[104:107], v[36:39]
    buffer_load_dwordx4 v[92:95], v44, s[12:15], s56 offen sc1
    s_waitcnt lgkmcnt(10)
    v_mfma_f32_16x16x32_bf16 v[20:23], v[160:163], v[100:103], v[20:23]
    ds_read_b128 v[156:159], v47 offset:54272
    v_mfma_f32_16x16x32_bf16 v[40:43], v[160:163], v[104:107], v[40:43]
    buffer_load_dwordx4 v[96:99], v45, s[12:15], s56 offen sc1
    s_add_u32 s56, s56, 2048
    s_cmp_eq_u32 s56, 55296
    s_cselect_b32 s56, 0, s56
    s_waitcnt vmcnt(13) lgkmcnt(9)
    v_mfma_f32_16x16x32_bf16 v[4:7], v[124:127], v[108:111], v[4:7]
    ds_read_b128 v[160:163], v47 offset:55296
    v_mfma_f32_16x16x32_bf16 v[24:27], v[124:127], v[112:115], v[24:27]
    s_waitcnt lgkmcnt(9)
    v_mfma_f32_16x16x32_bf16 v[8:11], v[128:131], v[108:111], v[8:11]
    ds_read_b128 v[124:127], v48 offset:0
    v_mfma_f32_16x16x32_bf16 v[28:31], v[128:131], v[112:115], v[28:31]
    s_waitcnt lgkmcnt(9)
    v_mfma_f32_16x16x32_bf16 v[12:15], v[132:135], v[108:111], v[12:15]
    ds_read_b128 v[128:131], v48 offset:1024
    v_mfma_f32_16x16x32_bf16 v[32:35], v[132:135], v[112:115], v[32:35]
    s_waitcnt lgkmcnt(9)
    v_mfma_f32_16x16x32_bf16 v[16:19], v[136:139], v[108:111], v[16:19]
    s_waitcnt lgkmcnt(7)
    v_min_u32 v252, v252, v253
    ds_read_b128 v[132:135], v48 offset:2048
    v_mfma_f32_16x16x32_bf16 v[36:39], v[136:139], v[112:115], v[36:39]
    buffer_load_dwordx4 v[100:103], v44, s[12:15], s56 offen sc1
    v_mfma_f32_16x16x32_bf16 v[20:23], v[140:143], v[108:111], v[20:23]
    v_readfirstlane_b32 s92, v252
    ds_read_b128 v[136:139], v48 offset:3072
    v_mfma_f32_16x16x32_bf16 v[40:43], v[140:143], v[112:115], v[40:43]
    buffer_load_dwordx4 v[104:107], v45, s[12:15], s56 offen sc1
    s_add_u32 s56, s56, 2048
    s_cmp_eq_u32 s56, 55296
    s_cselect_b32 s56, 0, s56
    s_waitcnt vmcnt(13) lgkmcnt(8)
    v_mfma_f32_16x16x32_bf16 v[4:7], v[144:147], v[116:119], v[4:7]
    s_cmp_lt_u32 s92, 43
    s_cbranch_scc1 SP_62s
OK_61:
    ds_read_b128 v[140:143], v48 offset:4096
    v_mfma_f32_16x16x32_bf16 v[24:27], v[144:147], v[120:123], v[24:27]
    s_waitcnt lgkmcnt(8)
    v_mfma_f32_16x16x32_bf16 v[8:11], v[148:151], v[116:119], v[8:11]
    v_add_u32 v251, 3, v251
    ds_write_b32 v250, v251
    ds_read_b128 v[144:147], v48 offset:10240
    v_mfma_f32_16x16x32_bf16 v[28:31], v[148:151], v[120:123], v[28:31]
    s_waitcnt lgkmcnt(9)
    v_mfma_f32_16x16x32_bf16 v[12:15], v[152:155], v[116:119], v[12:15]
    ds_read_b128 v[148:151], v48 offset:11264
    v_mfma_f32_16x16x32_bf16 v[32:35], v[152:155], v[120:123], v[32:35]
    s_waitcnt lgkmcnt(9)
    v_mfma_f32_16x16x32_bf16 v[16:19], v[156:159], v[116:119], v[16:19]
    ds_read_b128 v[152:155], v48 offset:12288
    v_mfma_f32_16x16x32_bf16 v[36:39], v[156:159], v[120:123], v[36:39]
    buffer_load_dwordx4 v[108:111], v44, s[12:15], s56 offen sc1
    s_waitcnt lgkmcnt(9)
    v_mfma_f32_16x16x32_bf16 v[20:23], v[160:163], v[116:119], v[20:23]
    ds_read_b128 v[156:159], v48 offset:13312
    v_mfma_f32_16x16x32_bf16 v[40:43], v[160:163], v[120:123], v[40:43]
    buffer_load_dwordx4 v[112:115], v45, s[12:15], s56 offen sc1
    s_add_u32 s56, s56, 2048
    s_cmp_eq_u32 s56, 55296
    s_cselect_b32 s56, 0, s56
    s_waitcnt vmcnt(13) lgkmcnt(9)
    v_mfma_f32_16x16x32_bf16 v[4:7], v[124:127], v[60:63], v[4:7]
    ds_read_b128 v[160:163], v48 offset:14336
    v_mfma_f32_16x16x32_bf16 v[24:27], v[124:127], v[64:67], v[24:27]
    ds_read_b64 v[252:253], v254 offset:1024
    s_waitcnt lgkmcnt(10)
    v_mfma_f32_16x16x32_bf16 v[8:11], v[128:131], v[60:63], v[8:11]
    ds_read_b128 v[124:127], v48 offset:20480
    v_mfma_f32_16x16x32_bf16 v[28:31], v[128:131], v[64:67], v[28:31]
    s_waitcnt vmcnt(6)
    v_cmp_le_u32 vcc, 4, v238
    s_nop 0
    s_and_b64 vcc, vcc, s[60:61]
    s_cmp_lg_u64 vcc, s[60:61]
    s_cbranch_scc1 LS_56
LK_55:
    s_waitcnt lgkmcnt(10)
    v_mfma_f32_16x16x32_bf16 v[12:15], v[132:135], v[60:63], v[12:15]
    ds_read_b128 v[128:131], v48 offset:21504
    v_mfma_f32_16x16x32_bf16 v[32:35], v[132:135], v[64:67], v[32:35]
    s_waitcnt lgkmcnt(10)
    v_mfma_f32_16x16x32_bf16 v[16:19], v[136:139], v[60:63], v[16:19]
    ds_read_b128 v[132:135], v48 offset:22528
    v_mfma_f32_16x16x32_bf16 v[36:39], v[136:139], v[64:67], v[36:39]
    buffer_load_dwordx4 v[116:119], v44, s[12:15], s56 offen sc1
    s_waitcnt lgkmcnt(10)
    v_mfma_f32_16x16x32_bf16 v[20:23], v[140:143], v[60:63], v[20:23]
    ds_read_b128 v[136:139], v48 offset:23552
    v_mfma_f32_16x16x32_bf16 v[40:43], v[140:143], v[64:67], v[40:43]
    buffer_load_dwordx4 v[120:123], v45, s[12:15], s56 offen sc1
    s_add_u32 s56, s56, 2048
    s_cmp_eq_u32 s56, 55296
    s_cselect_b32 s56, 0, s56
    s_waitcnt lgkmcnt(9)
    v_mfma_f32_16x16x32_bf16 v[4:7], v[144:147], v[68:71], v[4:7]
    ds_read_b128 v[140:143], v48 offset:24576
    v_mfma_f32_16x16x32_bf16 v[24:27], v[144:147], v[72:75], v[24:27]
    s_waitcnt lgkmcnt(9)
    v_mfma_f32_16x16x32_bf16 v[8:11], v[148:151], v[68:71], v[8:11]
    ds_read_b128 v[144:147], v48 offset:30720
    v_mfma_f32_16x16x32_bf16 v[28:31], v[148:151], v[72:75], v[28:31]
    s_waitcnt lgkmcnt(9)
    v_mfma_f32_16x16x32_bf16 v[12:15], v[152:155], v[68:71], v[12:15]
    ds_read_b128 v[148:151], v48 offset:31744
    v_mfma_f32_16x16x32_bf16 v[32:35], v[152:155], v[72:75], v[32:35]
    s_waitcnt lgkmcnt(9)
    v_mfma_f32_16x16x32_bf16 v[16:19], v[156:159], v[68:71], v[16:19]
    s_waitcnt lgkmcnt(7)
    v_min_u32 v252, v252, v253
    ds_read_b128 v[152:155], v48 offset:32768
    v_mfma_f32_16x16x32_bf16 v[36:39], v[156:159], v[72:75], v[36:39]
    buffer_load_dwordx4 v[60:63], v44, s[12:15], s56 offen sc1
    v_mfma_f32_16x16x32_bf16 v[20:23], v[160:163], v[68:71], v[20:23]
    v_readfirstlane_b32 s92, v252
    ds_read_b128 v[156:159], v48 offset:33792
    v_mfma_f32_16x16x32_bf16 v[40:43], v[160:163], v[72:75], v[40:43]
    buffer_load_dwordx4 v[64:67], v45, s[12:15], s56 offen sc1
    s_add_u32 s56, s56, 2048
    s_cmp_eq_u32 s56, 55296
    s_cselect_b32 s56, 0, s56
    s_waitcnt lgkmcnt(8)
    v_mfma_f32_16x16x32_bf16 v[4:7], v[124:127], v[76:79], v[4:7]
    s_cmp_lt_u32 s92, 46
    s_cbranch_scc1 SP_64s
OK_63:
    ds_read_b128 v[160:163], v48 offset:34816
    v_mfma_f32_16x16x32_bf16 v[24:27], v[124:127], v[80:83], v[24:27]
    s_waitcnt lgkmcnt(8)
    v_mfma_f32_16x16x32_bf16 v[8:11], v[128:131], v[76:79], v[8:11]
    v_add_u32 v251, 3, v251
    ds_write_b32 v250, v251
    ds_read_b128 v[124:127], v48 offset:40960
    v_mfma_f32_16x16x32_bf16 v[28:31], v[128:131], v[80:83], v[28:31]
    s_waitcnt lgkmcnt(9)
    v_mfma_f32_16x16x32_bf16 v[12:15], v[132:135], v[76:79], v[12:15]
    ds_read_b128 v[128:131], v48 offset:41984
    v_mfma_f32_16x16x32_bf16 v[32:35], v[132:135], v[80:83], v[32:35]
    s_waitcnt lgkmcnt(9)
    v_mfma_f32_16x16x32_bf16 v[16:19], v[136:139], v[76:79], v[16:19]
    ds_read_b128 v[132:135], v48 offset:43008
    v_mfma_f32_16x16x32_bf16 v[36:39], v[136:139], v[80:83], v[36:39]
    buffer_load_dwordx4 v[68:71], v44, s[12:15], s56 offen sc1
    s_waitcnt lgkmcnt(9)
    v_mfma_f32_16x16x32_bf16 v[20:23], v[140:143], v[76:79], v[20:23]
    ds_read_b128 v[136:139], v48 offset:44032
    v_mfma_f32_16x16x32_bf16 v[40:43], v[140:143], v[80:83], v[40:43]
    buffer_load_dwordx4 v[72:75], v45, s[12:15], s56 offen sc1
    s_add_u32 s56, s56, 2048
    s_cmp_eq_u32 s56, 55296
    s_cselect_b32 s56, 0, s56
    s_waitcnt lgkmcnt(9)
    v_mfma_f32_16x16x32_bf16 v[4:7], v[144:147], v[84:87], v[4:7]
    ds_read_b128 v[140:143], v48 offset:45056
    v_mfma_f32_16x16x32_bf16 v[24:27], v[144:147], v[88:91], v[24:27]
    ds_read_b64 v[252:253], v254 offset:1024
    s_waitcnt lgkmcnt(10)
    v_mfma_f32_16x16x32_bf16 v[8:11], v[148:151], v[84:87], v[8:11]
    ds_read_b128 v[144:147], v48 offset:51200
    v_mfma_f32_16x16x32_bf16 v[28:31], v[148:151], v[88:91], v[28:31]
    s_waitcnt lgkmcnt(10)
    v_mfma_f32_16x16x32_bf16 v[12:15], v[152:155], v[84:87], v[12:15]
    ds_read_b128 v[148:151], v48 offset:52224
    v_mfma_f32_16x16x32_bf16 v[32:35], v[152:155], v[88:91], v[32:35]
    s_waitcnt lgkmcnt(10)
    v_mfma_f32_16x16x32_bf16 v[16:19], v[156:159], v[84:87], v[16:19]
    ds_read_b128 v[152:155], v48 offset:53248
    v_mfma_f32_16x16x32_bf16 v[36:39], v[156:159], v[88:91], v[36:39]
    buffer_load_dwordx4 v[76:79], v44, s[12:15], s56 offen sc1
    s_waitcnt lgkmcnt(10)
    v_mfma_f32_16x16x32_bf16 v[20:23], v[160:163], v[84:87], v[20:23]
    ds_read_b128 v[156:159], v48 offset:54272
    v_mfma_f32_16x16x32_bf16 v[40:43], v[160:163], v[88:91], v[40:43]
    buffer_load_dwordx4 v[80:83], v45, s[12:15], s56 offen sc1
    s_add_u32 s56, s56, 2048
    s_cmp_eq_u32 s56, 55296
    s_cselect_b32 s56, 0, s56
    s_waitcnt vmcnt(12) lgkmcnt(9)
    v_mfma_f32_16x16x32_bf16 v[4:7], v[124:127], v[92:95], v[4:7]
    ds_read_b128 v[160:163], v48 offset:55296
    v_mfma_f32_16x16x32_bf16 v[24:27], v[124:127], v[96:99], v[24:27]
    s_waitcnt lgkmcnt(9)
    v_mfma_f32_16x16x32_bf16 v[8:11], v[128:131], v[92:95], v[8:11]
    ds_read_b128 v[124:127], v49 offset:24576
    v_mfma_f32_16x16x32_bf16 v[28:31], v[128:131], v[96:99], v[28:31]
    s_waitcnt lgkmcnt(9)
    v_mfma_f32_16x16x32_bf16 v[12:15], v[132:135], v[92:95], v[12:15]
    ds_read_b128 v[128:131], v49 offset:25600
    v_mfma_f32_16x16x32_bf16 v[32:35], v[132:135], v[96:99], v[32:35]
    s_waitcnt lgkmcnt(9)
    v_mfma_f32_16x16x32_bf16 v[16:19], v[136:139], v[92:95], v[16:19]
    s_waitcnt lgkmcnt(7)
    v_min_u32 v252, v252, v253
    ds_read_b128 v[132:135], v49 offset:26624
    v_mfma_f32_16x16x32_bf16 v[36:39], v[136:139], v[96:99], v[36:39]
    buffer_load_dwordx4 v[84:87], v44, s[12:15], s56 offen sc1
    v_mfma_f32_16x16x32_bf16 v[20:23], v[140:143], v[92:95], v[20:23]
    v_readfirstlane_b32 s92, v252
    ds_read_b128 v[136:139], v49 offset:27648
    v_mfma_f32_16x16x32_bf16 v[40:43], v[140:143], v[96:99], v[40:43]
    buffer_load_dwordx4 v[88:91], v45, s[12:15], s56 offen sc1
    s_add_u32 s56, s56, 2048
    s_cmp_eq_u32 s56, 55296
    s_cselect_b32 s56, 0, s56
    s_waitcnt vmcnt(12) lgkmcnt(8)
    v_mfma_f32_16x16x32_bf16 v[4:7], v[144:147], v[100:103], v[4:7]
    s_cmp_lt_u32 s92, 49
    s_cbranch_scc1 SP_66s
OK_65:
    ds_read_b128 v[140:143], v49 offset:28672
    v_mfma_f32_16x16x32_bf16 v[24:27], v[144:147], v[104:107], v[24:27]
    s_waitcnt lgkmcnt(8)
    v_mfma_f32_16x16x32_bf16 v[8:11], v[148:151], v[100:103], v[8:11]
    v_add_u32 v251, 3, v251
    ds_write_b32 v250, v251
    ds_read_b128 v[144:147], v47 offset:0
    v_mfma_f32_16x16x32_bf16 v[28:31], v[148:151], v[104:107], v[28:31]
    s_waitcnt lgkmcnt(9)
    v_mfma_f32_16x16x32_bf16 v[12:15], v[152:155], v[100:103], v[12:15]
    ds_read_b128 v[148:151], v47 offset:1024
    v_mfma_f32_16x16x32_bf16 v[32:35], v[152:155], v[104:107], v[32:35]
    s_waitcnt lgkmcnt(9)
    v_mfma_f32_16x16x32_bf16 v[16:19], v[156:159], v[100:103], v[16:19]
    ds_read_b128 v[152:155], v47 offset:2048
    v_mfma_f32_16x16x32_bf16 v[36:39], v[156:159], v[104:107], v[36:39]
    buffer_load_dwordx4 v[92:95], v44, s[12:15], s56 offen sc1
    s_waitcnt lgkmcnt(9)
    v_mfma_f32_16x16x32_bf16 v[20:23], v[160:163], v[100:103], v[20:23]
    ds_read_b128 v[156:159], v47 offset:3072
    v_mfma_f32_16x16x32_bf16 v[40:43], v[160:163], v[104:107], v[40:43]
    buffer_load_dwordx4 v[96:99], v45, s[12:15], s56 offen sc1
    s_add_u32 s56, s56, 2048
    s_cmp_eq_u32 s56, 55296
    s_cselect_b32 s56, 0, s56
    s_waitcnt vmcnt(12) lgkmcnt(9)
    v_mfma_f32_16x16x32_bf16 v[4:7], v[124:127], v[108:111], v[4:7]
    ds_read_b128 v[160:163], v47 offset:4096
    v_mfma_f32_16x16x32_bf16 v[24:27], v[124:127], v[112:115], v[24:27]
    ds_read_b64 v[252:253], v254 offset:1024
    s_waitcnt lgkmcnt(10)
    v_mfma_f32_16x16x32_bf16 v[8:11], v[128:131], v[108:111], v[8:11]
    ds_read_b128 v[124:127], v47 offset:10240
    v_mfma_f32_16x16x32_bf16 v[28:31], v[128:131], v[112:115], v[28:31]
    s_waitcnt lgkmcnt(10)
    v_mfma_f32_16x16x32_bf16 v[12:15], v[132:135], v[108:111], v[12:15]
    ds_read_b128 v[128:131], v47 offset:11264
    v_mfma_f32_16x16x32_bf16 v[32:35], v[132:135], v[112:115], v[32:35]
    s_waitcnt lgkmcnt(10)
    v_mfma_f32_16x16x32_bf16 v[16:19], v[136:139], v[108:111], v[16:19]
    ds_read_b128 v[132:135], v47 offset:12288
    v_mfma_f32_16x16x32_bf16 v[36:39], v[136:139], v[112:115], v[36:39]
    buffer_load_dwordx4 v[100:103], v44, s[12:15], s56 offen sc1
    s_waitcnt lgkmcnt(10)
    v_mfma_f32_16x16x32_bf16 v[20:23], v[140:143], v[108:111], v[20:23]
    ds_read_b128 v[136:139], v47 offset:13312
    v_mfma_f32_16x16x32_bf16 v[40:43], v[140:143], v[112:115], v[40:43]
    buffer_load_dwordx4 v[104:107], v45, s[12:15], s56 offen sc1
    s_add_u32 s56, s56, 2048
    s_cmp_eq_u32 s56, 55296
    s_cselect_b32 s56, 0, s56
    s_waitcnt vmcnt(12) lgkmcnt(9)
    v_mfma_f32_16x16x32_bf16 v[4:7], v[144:147], v[116:119], v[4:7]
    ds_read_b128 v[140:143], v47 offset:14336
    v_mfma_f32_16x16x32_bf16 v[24:27], v[144:147], v[120:123], v[24:27]
    s_waitcnt lgkmcnt(9)
    v_mfma_f32_16x16x32_bf16 v[8:11], v[148:151], v[116:119], v[8:11]
    ds_read_b128 v[144:147], v47 offset:20480
    v_mfma_f32_16x16x32_bf16 v[28:31], v[148:151], v[120:123], v[28:31]
    s_waitcnt lgkmcnt(9)
    v_mfma_f32_16x16x32_bf16 v[12:15], v[152:155], v[116:119], v[12:15]
    ds_read_b128 v[148:151], v47 offset:21504
    v_mfma_f32_16x16x32_bf16 v[32:35], v[152:155], v[120:123], v[32:35]
    s_waitcnt lgkmcnt(9)
    v_mfma_f32_16x16x32_bf16 v[16:19], v[156:159], v[116:119], v[16:19]
    s_waitcnt lgkmcnt(7)
    v_min_u32 v252, v252, v253
    ds_read_b128 v[152:155], v47 offset:22528
    v_mfma_f32_16x16x32_bf16 v[36:39], v[156:159], v[120:123], v[36:39]
    buffer_load_dwordx4 v[108:111], v44, s[12:15], s56 offen sc1
    v_mfma_f32_16x16x32_bf16 v[20:23], v[160:163], v[116:119], v[20:23]
    v_readfirstlane_b32 s92, v252
    ds_read_b128 v[156:159], v47 offset:23552
    v_mfma_f32_16x16x32_bf16 v[40:43], v[160:163], v[120:123], v[40:43]
    buffer_load_dwordx4 v[112:115], v45, s[12:15], s56 offen sc1
    s_add_u32 s56, s56, 2048
    s_cmp_eq_u32 s56, 55296
    s_cselect_b32 s56, 0, s56
    s_waitcnt vmcnt(12) lgkmcnt(8)
    v_mfma_f32_16x16x32_bf16 v[4:7], v[124:127], v[60:63], v[4:7]
    s_cmp_lt_u32 s92, 52
    s_cbranch_scc1 SP_68s
OK_67:
    ds_read_b128 v[160:163], v47 offset:24576
    v_mfma_f32_16x16x32_bf16 v[24:27], v[124:127], v[64:67], v[24:27]
    s_waitcnt lgkmcnt(8)
    v_mfma_f32_16x16x32_bf16 v[8:11], v[128:131], v[60:63], v[8:11]
    v_add_u32 v251, 3, v251
    ds_write_b32 v250, v251
    ds_read_b128 v[124:127], v47 offset:30720
    v_mfma_f32_16x16x32_bf16 v[28:31], v[128:131], v[64:67], v[28:31]
    s_waitcnt lgkmcnt(9)
    v_mfma_f32_16x16x32_bf16 v[12:15], v[132:135], v[60:63], v[12:15]
    ds_read_b128 v[128:131], v47 offset:31744
    v_mfma_f32_16x16x32_bf16 v[32:35], v[132:135], v[64:67], v[32:35]
    s_waitcnt lgkmcnt(9)
    v_mfma_f32_16x16x32_bf16 v[16:19], v[136:139], v[60:63], v[16:19]
    ds_read_b128 v[132:135], v47 offset:32768
    v_mfma_f32_16x16x32_bf16 v[36:39], v[136:139], v[64:67], v[36:39]
    buffer_load_dwordx4 v[116:119], v44, s[12:15], s56 offen sc1
    s_waitcnt lgkmcnt(9)
    v_mfma_f32_16x16x32_bf16 v[20:23], v[140:143], v[60:63], v[20:23]
    ds_read_b128 v[136:139], v47 offset:33792
    v_mfma_f32_16x16x32_bf16 v[40:43], v[140:143], v[64:67], v[40:43]
    buffer_load_dwordx4 v[120:123], v45, s[12:15], s56 offen sc1
    s_add_u32 s56, s56, 2048
    s_cmp_eq_u32 s56, 55296
    s_cselect_b32 s56, 0, s56
    s_waitcnt vmcnt(12) lgkmcnt(9)
    v_mfma_f32_16x16x32_bf16 v[4:7], v[144:147], v[68:71], v[4:7]
    ds_read_b128 v[140:143], v47 offset:34816
    v_mfma_f32_16x16x32_bf16 v[24:27], v[144:147], v[72:75], v[24:27]
    ds_read_b64 v[252:253], v254 offset:1024
    s_waitcnt lgkmcnt(10)
    v_mfma_f32_16x16x32_bf16 v[8:11], v[148:151], v[68:71], v[8:11]
    ds_read_b128 v[144:147], v47 offset:40960
    v_mfma_f32_16x16x32_bf16 v[28:31], v[148:151], v[72:75], v[28:31]
    s_waitcnt lgkmcnt(10)
    v_mfma_f32_16x16x32_bf16 v[12:15], v[152:155], v[68:71], v[12:15]
    ds_read_b128 v[148:151], v47 offset:41984
    v_mfma_f32_16x16x32_bf16 v[32:35], v[152:155], v[72:75], v[32:35]
    s_waitcnt lgkmcnt(10)
    v_mfma_f32_16x16x32_bf16 v[16:19], v[156:159], v[68:71], v[16:19]
    ds_read_b128 v[152:155], v47 offset:43008
    v_mfma_f32_16x16x32_bf16 v[36:39], v[156:159], v[72:75], v[36:39]
    buffer_load_dwordx4 v[60:63], v44, s[12:15], s56 offen sc1
    s_waitcnt lgkmcnt(10)
    v_mfma_f32_16x16x32_bf16 v[20:23], v[160:163], v[68:71], v[20:23]
    ds_read_b128 v[156:159], v47 offset:44032
    v_mfma_f32_16x16x32_bf16 v[40:43], v[160:163], v[72:75], v[40:43]
    buffer_load_dwordx4 v[64:67], v45, s[12:15], s56 offen sc1
    s_add_u32 s56, s56, 2048
    s_cmp_eq_u32 s56, 55296
    s_cselect_b32 s56, 0, s56
    s_waitcnt vmcnt(12) lgkmcnt(9)
    v_mfma_f32_16x16x32_bf16 v[4:7], v[124:127], v[76:79], v[4:7]
    ds_read_b128 v[160:163], v47 offset:45056
    v_mfma_f32_16x16x32_bf16 v[24:27], v[124:127], v[80:83], v[24:27]
    s_waitcnt lgkmcnt(9)
    v_mfma_f32_16x16x32_bf16 v[8:11], v[128:131], v[76:79], v[8:11]
    ds_read_b128 v[124:127], v47 offset:51200
    v_mfma_f32_16x16x32_bf16 v[28:31], v[128:131], v[80:83], v[28:31]
    s_waitcnt lgkmcnt(9)
    v_mfma_f32_16x16x32_bf16 v[12:15], v[132:135], v[76:79], v[12:15]
    ds_read_b128 v[128:131], v47 offset:52224
    v_mfma_f32_16x16x32_bf16 v[32:35], v[132:135], v[80:83], v[32:35]
    s_waitcnt lgkmcnt(9)
    v_mfma_f32_16x16x32_bf16 v[16:19], v[136:139], v[76:79], v[16:19]
    s_waitcnt lgkmcnt(7)
    v_min_u32 v252, v252, v253
    ds_read_b128 v[132:135], v47 offset:53248
    v_mfma_f32_16x16x32_bf16 v[36:39], v[136:139], v[80:83], v[36:39]
    buffer_load_dwordx4 v[68:71], v44, s[12:15], s56 offen sc1
    v_mfma_f32_16x16x32_bf16 v[20:23], v[140:143], v[76:79], v[20:23]
    v_readfirstlane_b32 s92, v252
    ds_read_b128 v[136:139], v47 offset:54272
    v_mfma_f32_16x16x32_bf16 v[40:43], v[140:143], v[80:83], v[40:43]
    buffer_load_dwordx4 v[72:75], v45, s[12:15], s56 offen sc1
    s_add_u32 s56, s56, 2048
    s_cmp_eq_u32 s56, 55296
    s_cselect_b32 s56, 0, s56
    s_waitcnt vmcnt(12) lgkmcnt(8)
    v_mfma_f32_16x16x32_bf16 v[4:7], v[144:147], v[84:87], v[4:7]
    s_cmp_lt_u32 s92, 55
    s_cbranch_scc1 SP_70s
OK_69:
    ds_read_b128 v[140:143], v47 offset:55296
    v_mfma_f32_16x16x32_bf16 v[24:27], v[144:147], v[88:91], v[24:27]
    s_waitcnt lgkmcnt(8)
    v_mfma_f32_16x16x32_bf16 v[8:11], v[148:151], v[84:87], v[8:11]
    v_add_u32 v251, 3, v251
    ds_write_b32 v250, v251
    ds_read_b128 v[144:147], v48 offset:0
    v_mfma_f32_16x16x32_bf16 v[28:31], v[148:151], v[88:91], v[28:31]
    s_waitcnt lgkmcnt(9)
    v_mfma_f32_16x16x32_bf16 v[12:15], v[152:155], v[84:87], v[12:15]
    ds_read_b128 v[148:151], v48 offset:1024
    v_mfma_f32_16x16x32_bf16 v[32:35], v[152:155], v[88:91], v[32:35]
    s_waitcnt lgkmcnt(9)
    v_mfma_f32_16x16x32_bf16 v[16:19], v[156:159], v[84:87], v[16:19]
    ds_read_b128 v[152:155], v48 offset:2048
    v_mfma_f32_16x16x32_bf16 v[36:39], v[156:159], v[88:91], v[36:39]
    buffer_load_dwordx4 v[76:79], v44, s[12:15], s56 offen sc1
    s_waitcnt lgkmcnt(9)
    v_mfma_f32_16x16x32_bf16 v[20:23], v[160:163], v[84:87], v[20:23]
    ds_read_b128 v[156:159], v48 offset:3072
    v_mfma_f32_16x16x32_bf16 v[40:43], v[160:163], v[88:91], v[40:43]
    buffer_load_dwordx4 v[80:83], v45, s[12:15], s56 offen sc1
    s_add_u32 s56, s56, 2048
    s_cmp_eq_u32 s56, 55296
    s_cselect_b32 s56, 0, s56
    s_waitcnt vmcnt(12) lgkmcnt(9)
    v_mfma_f32_16x16x32_bf16 v[4:7], v[124:127], v[92:95], v[4:7]
    ds_read_b128 v[160:163], v48 offset:4096
    v_mfma_f32_16x16x32_bf16 v[24:27], v[124:127], v[96:99], v[24:27]
    ds_read_b64 v[252:253], v254 offset:1024
    s_waitcnt lgkmcnt(10)
    v_mfma_f32_16x16x32_bf16 v[8:11], v[128:131], v[92:95], v[8:11]
    ds_read_b128 v[124:127], v48 offset:10240
    v_mfma_f32_16x16x32_bf16 v[28:31], v[128:131], v[96:99], v[28:31]
    s_waitcnt lgkmcnt(10)
    v_mfma_f32_16x16x32_bf16 v[12:15], v[132:135], v[92:95], v[12:15]
    ds_read_b128 v[128:131], v48 offset:11264
    v_mfma_f32_16x16x32_bf16 v[32:35], v[132:135], v[96:99], v[32:35]
    s_waitcnt lgkmcnt(10)
    v_mfma_f32_16x16x32_bf16 v[16:19], v[136:139], v[92:95], v[16:19]
    ds_read_b128 v[132:135], v48 offset:12288
    v_mfma_f32_16x16x32_bf16 v[36:39], v[136:139], v[96:99], v[36:39]
    s_waitcnt lgkmcnt(10)
    v_mfma_f32_16x16x32_bf16 v[20:23], v[140:143], v[92:95], v[20:23]
    ds_read_b128 v[136:139], v48 offset:13312
    v_mfma_f32_16x16x32_bf16 v[40:43], v[140:143], v[96:99], v[40:43]
    s_waitcnt vmcnt(10) lgkmcnt(9)
    v_mfma_f32_16x16x32_bf16 v[4:7], v[144:147], v[100:103], v[4:7]
    ds_read_b128 v[140:143], v48 offset:14336
    v_mfma_f32_16x16x32_bf16 v[24:27], v[144:147], v[104:107], v[24:27]
    s_waitcnt lgkmcnt(9)
    v_mfma_f32_16x16x32_bf16 v[8:11], v[148:151], v[100:103], v[8:11]
    ds_read_b128 v[144:147], v48 offset:20480
    v_mfma_f32_16x16x32_bf16 v[28:31], v[148:151], v[104:107], v[28:31]
    s_waitcnt lgkmcnt(9)
    v_mfma_f32_16x16x32_bf16 v[12:15], v[152:155], v[100:103], v[12:15]
    ds_read_b128 v[148:151], v48 offset:21504
    v_mfma_f32_16x16x32_bf16 v[32:35], v[152:155], v[104:107], v[32:35]
    s_waitcnt lgkmcnt(9)
    v_mfma_f32_16x16x32_bf16 v[16:19], v[156:159], v[100:103], v[16:19]
    s_waitcnt lgkmcnt(7)
    v_min_u32 v252, v252, v253
    ds_read_b128 v[152:155], v48 offset:22528
    v_mfma_f32_16x16x32_bf16 v[36:39], v[156:159], v[104:107], v[36:39]
    v_mfma_f32_16x16x32_bf16 v[20:23], v[160:163], v[100:103], v[20:23]
    v_readfirstlane_b32 s92, v252
    ds_read_b128 v[156:159], v48 offset:23552
    v_mfma_f32_16x16x32_bf16 v[40:43], v[160:163], v[104:107], v[40:43]
    s_waitcnt vmcnt(8) lgkmcnt(8)
    v_mfma_f32_16x16x32_bf16 v[4:7], v[124:127], v[108:111], v[4:7]
    s_cmp_lt_u32 s92, 58
    s_cbranch_scc1 SP_72s
OK_71:
    ds_read_b128 v[160:163], v48 offset:24576
    v_mfma_f32_16x16x32_bf16 v[24:27], v[124:127], v[112:115], v[24:27]
    s_waitcnt lgkmcnt(8)
    v_mfma_f32_16x16x32_bf16 v[8:11], v[128:131], v[108:111], v[8:11]
    v_add_u32 v251, 3, v251
    ds_write_b32 v250, v251
    ds_read_b128 v[124:127], v48 offset:30720
    v_mfma_f32_16x16x32_bf16 v[28:31], v[128:131], v[112:115], v[28:31]
    s_waitcnt lgkmcnt(9)
    v_mfma_f32_16x16x32_bf16 v[12:15], v[132:135], v[108:111], v[12:15]
    ds_read_b128 v[128:131], v48 offset:31744
    v_mfma_f32_16x16x32_bf16 v[32:35], v[132:135], v[112:115], v[32:35]
    s_waitcnt lgkmcnt(9)
    v_mfma_f32_16x16x32_bf16 v[16:19], v[136:139], v[108:111], v[16:19]
    ds_read_b128 v[132:135], v48 offset:32768
    v_mfma_f32_16x16x32_bf16 v[36:39], v[136:139], v[112:115], v[36:39]
    s_waitcnt lgkmcnt(9)
    v_mfma_f32_16x16x32_bf16 v[20:23], v[140:143], v[108:111], v[20:23]
    ds_read_b128 v[136:139], v48 offset:33792
    v_mfma_f32_16x16x32_bf16 v[40:43], v[140:143], v[112:115], v[40:43]
    s_waitcnt vmcnt(6) lgkmcnt(9)
    v_mfma_f32_16x16x32_bf16 v[4:7], v[144:147], v[116:119], v[4:7]
    ds_read_b128 v[140:143], v48 offset:34816
    v_mfma_f32_16x16x32_bf16 v[24:27], v[144:147], v[120:123], v[24:27]
    ds_read_b64 v[252:253], v254 offset:1024
    s_waitcnt lgkmcnt(10)
    v_mfma_f32_16x16x32_bf16 v[8:11], v[148:151], v[116:119], v[8:11]
    ds_read_b128 v[144:147], v49 offset:0
    v_mfma_f32_16x16x32_bf16 v[28:31], v[148:151], v[120:123], v[28:31]
    s_waitcnt lgkmcnt(10)
    v_mfma_f32_16x16x32_bf16 v[12:15], v[152:155], v[116:119], v[12:15]
    ds_read_b128 v[148:151], v49 offset:1024
    v_mfma_f32_16x16x32_bf16 v[32:35], v[152:155], v[120:123], v[32:35]
    s_waitcnt lgkmcnt(10)
    v_mfma_f32_16x16x32_bf16 v[16:19], v[156:159], v[116:119], v[16:19]
    ds_read_b128 v[152:155], v49 offset:2048
    v_mfma_f32_16x16x32_bf16 v[36:39], v[156:159], v[120:123], v[36:39]
    s_waitcnt lgkmcnt(10)
    v_mfma_f32_16x16x32_bf16 v[20:23], v[160:163], v[116:119], v[20:23]
    ds_read_b128 v[156:159], v49 offset:3072
    v_mfma_f32_16x16x32_bf16 v[40:43], v[160:163], v[120:123], v[40:43]
    s_waitcnt vmcnt(4) lgkmcnt(9)
    v_mfma_f32_16x16x32_bf16 v[4:7], v[124:127], v[60:63], v[4:7]
    ds_read_b128 v[160:163], v49 offset:4096
    v_mfma_f32_16x16x32_bf16 v[24:27], v[124:127], v[64:67], v[24:27]
    s_waitcnt lgkmcnt(9)
    v_mfma_f32_16x16x32_bf16 v[8:11], v[128:131], v[60:63], v[8:11]
    ds_read_b128 v[124:127], v49 offset:10240
    v_mfma_f32_16x16x32_bf16 v[28:31], v[128:131], v[64:67], v[28:31]
    ds_read_b32 v53, v54
    s_waitcnt lgkmcnt(10)
    v_mfma_f32_16x16x32_bf16 v[12:15], v[132:135], v[60:63], v[12:15]
    ds_read_b128 v[128:131], v49 offset:11264
    v_mfma_f32_16x16x32_bf16 v[32:35], v[132:135], v[64:67], v[32:35]
    s_waitcnt lgkmcnt(10)
    v_mfma_f32_16x16x32_bf16 v[16:19], v[136:139], v[60:63], v[16:19]
    ds_read_b128 v[132:135], v49 offset:12288
    v_mfma_f32_16x16x32_bf16 v[36:39], v[136:139], v[64:67], v[36:39]
    s_waitcnt lgkmcnt(10)
    v_mfma_f32_16x16x32_bf16 v[20:23], v[140:143], v[60:63], v[20:23]
    ds_read_b128 v[136:139], v49 offset:13312
    v_mfma_f32_16x16x32_bf16 v[40:43], v[140:143], v[64:67], v[40:43]
    s_waitcnt vmcnt(2) lgkmcnt(9)
    v_mfma_f32_16x16x32_bf16 v[4:7], v[144:147], v[68:71], v[4:7]
    ds_read_b128 v[140:143], v49 offset:14336
    v_mfma_f32_16x16x32_bf16 v[24:27], v[144:147], v[72:75], v[24:27]
    s_waitcnt lgkmcnt(9)
    v_mfma_f32_16x16x32_bf16 v[8:11], v[148:151], v[68:71], v[8:11]
    v_add_u32 v251, 3, v251
    ds_write_b32 v250, v251
    v_mfma_f32_16x16x32_bf16 v[28:31], v[148:151], v[72:75], v[28:31]
    s_waitcnt lgkmcnt(9)
    v_mfma_f32_16x16x32_bf16 v[12:15], v[152:155], v[68:71], v[12:15]
    v_mfma_f32_16x16x32_bf16 v[32:35], v[152:155], v[72:75], v[32:35]
    s_waitcnt lgkmcnt(8)
    v_mfma_f32_16x16x32_bf16 v[16:19], v[156:159], v[68:71], v[16:19]
    v_mfma_f32_16x16x32_bf16 v[36:39], v[156:159], v[72:75], v[36:39]
    s_waitcnt lgkmcnt(5)
    v_cmp_le_u32 vcc, 56, v53
    s_nop 0
    s_cmp_lg_u64 vcc, -1
    s_cbranch_scc1 SP_76s
OK_75:
    s_xor_b32 s49, s40, 1
    s_lshl_b32 s49, s49, 8
    s_add_u32 s49, s49, 144384
    v_mov_b32 v54, s49
    v_mfma_f32_16x16x32_bf16 v[20:23], v[160:163], v[68:71], v[20:23]
    v_mfma_f32_16x16x32_bf16 v[40:43], v[160:163], v[72:75], v[40:43]
    s_waitcnt vmcnt(0)
    v_mfma_f32_16x16x32_bf16 v[24:27], v[124:127], v[80:83], v[24:27]
    s_waitcnt lgkmcnt(4)
    v_mfma_f32_16x16x32_bf16 v[28:31], v[128:131], v[80:83], v[28:31]
    s_waitcnt lgkmcnt(3)
    v_mfma_f32_16x16x32_bf16 v[32:35], v[132:135], v[80:83], v[32:35]
    s_waitcnt lgkmcnt(2)
    v_mfma_f32_16x16x32_bf16 v[36:39], v[136:139], v[80:83], v[36:39]
    s_waitcnt lgkmcnt(1)
    v_mfma_f32_16x16x32_bf16 v[40:43], v[140:143], v[80:83], v[40:43]
    v_mfma_f32_16x16x32_bf16 v[4:7], v[124:127], v[76:79], v[4:7]
    ds_write_b128 v55, v[24:27] offset:0
    v_mfma_f32_16x16x32_bf16 v[8:11], v[128:131], v[76:79], v[8:11]
    ds_write_b128 v55, v[28:31] offset:1024
    v_mfma_f32_16x16x32_bf16 v[12:15], v[132:135], v[76:79], v[12:15]
    ds_write_b128 v55, v[32:35] offset:2048
    v_mfma_f32_16x16x32_bf16 v[16:19], v[136:139], v[76:79], v[16:19]
    ds_write_b128 v55, v[36:39] offset:3072
    v_mfma_f32_16x16x32_bf16 v[20:23], v[140:143], v[76:79], v[20:23]
    ds_write_b128 v55, v[40:43] offset:4096
    v_add_u32 v251, 1, v251
    ds_write_b32 v250, v251
    s_mov_b32 s91, 0
SP_78:
    ds_read_b32 v53, v54
    s_add_u32 s91, s91, 1
    s_waitcnt lgkmcnt(0)
    v_cmp_le_u32 vcc, 69, v53
    s_cmp_ge_u32 s91, 400000
    s_cbranch_scc1 OK_77
    s_cmp_lg_u64 vcc, -1
    s_cbranch_scc1 SP_78
OK_77:
    ds_read_b128 v[24:27], v56 offset:0
    ds_read_b128 v[28:31], v56 offset:1024
    ds_read_b128 v[32:35], v56 offset:2048
    ds_read_b128 v[36:39], v56 offset:3072
    ds_read_b128 v[40:43], v56 offset:4096
    s_waitcnt lgkmcnt(4)
    v_pk_add_f32 v[4:5], v[4:5], v[24:25]
    v_pk_add_f32 v[6:7], v[6:7], v[26:27]
    v_cvt_pk_bf16_f32 v164, v4, v5
    v_cvt_pk_bf16_f32 v165, v6, v7
    ds_write_b64 v174, v[164:165] offset:0
    s_waitcnt lgkmcnt(4)
    v_pk_add_f32 v[8:9], v[8:9], v[28:29]
    v_pk_add_f32 v[10:11], v[10:11], v[30:31]
    v_cvt_pk_bf16_f32 v166, v8, v9
    v_cvt_pk_bf16_f32 v167, v10, v11
    ds_write_b64 v174, v[166:167] offset:32
    s_waitcnt lgkmcnt(4)
    v_pk_add_f32 v[12:13], v[12:13], v[32:33]
    v_pk_add_f32 v[14:15], v[14:15], v[34:35]
    v_cvt_pk_bf16_f32 v168, v12, v13
    v_cvt_pk_bf16_f32 v169, v14, v15
    ds_write_b64 v174, v[168:169] offset:64
    s_waitcnt lgkmcnt(4)
    v_pk_add_f32 v[16:17], v[16:17], v[36:37]
    v_pk_add_f32 v[18:19], v[18:19], v[38:39]
    v_cvt_pk_bf16_f32 v170, v16, v17
    v_cvt_pk_bf16_f32 v171, v18, v19
    ds_write_b64 v174, v[170:171] offset:96
    s_waitcnt lgkmcnt(4)
    v_pk_add_f32 v[20:21], v[20:21], v[40:41]
    v_pk_add_f32 v[22:23], v[22:23], v[42:43]
    v_cvt_pk_bf16_f32 v172, v20, v21
    v_cvt_pk_bf16_f32 v173, v22, v23
    ds_write_b64 v174, v[172:173] offset:128
    s_waitcnt lgkmcnt(0)
    ds_read_b128 v[24:27], v175 offset:0
    ds_read_b128 v[28:31], v175 offset:1056
    ds_read_b128 v[32:35], v175 offset:2112
    s_mov_b32 exec_hi, 0x0fffffff
    s_waitcnt lgkmcnt(2)
    buffer_store_dwordx4 v[24:27], v176, s[4:7], s53 offen
    s_waitcnt lgkmcnt(1)
    buffer_store_dwordx4 v[28:31], v176, s[4:7], s54 offen
    s_waitcnt lgkmcnt(0)
    s_mov_b32 exec_hi, 0xff
    buffer_store_dwordx4 v[32:35], v176, s[4:7], s55 offen
    s_mov_b64 exec, -1
    s_endpgm
LWAVE:
    s_setprio 3
    s_sub_u32 s46, s40, 4
    v_lshrrev_b32 v12, 3, v0
    s_lshl_b32 s62, s46, 3
    v_add_u32 v19, s62, v12
    v_lshrrev_b32 v15, 4, v0
    v_and_b32 v17, 7, v0
    v_xor_b32 v16, v15, v17
    v_lshlrev_b32 v16, 4, v16
    s_lshl_b32 s62, s46, 6
    v_xor_b32 v16, s62, v16
    s_movk_i32 s59, 1280
    v_mad_u32_u24 v2, v19, s59, v16
    v_min_u32 v12, 59, v0
    v_cmp_lt_u32 vcc, 29, v12
    s_nop 1
    v_cndmask_b32 v13, 0, 1, vcc
    v_mul_u32_u24 v14, 30, v13
    v_sub_u32 v18, v12, v14
    v_mul_u32_u24 v14, 26, v18
    v_lshrrev_b32 v14, 8, v14
    v_mul_u32_u24 v14, 1120, v14
    v_lshl_add_u32 v18, v18, 4, v14
    v_mul_u32_u24 v13, 30720, v13
    s_mul_i32 s55, s46, 15360
    v_add3_u32 v8, v18, v13, s55
    s_cmp_eq_u32 s46, 0
    s_cselect_b32 s56, 0xffffff00, -1
    s_lshl_b32 s50, s46, 10
    s_mul_i32 s61, s46, 4352
    s_add_u32 s61, s61, 30720
    s_mov_b32 s49, s61
    s_mov_b32 s51, 0
    v_add_u32 v9, 2752, v8
    v_add_u32 v10, 5504, v8
    v_add_u32 v11, 8256, v8
    v_and_b32 v4, 3, v0
    v_lshlrev_b32 v4, 8, v4
    v_add_u32 v4, 144384, v4
    v_mov_b32 v254, 144384
    s_lshl_b32 s55, s46, 2
    s_add_u32 s55, s55, 145408
    v_mov_b32 v7, s55
    s_waitcnt lgkmcnt(0)
    s_mov_b32 s12, s34
    s_mov_b32 s13, s35
    s_mov_b32 s14, 0x1600000
    s_mov_b32 s15, 0x20000
    s_mov_b32 s4, s16
    s_mov_b32 s5, s17
    s_mov_b32 s6, 0x280000
    s_mov_b32 s7, 0x20000
    s_mov_b32 s8, s18
    s_mov_b32 s9, s19
    s_mov_b32 s10, 0x258000
    s_mov_b32 s11, 0x20000
    v_mov_b32 v12, 145664
    s_barrier
    ds_read_b32 v12, v12
    s_waitcnt lgkmcnt(0)
    v_readfirstlane_b32 s2, v12
    s_nop 0
    s_and_b32 s41, s2, 7
    s_lshl_b32 s41, s41, 1
    s_lshr_b32 s42, s2, 7
    s_add_u32 s41, s41, s42
    s_lshr_b32 s42, s2, 3
    s_and_b32 s42, s42, 15
    s_lshr_b32 s43, s42, 3
    s_lshl_b32 s44, s41, 1
    s_add_u32 s43, s43, s44
    s_and_b32 s44, s42, 7
    s_mul_i32 s3, s43, 2
    s_mul_i32 s91, s44, 1
    s_add_u32 s3, s3, s91
    s_mul_i32 s91, s3, 147
    s_lshr_b32 s91, s91, 10
    s_mul_i32 s91, s91, 7
    s_sub_u32 s3, s3, s91
    s_mul_i32 s62, s44, 160
    s_add_u32 s8, s8, s62
    s_addc_u32 s9, s9, 0
    s_sub_u32 s10, s10, s62
    s_mov_b32 s48, 0
    s_lshl_b32 s52, s43, 6
    s_sub_u32 s62, s52, 16
    v_add_u32 v13, s62, v19
    v_max_i32 v13, 0, v13
    v_mad_u32_u24 v1, v13, s59, v16
    s_mulk_i32 s52, 1280
    s_mov_b32 s47, 0
    s_add_u32 s55, s3, 3
    s_mul_i32 s69, s55, 245760
    s_lshl_b32 s68, s55, 7
    s_mov_b32 s66, 384
    s_mov_b32 s67, 737280
    s_mov_b32 m0, s49
    s_add_u32 s53, s48, 61440
    buffer_load_dwordx4 v8, s[8:11], s48 offen lds
    buffer_load_dwordx4 v9, s[8:11], s48 offen offset:1088 lds
    buffer_load_dwordx4 v10, s[8:11], s48 offen offset:2176 lds
    buffer_load_dwordx4 v11, s[8:11], s48 offen offset:3264 lds
    s_add_u32 m0, m0, 8704
    s_add_u32 s48, s48, 122880
    buffer_load_dwordx4 v8, s[8:11], s53 offen lds
    buffer_load_dwordx4 v9, s[8:11], s53 offen offset:1088 lds
    buffer_load_dwordx4 v10, s[8:11], s53 offen offset:2176 lds
    buffer_load_dwordx4 v11, s[8:11], s53 offen offset:3264 lds
    s_cmp_eq_u32 s48, 2457600
    s_cselect_b32 s48, 737280, s48
    s_cmp_eq_u32 s48, s67
    s_cselect_b32 s48, s69, s48
    s_cselect_b32 s67, -1, s67
    s_add_u32 s49, s49, 17408
    s_cmp_ge_u32 s49, 135168
    s_cselect_b32 s49, s61, s49
    s_mov_b32 m0, s50
    s_mov_b32 exec_lo, s56
    buffer_load_dwordx4 v1, s[4:7], s47 offen lds
    s_mov_b64 exec, -1
    s_add_u32 s53, s47, s52
    s_add_u32 m0, m0, 2048
    s_add_u32 s47, s47, 128
    buffer_load_dwordx4 v2, s[4:7], s53 offen lds
    s_add_u32 m0, m0, 2048
    s_add_u32 s53, s53, 20480
    buffer_load_dwordx4 v2, s[4:7], s53 offen lds
    s_add_u32 m0, m0, 2048
    s_add_u32 s53, s53, 20480
    buffer_load_dwordx4 v2, s[4:7], s53 offen lds
    s_add_u32 m0, m0, 2048
    s_add_u32 s53, s53, 20480
    buffer_load_dwordx4 v2, s[4:7], s53 offen lds
    s_cmp_eq_u32 s47, 1280
    s_cselect_b32 s47, 384, s47
    s_cmp_eq_u32 s47, s66
    s_cselect_b32 s47, s68, s47
    s_cselect_b32 s66, -1, s66
    s_add_u32 s50, s50, 10240
    s_cmp_ge_u32 s50, 30720
    s_cselect_b32 s55, 30720, 0
    s_sub_u32 s50, s50, s55
    s_mov_b32 m0, s49
    s_add_u32 s53, s48, 61440
    buffer_load_dwordx4 v8, s[8:11], s48 offen lds
    buffer_load_dwordx4 v9, s[8:11], s48 offen offset:1088 lds
    buffer_load_dwordx4 v10, s[8:11], s48 offen offset:2176 lds
    buffer_load_dwordx4 v11, s[8:11], s48 offen offset:3264 lds
    s_add_u32 m0, m0, 8704
    s_add_u32 s48, s48, 122880
    buffer_load_dwordx4 v8, s[8:11], s53 offen lds
    buffer_load_dwordx4 v9, s[8:11], s53 offen offset:1088 lds
    buffer_load_dwordx4 v10, s[8:11], s53 offen offset:2176 lds
    buffer_load_dwordx4 v11, s[8:11], s53 offen offset:3264 lds
    s_cmp_eq_u32 s48, 2457600
    s_cselect_b32 s48, 737280, s48
    s_cmp_eq_u32 s48, s67
    s_cselect_b32 s48, s69, s48
    s_cselect_b32 s67, -1, s67
    s_add_u32 s49, s49, 17408
    s_cmp_ge_u32 s49, 135168
    s_cselect_b32 s49, s61, s49
    s_mov_b32 m0, s50
    s_mov_b32 exec_lo, s56
    buffer_load_dwordx4 v1, s[4:7], s47 offen lds
    s_mov_b64 exec, -1
    s_add_u32 s53, s47, s52
    s_add_u32 m0, m0, 2048
    s_add_u32 s47, s47, 128
    buffer_load_dwordx4 v2, s[4:7], s53 offen lds
    s_add_u32 m0, m0, 2048
    s_add_u32 s53, s53, 20480
    buffer_load_dwordx4 v2, s[4:7], s53 offen lds
    s_add_u32 m0, m0, 2048
    s_add_u32 s53, s53, 20480
    buffer_load_dwordx4 v2, s[4:7], s53 offen lds
    s_add_u32 m0, m0, 2048
    s_add_u32 s53, s53, 20480
    buffer_load_dwordx4 v2, s[4:7], s53 offen lds
    s_cmp_eq_u32 s47, 1280
    s_cselect_b32 s47, 384, s47
    s_cmp_eq_u32 s47, s66
    s_cselect_b32 s47, s68, s47
    s_cselect_b32 s66, -1, s66
    s_add_u32 s50, s50, 10240
    s_cmp_ge_u32 s50, 30720
    s_cselect_b32 s55, 30720, 0
    s_sub_u32 s50, s50, s55
    s_mov_b32 m0, s49
    s_add_u32 s53, s48, 61440
    buffer_load_dwordx4 v8, s[8:11], s48 offen lds
    buffer_load_dwordx4 v9, s[8:11], s48 offen offset:1088 lds
    buffer_load_dwordx4 v10, s[8:11], s48 offen offset:2176 lds
    buffer_load_dwordx4 v11, s[8:11], s48 offen offset:3264 lds
    s_add_u32 m0, m0, 8704
    s_add_u32 s48, s48, 122880
    buffer_load_dwordx4 v8, s[8:11], s53 offen lds
    buffer_load_dwordx4 v9, s[8:11], s53 offen offset:1088 lds
    buffer_load_dwordx4 v10, s[8:11], s53 offen offset:2176 lds
    buffer_load_dwordx4 v11, s[8:11], s53 offen offset:3264 lds
    s_cmp_eq_u32 s48, 2457600
    s_cselect_b32 s48, 737280, s48
    s_cmp_eq_u32 s48, s67
    s_cselect_b32 s48, s69, s48
    s_cselect_b32 s67, -1, s67
    s_add_u32 s49, s49, 17408
    s_cmp_ge_u32 s49, 135168
    s_cselect_b32 s49, s61, s49
    s_mov_b32 m0, s49
    s_add_u32 s53, s48, 61440
    buffer_load_dwordx4 v8, s[8:11], s48 offen lds
    buffer_load_dwordx4 v9, s[8:11], s48 offen offset:1088 lds
    buffer_load_dwordx4 v10, s[8:11], s48 offen offset:2176 lds
    buffer_load_dwordx4 v11, s[8:11], s48 offen offset:3264 lds
    s_add_u32 m0, m0, 8704
    s_add_u32 s48, s48, 122880
    buffer_load_dwordx4 v8, s[8:11], s53 offen lds
    buffer_load_dwordx4 v9, s[8:11], s53 offen offset:1088 lds
    buffer_load_dwordx4 v10, s[8:11], s53 offen offset:2176 lds
    buffer_load_dwordx4 v11, s[8:11], s53 offen offset:3264 lds
    s_cmp_eq_u32 s48, 2457600
    s_cselect_b32 s48, 737280, s48
    s_cmp_eq_u32 s48, s67
    s_cselect_b32 s48, s69, s48
    s_cselect_b32 s67, -1, s67
    s_add_u32 s49, s49, 17408
    s_cmp_ge_u32 s49, 135168
    s_cselect_b32 s49, s61, s49
    s_waitcnt vmcnt(29)
    v_mov_b32 v6, 1
    s_mov_b64 exec, 1
    ds_max_u32 v7, v6
    s_mov_b64 exec, -1
    s_waitcnt vmcnt(21)
    v_mov_b32 v6, 2
    s_mov_b64 exec, 1
    ds_max_u32 v7, v6
    s_mov_b64 exec, -1
    s_mov_b32 m0, s49
    s_add_u32 s53, s48, 61440
    buffer_load_dwordx4 v8, s[8:11], s48 offen lds
    buffer_load_dwordx4 v9, s[8:11], s48 offen offset:1088 lds
    buffer_load_dwordx4 v10, s[8:11], s48 offen offset:2176 lds
    buffer_load_dwordx4 v11, s[8:11], s48 offen offset:3264 lds
    s_add_u32 m0, m0, 8704
    s_add_u32 s48, s48, 122880
    buffer_load_dwordx4 v8, s[8:11], s53 offen lds
    buffer_load_dwordx4 v9, s[8:11], s53 offen offset:1088 lds
    buffer_load_dwordx4 v10, s[8:11], s53 offen offset:2176 lds
    buffer_load_dwordx4 v11, s[8:11], s53 offen offset:3264 lds
    s_cmp_eq_u32 s48, 2457600
    s_cselect_b32 s48, 737280, s48
    s_cmp_eq_u32 s48, s67
    s_cselect_b32 s48, s69, s48
    s_cselect_b32 s67, -1, s67
    s_add_u32 s49, s49, 17408
    s_cmp_ge_u32 s49, 135168
    s_cselect_b32 s49, s61, s49
    s_waitcnt vmcnt(16)
    v_mov_b32 v6, 3
    s_mov_b64 exec, 1
    ds_max_u32 v7, v6
    s_mov_b64 exec, -1
    s_mov_b32 m0, s50
    s_mov_b32 exec_lo, s56
    buffer_load_dwordx4 v1, s[4:7], s47 offen lds
    s_mov_b64 exec, -1
    s_add_u32 s53, s47, s52
    s_add_u32 m0, m0, 2048
    s_add_u32 s47, s47, 128
    buffer_load_dwordx4 v2, s[4:7], s53 offen lds
    s_add_u32 m0, m0, 2048
    s_add_u32 s53, s53, 20480
    buffer_load_dwordx4 v2, s[4:7], s53 offen lds
    s_add_u32 m0, m0, 2048
    s_add_u32 s53, s53, 20480
    buffer_load_dwordx4 v2, s[4:7], s53 offen lds
    s_add_u32 m0, m0, 2048
    s_add_u32 s53, s53, 20480
    buffer_load_dwordx4 v2, s[4:7], s53 offen lds
    s_cmp_eq_u32 s47, 1280
    s_cselect_b32 s47, 384, s47
    s_cmp_eq_u32 s47, s66
    s_cselect_b32 s47, s68, s47
    s_cselect_b32 s66, -1, s66
    s_add_u32 s50, s50, 10240
    s_cmp_ge_u32 s50, 30720
    s_cselect_b32 s55, 30720, 0
    s_sub_u32 s50, s50, s55
    s_mov_b32 m0, s49
    s_add_u32 s53, s48, 61440
    buffer_load_dwordx4 v8, s[8:11], s48 offen lds
    buffer_load_dwordx4 v9, s[8:11], s48 offen offset:1088 lds
    buffer_load_dwordx4 v10, s[8:11], s48 offen offset:2176 lds
    buffer_load_dwordx4 v11, s[8:11], s48 offen offset:3264 lds
    s_add_u32 m0, m0, 8704
    s_add_u32 s48, s48, 122880
    buffer_load_dwordx4 v8, s[8:11], s53 offen lds
    buffer_load_dwordx4 v9, s[8:11], s53 offen offset:1088 lds
    buffer_load_dwordx4 v10, s[8:11], s53 offen offset:2176 lds
    buffer_load_dwordx4 v11, s[8:11], s53 offen offset:3264 lds
    s_cmp_eq_u32 s48, 2457600
    s_cselect_b32 s48, 737280, s48
    s_cmp_eq_u32 s48, s67
    s_cselect_b32 s48, s69, s48
    s_cselect_b32 s67, -1, s67
    s_add_u32 s49, s49, 17408
    s_cmp_ge_u32 s49, 135168
    s_cselect_b32 s49, s61, s49
    ds_read_b32 v5, v4
    s_waitcnt vmcnt(21)
    v_mov_b32 v6, 4
    s_mov_b64 exec, 1
    ds_max_u32 v7, v6
    s_mov_b64 exec, -1
    s_mov_b32 s57, 1
    s_mov_b32 s58, 5
LW1LOOP:
    s_add_u32 s55, s58, 1
    s_waitcnt lgkmcnt(1)
    v_cmp_le_u32 vcc, s57, v5
    s_nop 0
    s_cmp_lg_u64 vcc, -1
    s_cbranch_scc1 SP_80s
OK_79:
    s_mov_b32 m0, s49
    s_add_u32 s53, s48, 61440
    buffer_load_dwordx4 v8, s[8:11], s48 offen lds
    buffer_load_dwordx4 v9, s[8:11], s48 offen offset:1088 lds
    buffer_load_dwordx4 v10, s[8:11], s48 offen offset:2176 lds
    buffer_load_dwordx4 v11, s[8:11], s48 offen offset:3264 lds
    s_add_u32 m0, m0, 8704
    s_add_u32 s48, s48, 122880
    buffer_load_dwordx4 v8, s[8:11], s53 offen lds
    buffer_load_dwordx4 v9, s[8:11], s53 offen offset:1088 lds
    buffer_load_dwordx4 v10, s[8:11], s53 offen offset:2176 lds
    buffer_load_dwordx4 v11, s[8:11], s53 offen offset:3264 lds
    s_cmp_eq_u32 s48, 2457600
    s_cselect_b32 s48, 737280, s48
    s_cmp_eq_u32 s48, s67
    s_cselect_b32 s48, s69, s48
    s_cselect_b32 s67, -1, s67
    s_add_u32 s49, s49, 17408
    s_cmp_ge_u32 s49, 135168
    s_cselect_b32 s49, s61, s49
    ds_read_b32 v5, v4
    s_waitcnt vmcnt(16)
    v_mov_b32 v6, s58
    s_mov_b64 exec, 1
    ds_max_u32 v7, v6
    s_mov_b64 exec, -1
    s_add_u32 s57, s57, 1
    s_add_u32 s58, s58, 1
    s_waitcnt lgkmcnt(1)
    v_cmp_le_u32 vcc, s57, v5
    s_nop 0
    s_cmp_lg_u64 vcc, -1
    s_cbranch_scc1 SP_82s
OK_81:
    s_mov_b32 m0, s50
    s_mov_b32 exec_lo, s56
    buffer_load_dwordx4 v1, s[4:7], s47 offen lds
    s_mov_b64 exec, -1
    s_add_u32 s53, s47, s52
    s_add_u32 m0, m0, 2048
    s_add_u32 s47, s47, 128
    buffer_load_dwordx4 v2, s[4:7], s53 offen lds
    s_add_u32 m0, m0, 2048
    s_add_u32 s53, s53, 20480
    buffer_load_dwordx4 v2, s[4:7], s53 offen lds
    s_add_u32 m0, m0, 2048
    s_add_u32 s53, s53, 20480
    buffer_load_dwordx4 v2, s[4:7], s53 offen lds
    s_add_u32 m0, m0, 2048
    s_add_u32 s53, s53, 20480
    buffer_load_dwordx4 v2, s[4:7], s53 offen lds
    s_cmp_eq_u32 s47, 1280
    s_cselect_b32 s47, 384, s47
    s_cmp_eq_u32 s47, s66
    s_cselect_b32 s47, s68, s47
    s_cselect_b32 s66, -1, s66
    s_add_u32 s50, s50, 10240
    s_cmp_ge_u32 s50, 30720
    s_cselect_b32 s55, 30720, 0
    s_sub_u32 s50, s50, s55
    s_mov_b32 m0, s49
    s_add_u32 s53, s48, 61440
    buffer_load_dwordx4 v8, s[8:11], s48 offen lds
    buffer_load_dwordx4 v9, s[8:11], s48 offen offset:1088 lds
    buffer_load_dwordx4 v10, s[8:11], s48 offen offset:2176 lds
    buffer_load_dwordx4 v11, s[8:11], s48 offen offset:3264 lds
    s_add_u32 m0, m0, 8704
    s_add_u32 s48, s48, 122880
    buffer_load_dwordx4 v8, s[8:11], s53 offen lds
    buffer_load_dwordx4 v9, s[8:11], s53 offen offset:1088 lds
    buffer_load_dwordx4 v10, s[8:11], s53 offen offset:2176 lds
    buffer_load_dwordx4 v11, s[8:11], s53 offen offset:3264 lds
    s_cmp_eq_u32 s48, 2457600
    s_cselect_b32 s48, 737280, s48
    s_cmp_eq_u32 s48, s67
    s_cselect_b32 s48, s69, s48
    s_cselect_b32 s67, -1, s67
    s_add_u32 s49, s49, 17408
    s_cmp_ge_u32 s49, 135168
    s_cselect_b32 s49, s61, s49
    ds_read_b32 v5, v4
    s_waitcnt vmcnt(21)
    v_mov_b32 v6, s58
    s_mov_b64 exec, 1
    ds_max_u32 v7, v6
    s_mov_b64 exec, -1
    s_add_u32 s57, s57, 1
    s_add_u32 s58, s58, 1
    s_add_u32 s51, s51, 1
    s_cmp_lt_u32 s51, 7
    s_cbranch_scc1 LW1LOOP
    s_waitcnt vmcnt(8)
    v_mov_b32 v6, 19
    s_mov_b64 exec, 1
    ds_max_u32 v7, v6
    s_mov_b64 exec, -1
    s_waitcnt vmcnt(0)
    v_mov_b32 v6, 20
    s_mov_b64 exec, 1
    ds_max_u32 v7, v6
    s_mov_b64 exec, -1
    v_lshlrev_b32 v3, 4, v0
    s_mul_i32 s55, s44, 160
    s_mul_i32 s62, s42, 224
    s_movk_i32 s59, 1280
    s_movk_i32 s60, 3456
    s_mul_i32 s54, s46, 160
    v_add_u32 v19, s54, v0
    v_add_u32 v13, 0, v19
    v_mul_u32_u24 v12, 205, v13
    v_lshrrev_b32 v12, 11, v12
    v_mul_u32_u24 v14, 10, v12
    v_sub_u32 v13, v13, v14
    v_lshl_add_u32 v13, v13, 4, s55
    v_bfe_u32 v14, v12, 2, 2
    v_and_b32 v15, 3, v12
    v_lshrrev_b32 v16, 4, v12
    v_lshrrev_b32 v17, 1, v14
    v_lshl_add_u32 v17, v17, 2, v15
    v_lshl_add_u32 v17, v14, 3, v17
    v_lshl_add_u32 v17, v16, 2, v17
    v_mad_u32_u24 v20, v17, s59, v13
    v_lshl_add_u32 v17, v14, 1, v16
    v_mul_u32_u24 v17, 20, v17
    v_add3_u32 v17, v17, v15, 16
    v_mad_u32_u24 v23, v17, s59, v13
    v_add_u32 v13, 64, v19
    v_mul_u32_u24 v12, 205, v13
    v_lshrrev_b32 v12, 11, v12
    v_mul_u32_u24 v14, 10, v12
    v_sub_u32 v13, v13, v14
    v_lshl_add_u32 v13, v13, 4, s55
    v_bfe_u32 v14, v12, 2, 2
    v_and_b32 v15, 3, v12
    v_lshrrev_b32 v16, 4, v12
    v_lshrrev_b32 v17, 1, v14
    v_lshl_add_u32 v17, v17, 2, v15
    v_lshl_add_u32 v17, v14, 3, v17
    v_lshl_add_u32 v17, v16, 2, v17
    v_mad_u32_u24 v21, v17, s59, v13
    v_lshl_add_u32 v17, v14, 1, v16
    v_mul_u32_u24 v17, 20, v17
    v_add3_u32 v17, v17, v15, 16
    v_mad_u32_u24 v24, v17, s59, v13
    v_add_u32 v13, 128, v19
    v_mul_u32_u24 v12, 205, v13
    v_lshrrev_b32 v12, 11, v12
    v_mul_u32_u24 v14, 10, v12
    v_sub_u32 v13, v13, v14
    v_lshl_add_u32 v13, v13, 4, s55
    v_bfe_u32 v14, v12, 2, 2
    v_and_b32 v15, 3, v12
    v_lshrrev_b32 v16, 4, v12
    v_lshrrev_b32 v17, 1, v14
    v_lshl_add_u32 v17, v17, 2, v15
    v_lshl_add_u32 v17, v14, 3, v17
    v_lshl_add_u32 v17, v16, 2, v17
    v_mad_u32_u24 v22, v17, s59, v13
    v_lshl_add_u32 v17, v14, 1, v16
    v_mul_u32_u24 v17, 20, v17
    v_add3_u32 v17, v17, v15, 16
    v_mad_u32_u24 v25, v17, s59, v13
    s_mov_b32 s36, s20
    s_mov_b32 s37, s21
    s_mov_b32 s38, 0xc8000
    s_mov_b32 s39, 0x20000
    s_mul_i32 s61, s46, 2560
    s_waitcnt vmcnt(0)
    v_mov_b32 v6, 20
    s_mov_b64 exec, 1
    ds_max_u32 v7, v6
    s_mov_b64 exec, -1
    s_mov_b32 s91, 0
SP_84:
    s_sleep 1
    ds_read_b32 v5, v4
    s_add_u32 s91, s91, 1
    s_waitcnt lgkmcnt(0)
    v_cmp_le_u32 vcc, 17, v5
    s_cmp_ge_u32 s91, 400000
    s_cbranch_scc1 OK_83
    s_cmp_lg_u64 vcc, -1
    s_cbranch_scc1 SP_84
OK_83:
    s_add_u32 m0, s61, 66560
    s_mov_b32 s53, 563200
    buffer_load_dwordx4 v20, s[36:39], s53 offen lds
    s_add_u32 m0, m0, 1024
    s_nop 0
    buffer_load_dwordx4 v21, s[36:39], s53 offen lds
    s_add_u32 m0, m0, 1024
    s_mov_b32 exec_hi, 0
    buffer_load_dwordx4 v22, s[36:39], s53 offen lds
    s_mov_b32 exec_hi, -1
    s_add_u32 m0, m0, 3072
    s_mov_b32 s53, 409600
    buffer_load_dwordx4 v23, s[36:39], s53 offen lds
    s_add_u32 m0, m0, 1024
    s_nop 0
    buffer_load_dwordx4 v24, s[36:39], s53 offen lds
    s_add_u32 m0, m0, 1024
    s_mov_b32 exec_hi, 0
    buffer_load_dwordx4 v25, s[36:39], s53 offen lds
    s_mov_b32 exec_hi, -1
    s_add_u32 m0, m0, 3072
    s_mov_b32 s53, 614400
    buffer_load_dwordx4 v20, s[36:39], s53 offen lds
    s_add_u32 m0, m0, 1024
    s_nop 0
    buffer_load_dwordx4 v21, s[36:39], s53 offen lds
    s_add_u32 m0, m0, 1024
    s_mov_b32 exec_hi, 0
    buffer_load_dwordx4 v22, s[36:39], s53 offen lds
    s_mov_b32 exec_hi, -1
    s_add_u32 m0, m0, 3072
    s_mov_b32 s53, 665600
    buffer_load_dwordx4 v20, s[36:39], s53 offen lds
    s_add_u32 m0, m0, 1024
    s_nop 0
    buffer_load_dwordx4 v21, s[36:39], s53 offen lds
    s_add_u32 m0, m0, 1024
    s_mov_b32 exec_hi, 0
    buffer_load_dwordx4 v22, s[36:39], s53 offen lds
    s_mov_b32 exec_hi, -1
    s_add_u32 m0, m0, 3072
    s_mov_b32 s53, 716800
    buffer_load_dwordx4 v20, s[36:39], s53 offen lds
    s_add_u32 m0, m0, 1024
    s_nop 0
    buffer_load_dwordx4 v21, s[36:39], s53 offen lds
    s_add_u32 m0, m0, 1024
    s_mov_b32 exec_hi, 0
    buffer_load_dwordx4 v22, s[36:39], s53 offen lds
    s_mov_b32 exec_hi, -1
    s_add_u32 m0, m0, 3072
    s_mov_b32 s53, 768000
    buffer_load_dwordx4 v20, s[36:39], s53 offen lds
    s_add_u32 m0, m0, 1024
    s_nop 0
    buffer_load_dwordx4 v21, s[36:39], s53 offen lds
    s_add_u32 m0, m0, 1024
    s_mov_b32 exec_hi, 0
    buffer_load_dwordx4 v22, s[36:39], s53 offen lds
    s_mov_b32 exec_hi, -1
    s_add_u32 m0, m0, 3072
    s_mov_b32 s53, 614400
    buffer_load_dwordx4 v23, s[36:39], s53 offen lds
    s_add_u32 m0, m0, 1024
    s_nop 0
    buffer_load_dwordx4 v24, s[36:39], s53 offen lds
    s_add_u32 m0, m0, 1024
    s_mov_b32 exec_hi, 0
    buffer_load_dwordx4 v25, s[36:39], s53 offen lds
    s_mov_b32 exec_hi, -1
    s_add_u32 m0, m0, 3072
    v_mov_b32 v18, 0x40000000
    s_and_b32 s54, s42, 1
    s_lshl_b32 s54, s54, 1
    v_add_u32 v13, 0, v0
    v_mul_u32_u24 v12, 586, v13
    v_lshrrev_b32 v12, 13, v12
    v_mul_u32_u24 v14, 14, v12
    v_sub_u32 v13, v13, v14
    v_add_u32 v13, s54, v13
    v_add_u32 v14, -14, v13
    v_min_u32 v13, v13, v14
    v_lshl_add_u32 v13, v13, 4, s62
    v_bfe_u32 v14, v12, 2, 2
    v_and_b32 v15, 3, v12
    v_lshrrev_b32 v16, 4, v12
    v_mad_u32_u24 v26, v12, s60, v13
    v_lshl_add_u32 v17, v14, 3, v15
    v_lshl_add_u32 v17, v16, 2, v17
    v_mad_u32_u24 v33, v17, s60, v13
    v_cmp_gt_u32 vcc, s60, v13
    s_nop 1
    v_cndmask_b32 v26, v18, v26, vcc
    v_cndmask_b32 v33, v18, v33, vcc
    v_add_u32 v13, 64, v0
    v_mul_u32_u24 v12, 586, v13
    v_lshrrev_b32 v12, 13, v12
    v_mul_u32_u24 v14, 14, v12
    v_sub_u32 v13, v13, v14
    v_add_u32 v13, s54, v13
    v_add_u32 v14, -14, v13
    v_min_u32 v13, v13, v14
    v_lshl_add_u32 v13, v13, 4, s62
    v_bfe_u32 v14, v12, 2, 2
    v_and_b32 v15, 3, v12
    v_lshrrev_b32 v16, 4, v12
    v_mad_u32_u24 v27, v12, s60, v13
    v_lshl_add_u32 v17, v14, 3, v15
    v_lshl_add_u32 v17, v16, 2, v17
    v_mad_u32_u24 v34, v17, s60, v13
    v_cmp_gt_u32 vcc, s60, v13
    s_nop 1
    v_cndmask_b32 v27, v18, v27, vcc
    v_cndmask_b32 v34, v18, v34, vcc
    v_add_u32 v13, 128, v0
    v_mul_u32_u24 v12, 586, v13
    v_lshrrev_b32 v12, 13, v12
    v_mul_u32_u24 v14, 14, v12
    v_sub_u32 v13, v13, v14
    v_add_u32 v13, s54, v13
    v_add_u32 v14, -14, v13
    v_min_u32 v13, v13, v14
    v_lshl_add_u32 v13, v13, 4, s62
    v_bfe_u32 v14, v12, 2, 2
    v_and_b32 v15, 3, v12
    v_lshrrev_b32 v16, 4, v12
    v_mad_u32_u24 v28, v12, s60, v13
    v_lshl_add_u32 v17, v14, 3, v15
    v_lshl_add_u32 v17, v16, 2, v17
    v_mad_u32_u24 v35, v17, s60, v13
    v_cmp_gt_u32 vcc, s60, v13
    s_nop 1
    v_cndmask_b32 v28, v18, v28, vcc
    v_cndmask_b32 v35, v18, v35, vcc
    v_add_u32 v13, 192, v0
    v_mul_u32_u24 v12, 586, v13
    v_lshrrev_b32 v12, 13, v12
    v_mul_u32_u24 v14, 14, v12
    v_sub_u32 v13, v13, v14
    v_add_u32 v13, s54, v13
    v_add_u32 v14, -14, v13
    v_min_u32 v13, v13, v14
    v_lshl_add_u32 v13, v13, 4, s62
    v_bfe_u32 v14, v12, 2, 2
    v_and_b32 v15, 3, v12
    v_lshrrev_b32 v16, 4, v12
    v_mad_u32_u24 v29, v12, s60, v13
    v_lshl_add_u32 v17, v14, 3, v15
    v_lshl_add_u32 v17, v16, 2, v17
    v_mad_u32_u24 v36, v17, s60, v13
    v_cmp_gt_u32 vcc, s60, v13
    s_nop 1
    v_cndmask_b32 v29, v18, v29, vcc
    v_cndmask_b32 v36, v18, v36, vcc
    v_add_u32 v13, 256, v0
    v_mul_u32_u24 v12, 586, v13
    v_lshrrev_b32 v12, 13, v12
    v_mul_u32_u24 v14, 14, v12
    v_sub_u32 v13, v13, v14
    v_add_u32 v13, s54, v13
    v_add_u32 v14, -14, v13
    v_min_u32 v13, v13, v14
    v_lshl_add_u32 v13, v13, 4, s62
    v_bfe_u32 v14, v12, 2, 2
    v_and_b32 v15, 3, v12
    v_lshrrev_b32 v16, 4, v12
    v_mad_u32_u24 v30, v12, s60, v13
    v_lshl_add_u32 v17, v14, 3, v15
    v_lshl_add_u32 v17, v16, 2, v17
    v_mad_u32_u24 v37, v17, s60, v13
    v_cmp_gt_u32 vcc, s60, v13
    s_nop 1
    v_cndmask_b32 v30, v18, v30, vcc
    v_cndmask_b32 v37, v18, v37, vcc
    v_add_u32 v13, 320, v0
    v_mul_u32_u24 v12, 586, v13
    v_lshrrev_b32 v12, 13, v12
    v_mul_u32_u24 v14, 14, v12
    v_sub_u32 v13, v13, v14
    v_add_u32 v13, s54, v13
    v_add_u32 v14, -14, v13
    v_min_u32 v13, v13, v14
    v_lshl_add_u32 v13, v13, 4, s62
    v_bfe_u32 v14, v12, 2, 2
    v_and_b32 v15, 3, v12
    v_lshrrev_b32 v16, 4, v12
    v_mad_u32_u24 v31, v12, s60, v13
    v_lshl_add_u32 v17, v14, 3, v15
    v_lshl_add_u32 v17, v16, 2, v17
    v_mad_u32_u24 v38, v17, s60, v13
    v_cmp_gt_u32 vcc, s60, v13
    s_nop 1
    v_cndmask_b32 v31, v18, v31, vcc
    v_cndmask_b32 v38, v18, v38, vcc
    v_add_u32 v13, 384, v0
    v_mul_u32_u24 v12, 586, v13
    v_lshrrev_b32 v12, 13, v12
    v_mul_u32_u24 v14, 14, v12
    v_sub_u32 v13, v13, v14
    v_add_u32 v13, s54, v13
    v_add_u32 v14, -14, v13
    v_min_u32 v13, v13, v14
    v_lshl_add_u32 v13, v13, 4, s62
    v_bfe_u32 v14, v12, 2, 2
    v_and_b32 v15, 3, v12
    v_lshrrev_b32 v16, 4, v12
    v_mad_u32_u24 v32, v12, s60, v13
    v_lshl_add_u32 v17, v14, 3, v15
    v_lshl_add_u32 v17, v16, 2, v17
    v_mad_u32_u24 v39, v17, s60, v13
    v_cmp_gt_u32 vcc, s60, v13
    s_nop 1
    v_cndmask_b32 v32, v18, v32, vcc
    v_cndmask_b32 v39, v18, v39, vcc
    s_waitcnt vmcnt(0)
    v_mov_b32 v6, 20
    s_mov_b64 exec, 1
    ds_max_u32 v7, v6
    s_mov_b64 exec, -1
    s_mov_b32 s91, 0
SP_86:
    s_sleep 1
    ds_read_b32 v5, v4
    s_add_u32 s91, s91, 1
    s_waitcnt lgkmcnt(0)
    v_cmp_le_u32 vcc, 20, v5
    s_cmp_ge_u32 s91, 400000
    s_cbranch_scc1 OK_85
    s_cmp_lg_u64 vcc, -1
    s_cbranch_scc1 SP_86
OK_85:
    s_add_u32 m0, s61, 0
    s_mov_b32 s53, 0
    buffer_load_dwordx4 v20, s[36:39], s53 offen lds
    s_add_u32 m0, m0, 1024
    s_nop 0
    buffer_load_dwordx4 v21, s[36:39], s53 offen lds
    s_add_u32 m0, m0, 1024
    s_mov_b32 exec_hi, 0
    buffer_load_dwordx4 v22, s[36:39], s53 offen lds
    s_mov_b32 exec_hi, -1
    s_add_u32 m0, m0, 3072
    s_mov_b32 s53, 51200
    buffer_load_dwordx4 v20, s[36:39], s53 offen lds
    s_add_u32 m0, m0, 1024
    s_nop 0
    buffer_load_dwordx4 v21, s[36:39], s53 offen lds
    s_add_u32 m0, m0, 1024
    s_mov_b32 exec_hi, 0
    buffer_load_dwordx4 v22, s[36:39], s53 offen lds
    s_mov_b32 exec_hi, -1
    s_add_u32 m0, m0, 3072
    s_mov_b32 s53, 102400
    buffer_load_dwordx4 v20, s[36:39], s53 offen lds
    s_add_u32 m0, m0, 1024
    s_nop 0
    buffer_load_dwordx4 v21, s[36:39], s53 offen lds
    s_add_u32 m0, m0, 1024
    s_mov_b32 exec_hi, 0
    buffer_load_dwordx4 v22, s[36:39], s53 offen lds
    s_mov_b32 exec_hi, -1
    s_add_u32 m0, m0, 3072
    s_mov_b32 s53, 153600
    buffer_load_dwordx4 v20, s[36:39], s53 offen lds
    s_add_u32 m0, m0, 1024
    s_nop 0
    buffer_load_dwordx4 v21, s[36:39], s53 offen lds
    s_add_u32 m0, m0, 1024
    s_mov_b32 exec_hi, 0
    buffer_load_dwordx4 v22, s[36:39], s53 offen lds
    s_mov_b32 exec_hi, -1
    s_add_u32 m0, m0, 3072
    s_mov_b32 s53, 0
    buffer_load_dwordx4 v23, s[36:39], s53 offen lds
    s_add_u32 m0, m0, 1024
    s_nop 0
    buffer_load_dwordx4 v24, s[36:39], s53 offen lds
    s_add_u32 m0, m0, 1024
    s_mov_b32 exec_hi, 0
    buffer_load_dwordx4 v25, s[36:39], s53 offen lds
    s_mov_b32 exec_hi, -1
    s_add_u32 m0, m0, 3072
    s_mov_b32 s53, 204800
    buffer_load_dwordx4 v20, s[36:39], s53 offen lds
    s_add_u32 m0, m0, 1024
    s_nop 0
    buffer_load_dwordx4 v21, s[36:39], s53 offen lds
    s_add_u32 m0, m0, 1024
    s_mov_b32 exec_hi, 0
    buffer_load_dwordx4 v22, s[36:39], s53 offen lds
    s_mov_b32 exec_hi, -1
    s_add_u32 m0, m0, 3072
    s_mov_b32 s53, 256000
    buffer_load_dwordx4 v20, s[36:39], s53 offen lds
    s_add_u32 m0, m0, 1024
    s_nop 0
    buffer_load_dwordx4 v21, s[36:39], s53 offen lds
    s_add_u32 m0, m0, 1024
    s_mov_b32 exec_hi, 0
    buffer_load_dwordx4 v22, s[36:39], s53 offen lds
    s_mov_b32 exec_hi, -1
    s_add_u32 m0, m0, 3072
    s_mov_b32 s53, 307200
    buffer_load_dwordx4 v20, s[36:39], s53 offen lds
    s_add_u32 m0, m0, 1024
    s_nop 0
    buffer_load_dwordx4 v21, s[36:39], s53 offen lds
    s_add_u32 m0, m0, 1024
    s_mov_b32 exec_hi, 0
    buffer_load_dwordx4 v22, s[36:39], s53 offen lds
    s_mov_b32 exec_hi, -1
    s_add_u32 m0, m0, 3072
    s_mov_b32 s53, 358400
    buffer_load_dwordx4 v20, s[36:39], s53 offen lds
    s_add_u32 m0, m0, 1024
    s_nop 0
    buffer_load_dwordx4 v21, s[36:39], s53 offen lds
    s_add_u32 m0, m0, 1024
    s_mov_b32 exec_hi, 0
    buffer_load_dwordx4 v22, s[36:39], s53 offen lds
    s_mov_b32 exec_hi, -1
    s_add_u32 m0, m0, 3072
    s_mov_b32 s53, 204800
    buffer_load_dwordx4 v23, s[36:39], s53 offen lds
    s_add_u32 m0, m0, 1024
    s_nop 0
    buffer_load_dwordx4 v24, s[36:39], s53 offen lds
    s_add_u32 m0, m0, 1024
    s_mov_b32 exec_hi, 0
    buffer_load_dwordx4 v25, s[36:39], s53 offen lds
    s_mov_b32 exec_hi, -1
    s_add_u32 m0, m0, 3072
    s_mov_b32 s53, 409600
    buffer_load_dwordx4 v20, s[36:39], s53 offen lds
    s_add_u32 m0, m0, 1024
    s_nop 0
    buffer_load_dwordx4 v21, s[36:39], s53 offen lds
    s_add_u32 m0, m0, 1024
    s_mov_b32 exec_hi, 0
    buffer_load_dwordx4 v22, s[36:39], s53 offen lds
    s_mov_b32 exec_hi, -1
    s_add_u32 m0, m0, 3072
    s_mov_b32 s53, 460800
    buffer_load_dwordx4 v20, s[36:39], s53 offen lds
    s_add_u32 m0, m0, 1024
    s_nop 0
    buffer_load_dwordx4 v21, s[36:39], s53 offen lds
    s_add_u32 m0, m0, 1024
    s_mov_b32 exec_hi, 0
    buffer_load_dwordx4 v22, s[36:39], s53 offen lds
    s_mov_b32 exec_hi, -1
    s_add_u32 m0, m0, 3072
    s_mov_b32 s53, 512000
    buffer_load_dwordx4 v20, s[36:39], s53 offen lds
    s_add_u32 m0, m0, 1024
    s_nop 0
    buffer_load_dwordx4 v21, s[36:39], s53 offen lds
    s_add_u32 m0, m0, 1024
    s_mov_b32 exec_hi, 0
    buffer_load_dwordx4 v22, s[36:39], s53 offen lds
    s_mov_b32 exec_hi, -1
    s_add_u32 m0, m0, 3072
    s_cmp_eq_u32 s46, 0
    s_cselect_b32 s4, s24, s26
    s_cselect_b32 s5, s25, s27
    s_mov_b32 s6, 2211840
    s_bitcmp1_b32 s41, 0
    s_cselect_b32 s47, 0, 0
    s_mov_b32 s66, 2
    s_mov_b32 s67, 2
    s_sub_u32 s66, s66, 2
    s_sub_u32 s67, s67, 2
    s_mul_i32 s61, s46, 7168
    s_mul_i32 s49, s46, 5120
    s_waitcnt vmcnt(0)
    v_mov_b32 v6, 21
    s_mov_b64 exec, 1
    ds_max_u32 v7, v6
    s_mov_b64 exec, -1
    s_waitcnt vmcnt(0)
    v_mov_b32 v6, 21
    s_mov_b64 exec, 1
    ds_max_u32 v7, v6
    s_mov_b64 exec, -1
    s_mov_b32 s91, 0
SP_88:
    s_sleep 1
    ds_read_b32 v5, v4
    s_add_u32 s91, s91, 1
    s_waitcnt lgkmcnt(0)
    v_cmp_le_u32 vcc, 25, v5
    s_cmp_ge_u32 s91, 400000
    s_cbranch_scc1 OK_87
    s_cmp_lg_u64 vcc, -1
    s_cbranch_scc1 SP_88
OK_87:
    s_add_u32 m0, s61, 114688
    s_mov_b32 s70, 0
    s_mul_i32 s48, s47, 110592
    s_branch SUB_P3
R3_89:
    s_add_u32 s47, s47, s66
    ds_read_b32 v5, v4
    s_waitcnt lgkmcnt(0)
    v_cmp_le_u32 vcc, 26, v5
    s_nop 0
    s_cmp_lg_u64 vcc, -1
    s_cbranch_scc1 SP_91s
OK_90:
    s_add_u32 m0, s61, 0
    s_mov_b32 s70, 1
    s_mul_i32 s48, s47, 110592
    s_branch SUB_P3
R3_92:
    s_add_u32 s47, s47, s67
    ds_read_b32 v5, v4
    s_waitcnt vmcnt(14)
    v_mov_b32 v6, 22
    s_mov_b64 exec, 1
    ds_max_u32 v7, v6
    s_mov_b64 exec, -1
    s_waitcnt lgkmcnt(1)
    v_cmp_le_u32 vcc, 29, v5
    s_nop 0
    s_cmp_lg_u64 vcc, -1
    s_cbranch_scc1 SP_94s
OK_93:
    s_add_u32 m0, s61, 28672
    s_mov_b32 s70, 2
    s_mul_i32 s48, s47, 110592
    s_branch SUB_P3
R3_95:
    s_add_u32 s47, s47, s66
    ds_read_b32 v5, v4
    s_waitcnt vmcnt(14)
    v_mov_b32 v6, 23
    s_mov_b64 exec, 1
    ds_max_u32 v7, v6
    s_mov_b64 exec, -1
    s_waitcnt lgkmcnt(1)
    v_cmp_le_u32 vcc, 30, v5
    s_nop 0
    s_cmp_lg_u64 vcc, -1
    s_cbranch_scc1 SP_97s
OK_96:
    s_add_u32 m0, s61, 57344
    s_mov_b32 s70, 3
    s_mul_i32 s48, s47, 110592
    s_branch SUB_P3
R3_98:
    s_add_u32 s47, s47, s67
    ds_read_b32 v5, v4
    s_waitcnt vmcnt(14)
    v_mov_b32 v6, 24
    s_mov_b64 exec, 1
    ds_max_u32 v7, v6
    s_mov_b64 exec, -1
    s_waitcnt lgkmcnt(1)
    v_cmp_le_u32 vcc, 30, v5
    s_nop 0
    s_cmp_lg_u64 vcc, -1
    s_cbranch_scc1 SP_100s
OK_99:
    s_add_u32 m0, s61, 86016
    s_mov_b32 s70, 4
    s_mul_i32 s48, s47, 110592
    s_branch SUB_P3
R3_101:
    s_add_u32 s47, s47, s66
    ds_read_b32 v5, v4
    s_waitcnt vmcnt(14)
    v_mov_b32 v6, 25
    s_mov_b64 exec, 1
    ds_max_u32 v7, v6
    s_mov_b64 exec, -1
    s_waitcnt lgkmcnt(1)
    v_cmp_le_u32 vcc, 31, v5
    s_nop 0
    s_cmp_lg_u64 vcc, -1
    s_cbranch_scc1 SP_103s
OK_102:
    s_add_u32 m0, s61, 114688
    s_mov_b32 s70, 5
    s_mul_i32 s48, s47, 110592
    s_branch SUB_P3
R3_104:
    s_add_u32 s47, s47, s67
    ds_read_b32 v5, v4
    s_waitcnt vmcnt(14)
    v_mov_b32 v6, 26
    s_mov_b64 exec, 1
    ds_max_u32 v7, v6
    s_mov_b64 exec, -1
    s_waitcnt lgkmcnt(1)
    v_cmp_le_u32 vcc, 32, v5
    s_nop 0
    s_cmp_lg_u64 vcc, -1
    s_cbranch_scc1 SP_106s
OK_105:
    s_add_u32 m0, s61, 0
    s_mov_b32 s70, 6
    s_mul_i32 s48, s47, 110592
    s_branch SUB_P3
R3_107:
    s_add_u32 s47, s47, s66
    ds_read_b32 v5, v4
    s_waitcnt vmcnt(14)
    v_mov_b32 v6, 27
    s_mov_b64 exec, 1
    ds_max_u32 v7, v6
    s_mov_b64 exec, -1
    s_waitcnt lgkmcnt(1)
    v_cmp_le_u32 vcc, 33, v5
    s_nop 0
    s_cmp_lg_u64 vcc, -1
    s_cbranch_scc1 SP_109s
OK_108:
    s_add_u32 m0, s61, 28672
    s_mov_b32 s70, 7
    s_mul_i32 s48, s47, 110592
    s_branch SUB_P3
R3_110:
    s_add_u32 s47, s47, s67
    ds_read_b32 v5, v4
    s_waitcnt vmcnt(14)
    v_mov_b32 v6, 28
    s_mov_b64 exec, 1
    ds_max_u32 v7, v6
    s_mov_b64 exec, -1
    s_waitcnt lgkmcnt(1)
    v_cmp_le_u32 vcc, 34, v5
    s_nop 0
    s_cmp_lg_u64 vcc, -1
    s_cbranch_scc1 SP_112s
OK_111:
    s_add_u32 m0, s61, 57344
    s_mov_b32 s70, 8
    s_mul_i32 s48, s47, 110592
    s_branch SUB_P3
R3_113:
    s_add_u32 s47, s47, s66
    ds_read_b32 v5, v4
    s_waitcnt vmcnt(14)
    v_mov_b32 v6, 29
    s_mov_b64 exec, 1
    ds_max_u32 v7, v6
    s_mov_b64 exec, -1
    s_waitcnt lgkmcnt(1)
    v_cmp_le_u32 vcc, 35, v5
    s_nop 0
    s_cmp_lg_u64 vcc, -1
    s_cbranch_scc1 SP_115s
OK_114:
    s_add_u32 m0, s61, 86016
    s_mov_b32 s70, 9
    s_mul_i32 s48, s47, 110592
    s_branch SUB_P3
R3_116:
    s_add_u32 s47, s47, s67
    ds_read_b32 v5, v4
    s_waitcnt vmcnt(14)
    v_mov_b32 v6, 30
    s_mov_b64 exec, 1
    ds_max_u32 v7, v6
    s_mov_b64 exec, -1
    s_mul_i32 s53, s44, 276480
    s_add_u32 s53, s53, 0x1200000
    s_add_u32 s53, s53, s49
    s_mul_i32 s47, s44, 0
    s_lshr_b32 s47, s47, 3
    s_mul_i32 s47, s47, 10240
    s_waitcnt vmcnt(0)
    v_mov_b32 v6, 31
    s_mov_b64 exec, 1
    ds_max_u32 v7, v6
    s_mov_b64 exec, -1
    s_mov_b32 s91, 0
SP_118:
    ds_read_b32 v5, v254 offset:1036
    s_add_u32 s91, s91, 1
    s_waitcnt lgkmcnt(0)
    v_readfirstlane_b32 s92, v5
    s_cmp_ge_u32 s91, 400000
    s_cbranch_scc1 OK_117
    s_cmp_lt_u32 s92, 1
    s_cbranch_scc1 SP_118
OK_117:
    s_add_u32 s54, s47, 153600
    s_cmp_ge_u32 s54, 276480
    s_cselect_b32 s55, 276480, 0
    s_sub_u32 s54, s54, s55
    s_add_u32 s54, s54, s53
    s_add_u32 s55, s54, 4096
    buffer_load_dwordx4 v[28:31], v3, s[12:15], s54 offen offset:0 sc1
    buffer_load_dwordx4 v[32:35], v3, s[12:15], s54 offen offset:1024 sc1
    buffer_load_dwordx4 v[36:39], v3, s[12:15], s54 offen offset:2048 sc1
    buffer_load_dwordx4 v[40:43], v3, s[12:15], s54 offen offset:3072 sc1
    buffer_load_dwordx4 v[44:47], v3, s[12:15], s55 offen offset:0 sc1
    s_add_u32 s54, s47, 163840
    s_cmp_ge_u32 s54, 276480
    s_cselect_b32 s55, 276480, 0
    s_sub_u32 s54, s54, s55
    s_add_u32 s54, s54, s53
    s_add_u32 s55, s54, 4096
    buffer_load_dwordx4 v[48:51], v3, s[12:15], s54 offen offset:0 sc1
    buffer_load_dwordx4 v[52:55], v3, s[12:15], s54 offen offset:1024 sc1
    buffer_load_dwordx4 v[56:59], v3, s[12:15], s54 offen offset:2048 sc1
    buffer_load_dwordx4 v[60:63], v3, s[12:15], s54 offen offset:3072 sc1
    buffer_load_dwordx4 v[64:67], v3, s[12:15], s55 offen offset:0 sc1
    s_add_u32 s54, s47, 174080
    s_cmp_ge_u32 s54, 276480
    s_cselect_b32 s55, 276480, 0
    s_sub_u32 s54, s54, s55
    s_add_u32 s54, s54, s53
    s_add_u32 s55, s54, 4096
    buffer_load_dwordx4 v[68:71], v3, s[12:15], s54 offen offset:0 sc1
    buffer_load_dwordx4 v[72:75], v3, s[12:15], s54 offen offset:1024 sc1
    buffer_load_dwordx4 v[76:79], v3, s[12:15], s54 offen offset:2048 sc1
    buffer_load_dwordx4 v[80:83], v3, s[12:15], s54 offen offset:3072 sc1
    buffer_load_dwordx4 v[84:87], v3, s[12:15], s55 offen offset:0 sc1
    s_add_u32 s54, s47, 184320
    s_cmp_ge_u32 s54, 276480
    s_cselect_b32 s55, 276480, 0
    s_sub_u32 s54, s54, s55
    s_add_u32 s54, s54, s53
    s_add_u32 s55, s54, 4096
    buffer_load_dwordx4 v[88:91], v3, s[12:15], s54 offen offset:0 sc1
    buffer_load_dwordx4 v[92:95], v3, s[12:15], s54 offen offset:1024 sc1
    buffer_load_dwordx4 v[96:99], v3, s[12:15], s54 offen offset:2048 sc1
    buffer_load_dwordx4 v[100:103], v3, s[12:15], s54 offen offset:3072 sc1
    buffer_load_dwordx4 v[104:107], v3, s[12:15], s55 offen offset:0 sc1
    s_add_u32 s54, s47, 194560
    s_cmp_ge_u32 s54, 276480
    s_cselect_b32 s55, 276480, 0
    s_sub_u32 s54, s54, s55
    s_add_u32 s54, s54, s53
    s_add_u32 s55, s54, 4096
    buffer_load_dwordx4 v[108:111], v3, s[12:15], s54 offen offset:0 sc1
    buffer_load_dwordx4 v[112:115], v3, s[12:15], s54 offen offset:1024 sc1
    buffer_load_dwordx4 v[116:119], v3, s[12:15], s54 offen offset:2048 sc1
    buffer_load_dwordx4 v[120:123], v3, s[12:15], s54 offen offset:3072 sc1
    buffer_load_dwordx4 v[124:127], v3, s[12:15], s55 offen offset:0 sc1
    s_add_u32 s54, s47, 204800
    s_cmp_ge_u32 s54, 276480
    s_cselect_b32 s55, 276480, 0
    s_sub_u32 s54, s54, s55
    s_add_u32 s54, s54, s53
    s_add_u32 s55, s54, 4096
    buffer_load_dwordx4 v[128:131], v3, s[12:15], s54 offen offset:0 sc1
    buffer_load_dwordx4 v[132:135], v3, s[12:15], s54 offen offset:1024 sc1
    buffer_load_dwordx4 v[136:139], v3, s[12:15], s54 offen offset:2048 sc1
    buffer_load_dwordx4 v[140:143], v3, s[12:15], s54 offen offset:3072 sc1
    buffer_load_dwordx4 v[144:147], v3, s[12:15], s55 offen offset:0 sc1
    s_add_u32 s54, s47, 215040
    s_cmp_ge_u32 s54, 276480
    s_cselect_b32 s55, 276480, 0
    s_sub_u32 s54, s54, s55
    s_add_u32 s54, s54, s53
    s_add_u32 s55, s54, 4096
    buffer_load_dwordx4 v[148:151], v3, s[12:15], s54 offen offset:0 sc1
    buffer_load_dwordx4 v[152:155], v3, s[12:15], s54 offen offset:1024 sc1
    buffer_load_dwordx4 v[156:159], v3, s[12:15], s54 offen offset:2048 sc1
    buffer_load_dwordx4 v[160:163], v3, s[12:15], s54 offen offset:3072 sc1
    buffer_load_dwordx4 v[164:167], v3, s[12:15], s55 offen offset:0 sc1
    s_add_u32 s54, s47, 225280
    s_cmp_ge_u32 s54, 276480
    s_cselect_b32 s55, 276480, 0
    s_sub_u32 s54, s54, s55
    s_add_u32 s54, s54, s53
    s_add_u32 s55, s54, 4096
    buffer_load_dwordx4 v[168:171], v3, s[12:15], s54 offen offset:0 sc1
    buffer_load_dwordx4 v[172:175], v3, s[12:15], s54 offen offset:1024 sc1
    buffer_load_dwordx4 v[176:179], v3, s[12:15], s54 offen offset:2048 sc1
    buffer_load_dwordx4 v[180:183], v3, s[12:15], s54 offen offset:3072 sc1
    buffer_load_dwordx4 v[184:187], v3, s[12:15], s55 offen offset:0 sc1
    s_add_u32 s54, s47, 235520
    s_cmp_ge_u32 s54, 276480
    s_cselect_b32 s55, 276480, 0
    s_sub_u32 s54, s54, s55
    s_add_u32 s54, s54, s53
    s_add_u32 s55, s54, 4096
    buffer_load_dwordx4 v[188:191], v3, s[12:15], s54 offen offset:0 sc1
    buffer_load_dwordx4 v[192:195], v3, s[12:15], s54 offen offset:1024 sc1
    buffer_load_dwordx4 v[196:199], v3, s[12:15], s54 offen offset:2048 sc1
    buffer_load_dwordx4 v[200:203], v3, s[12:15], s54 offen offset:3072 sc1
    buffer_load_dwordx4 v[204:207], v3, s[12:15], s55 offen offset:0 sc1
    s_add_u32 s54, s47, 245760
    s_cmp_ge_u32 s54, 276480
    s_cselect_b32 s55, 276480, 0
    s_sub_u32 s54, s54, s55
    s_add_u32 s54, s54, s53
    s_add_u32 s55, s54, 4096
    buffer_load_dwordx4 v[208:211], v3, s[12:15], s54 offen offset:0 sc1
    buffer_load_dwordx4 v[212:215], v3, s[12:15], s54 offen offset:1024 sc1
    buffer_load_dwordx4 v[216:219], v3, s[12:15], s54 offen offset:2048 sc1
    buffer_load_dwordx4 v[220:223], v3, s[12:15], s54 offen offset:3072 sc1
    buffer_load_dwordx4 v[224:227], v3, s[12:15], s55 offen offset:0 sc1
    s_add_u32 s54, s47, 143360
    s_cmp_ge_u32 s54, 276480
    s_cselect_b32 s55, 276480, 0
    s_sub_u32 s54, s54, s55
    s_add_u32 s54, s54, s53
    s_add_u32 m0, s49, 147456
    s_nop 0
    buffer_load_dwordx4 v3, s[12:15], s54 offen sc1 lds
    buffer_load_dwordx4 v3, s[12:15], s54 offen offset:1024 sc1 lds
    buffer_load_dwordx4 v3, s[12:15], s54 offen offset:2048 sc1 lds
    buffer_load_dwordx4 v3, s[12:15], s54 offen offset:3072 sc1 lds
    s_add_u32 m0, m0, 4096
    s_add_u32 s54, s54, 4096
    buffer_load_dwordx4 v3, s[12:15], s54 offen sc1 lds
    ds_read_b32 v5, v4
    s_waitcnt lgkmcnt(0)
    v_cmp_le_u32 vcc, 36, v5
    s_nop 0
    s_cmp_lg_u64 vcc, -1
    s_cbranch_scc1 SP_120s
OK_119:
    s_add_u32 s54, s47, 0
    s_cmp_ge_u32 s54, 276480
    s_cselect_b32 s55, 276480, 0
    s_sub_u32 s54, s54, s55
    s_add_u32 s54, s54, s53
    s_add_u32 m0, s49, 122880
    s_nop 0
    buffer_load_dwordx4 v3, s[12:15], s54 offen sc1 lds
    buffer_load_dwordx4 v3, s[12:15], s54 offen offset:1024 sc1 lds
    buffer_load_dwordx4 v3, s[12:15], s54 offen offset:2048 sc1 lds
    buffer_load_dwordx4 v3, s[12:15], s54 offen offset:3072 sc1 lds
    s_add_u32 m0, m0, 4096
    s_add_u32 s54, s54, 4096
    buffer_load_dwordx4 v3, s[12:15], s54 offen sc1 lds
    ds_read_b32 v5, v4
    s_add_u32 s54, s47, 10240
    s_cmp_ge_u32 s54, 276480
    s_cselect_b32 s55, 276480, 0
    s_sub_u32 s54, s54, s55
    s_add_u32 s54, s54, s53
    s_add_u32 m0, s49, 133120
    s_nop 0
    buffer_load_dwordx4 v3, s[12:15], s54 offen sc1 lds
    buffer_load_dwordx4 v3, s[12:15], s54 offen offset:1024 sc1 lds
    buffer_load_dwordx4 v3, s[12:15], s54 offen offset:2048 sc1 lds
    buffer_load_dwordx4 v3, s[12:15], s54 offen offset:3072 sc1 lds
    s_add_u32 m0, m0, 4096
    s_add_u32 s54, s54, 4096
    buffer_load_dwordx4 v3, s[12:15], s54 offen sc1 lds
    ds_read_b32 v5, v4
    s_waitcnt lgkmcnt(0)
    v_cmp_le_u32 vcc, 37, v5
    s_nop 0
    s_cmp_lg_u64 vcc, -1
    s_cbranch_scc1 SP_122s
OK_121:
    s_add_u32 s54, s47, 20480
    s_cmp_ge_u32 s54, 276480
    s_cselect_b32 s55, 276480, 0
    s_sub_u32 s54, s54, s55
    s_add_u32 s54, s54, s53
    s_add_u32 m0, s49, 0
    s_nop 0
    buffer_load_dwordx4 v3, s[12:15], s54 offen sc1 lds
    buffer_load_dwordx4 v3, s[12:15], s54 offen offset:1024 sc1 lds
    buffer_load_dwordx4 v3, s[12:15], s54 offen offset:2048 sc1 lds
    buffer_load_dwordx4 v3, s[12:15], s54 offen offset:3072 sc1 lds
    s_add_u32 m0, m0, 4096
    s_add_u32 s54, s54, 4096
    buffer_load_dwordx4 v3, s[12:15], s54 offen sc1 lds
    ds_read_b32 v5, v4
    s_add_u32 s54, s47, 30720
    s_cmp_ge_u32 s54, 276480
    s_cselect_b32 s55, 276480, 0
    s_sub_u32 s54, s54, s55
    s_add_u32 s54, s54, s53
    s_add_u32 m0, s49, 10240
    s_nop 0
    buffer_load_dwordx4 v3, s[12:15], s54 offen sc1 lds
    buffer_load_dwordx4 v3, s[12:15], s54 offen offset:1024 sc1 lds
    buffer_load_dwordx4 v3, s[12:15], s54 offen offset:2048 sc1 lds
    buffer_load_dwordx4 v3, s[12:15], s54 offen offset:3072 sc1 lds
    s_add_u32 m0, m0, 4096
    s_add_u32 s54, s54, 4096
    buffer_load_dwordx4 v3, s[12:15], s54 offen sc1 lds
    ds_read_b32 v5, v4
    s_waitcnt vmcnt(15)
    v_mov_b32 v6, 32
    s_mov_b64 exec, 1
    ds_max_u32 v7, v6
    s_mov_b64 exec, -1
    s_waitcnt lgkmcnt(1)
    v_cmp_le_u32 vcc, 38, v5
    s_nop 0
    s_cmp_lg_u64 vcc, -1
    s_cbranch_scc1 SP_124s
OK_123:
    s_add_u32 s54, s47, 40960
    s_cmp_ge_u32 s54, 276480
    s_cselect_b32 s55, 276480, 0
    s_sub_u32 s54, s54, s55
    s_add_u32 s54, s54, s53
    s_add_u32 m0, s49, 20480
    s_nop 0
    buffer_load_dwordx4 v3, s[12:15], s54 offen sc1 lds
    buffer_load_dwordx4 v3, s[12:15], s54 offen offset:1024 sc1 lds
    buffer_load_dwordx4 v3, s[12:15], s54 offen offset:2048 sc1 lds
    buffer_load_dwordx4 v3, s[12:15], s54 offen offset:3072 sc1 lds
    s_add_u32 m0, m0, 4096
    s_add_u32 s54, s54, 4096
    buffer_load_dwordx4 v3, s[12:15], s54 offen sc1 lds
    ds_read_b32 v5, v4
    s_waitcnt vmcnt(15)
    v_mov_b32 v6, 33
    s_mov_b64 exec, 1
    ds_max_u32 v7, v6
    s_mov_b64 exec, -1
    s_add_u32 s54, s47, 51200
    s_cmp_ge_u32 s54, 276480
    s_cselect_b32 s55, 276480, 0
    s_sub_u32 s54, s54, s55
    s_add_u32 s54, s54, s53
    s_add_u32 m0, s49, 30720
    s_nop 0
    buffer_load_dwordx4 v3, s[12:15], s54 offen sc1 lds
    buffer_load_dwordx4 v3, s[12:15], s54 offen offset:1024 sc1 lds
    buffer_load_dwordx4 v3, s[12:15], s54 offen offset:2048 sc1 lds
    buffer_load_dwordx4 v3, s[12:15], s54 offen offset:3072 sc1 lds
    s_add_u32 m0, m0, 4096
    s_add_u32 s54, s54, 4096
    buffer_load_dwordx4 v3, s[12:15], s54 offen sc1 lds
    ds_read_b32 v5, v4
    s_waitcnt vmcnt(15)
    v_mov_b32 v6, 34
    s_mov_b64 exec, 1
    ds_max_u32 v7, v6
    s_mov_b64 exec, -1
    s_add_u32 s54, s47, 61440
    s_cmp_ge_u32 s54, 276480
    s_cselect_b32 s55, 276480, 0
    s_sub_u32 s54, s54, s55
    s_add_u32 s54, s54, s53
    s_add_u32 m0, s49, 40960
    s_nop 0
    buffer_load_dwordx4 v3, s[12:15], s54 offen sc1 lds
    buffer_load_dwordx4 v3, s[12:15], s54 offen offset:1024 sc1 lds
    buffer_load_dwordx4 v3, s[12:15], s54 offen offset:2048 sc1 lds
    buffer_load_dwordx4 v3, s[12:15], s54 offen offset:3072 sc1 lds
    s_add_u32 m0, m0, 4096
    s_add_u32 s54, s54, 4096
    buffer_load_dwordx4 v3, s[12:15], s54 offen sc1 lds
    ds_read_b32 v5, v4
    s_waitcnt vmcnt(15)
    v_mov_b32 v6, 35
    s_mov_b64 exec, 1
    ds_max_u32 v7, v6
    s_mov_b64 exec, -1
    s_waitcnt lgkmcnt(1)
    v_cmp_le_u32 vcc, 39, v5
    s_nop 0
    s_cmp_lg_u64 vcc, -1
    s_cbranch_scc1 SP_126s
OK_125:
    s_add_u32 s54, s47, 71680
    s_cmp_ge_u32 s54, 276480
    s_cselect_b32 s55, 276480, 0
    s_sub_u32 s54, s54, s55
    s_add_u32 s54, s54, s53
    s_add_u32 m0, s49, 51200
    s_nop 0
    buffer_load_dwordx4 v3, s[12:15], s54 offen sc1 lds
    buffer_load_dwordx4 v3, s[12:15], s54 offen offset:1024 sc1 lds
    buffer_load_dwordx4 v3, s[12:15], s54 offen offset:2048 sc1 lds
    buffer_load_dwordx4 v3, s[12:15], s54 offen offset:3072 sc1 lds
    s_add_u32 m0, m0, 4096
    s_add_u32 s54, s54, 4096
    buffer_load_dwordx4 v3, s[12:15], s54 offen sc1 lds
    ds_read_b32 v5, v4
    s_waitcnt vmcnt(15)
    v_mov_b32 v6, 36
    s_mov_b64 exec, 1
    ds_max_u32 v7, v6
    s_mov_b64 exec, -1
    s_add_u32 s54, s47, 81920
    s_cmp_ge_u32 s54, 276480
    s_cselect_b32 s55, 276480, 0
    s_sub_u32 s54, s54, s55
    s_add_u32 s54, s54, s53
    s_add_u32 m0, s49, 61440
    s_nop 0
    buffer_load_dwordx4 v3, s[12:15], s54 offen sc1 lds
    buffer_load_dwordx4 v3, s[12:15], s54 offen offset:1024 sc1 lds
    buffer_load_dwordx4 v3, s[12:15], s54 offen offset:2048 sc1 lds
    buffer_load_dwordx4 v3, s[12:15], s54 offen offset:3072 sc1 lds
    s_add_u32 m0, m0, 4096
    s_add_u32 s54, s54, 4096
    buffer_load_dwordx4 v3, s[12:15], s54 offen sc1 lds
    ds_read_b32 v5, v4
    s_waitcnt vmcnt(15)
    v_mov_b32 v6, 37
    s_mov_b64 exec, 1
    ds_max_u32 v7, v6
    s_mov_b64 exec, -1
    s_add_u32 s54, s47, 92160
    s_cmp_ge_u32 s54, 276480
    s_cselect_b32 s55, 276480, 0
    s_sub_u32 s54, s54, s55
    s_add_u32 s54, s54, s53
    s_add_u32 m0, s49, 71680
    s_nop 0
    buffer_load_dwordx4 v3, s[12:15], s54 offen sc1 lds
    buffer_load_dwordx4 v3, s[12:15], s54 offen offset:1024 sc1 lds
    buffer_load_dwordx4 v3, s[12:15], s54 offen offset:2048 sc1 lds
    buffer_load_dwordx4 v3, s[12:15], s54 offen offset:3072 sc1 lds
    s_add_u32 m0, m0, 4096
    s_add_u32 s54, s54, 4096
    buffer_load_dwordx4 v3, s[12:15], s54 offen sc1 lds
    ds_read_b32 v5, v4
    s_waitcnt vmcnt(15)
    v_mov_b32 v6, 38
    s_mov_b64 exec, 1
    ds_max_u32 v7, v6
    s_mov_b64 exec, -1
    s_waitcnt lgkmcnt(1)
    v_cmp_le_u32 vcc, 40, v5
    s_nop 0
    s_cmp_lg_u64 vcc, -1
    s_cbranch_scc1 SP_128s
OK_127:
    s_add_u32 s54, s47, 102400
    s_cmp_ge_u32 s54, 276480
    s_cselect_b32 s55, 276480, 0
    s_sub_u32 s54, s54, s55
    s_add_u32 s54, s54, s53
    s_add_u32 m0, s49, 81920
    s_nop 0
    buffer_load_dwordx4 v3, s[12:15], s54 offen sc1 lds
    buffer_load_dwordx4 v3, s[12:15], s54 offen offset:1024 sc1 lds
    buffer_load_dwordx4 v3, s[12:15], s54 offen offset:2048 sc1 lds
    buffer_load_dwordx4 v3, s[12:15], s54 offen offset:3072 sc1 lds
    s_add_u32 m0, m0, 4096
    s_add_u32 s54, s54, 4096
    buffer_load_dwordx4 v3, s[12:15], s54 offen sc1 lds
    ds_read_b32 v5, v4
    s_waitcnt vmcnt(15)
    v_mov_b32 v6, 39
    s_mov_b64 exec, 1
    ds_max_u32 v7, v6
    s_mov_b64 exec, -1
    s_add_u32 s54, s47, 112640
    s_cmp_ge_u32 s54, 276480
    s_cselect_b32 s55, 276480, 0
    s_sub_u32 s54, s54, s55
    s_add_u32 s54, s54, s53
    s_add_u32 m0, s49, 92160
    s_nop 0
    buffer_load_dwordx4 v3, s[12:15], s54 offen sc1 lds
    buffer_load_dwordx4 v3, s[12:15], s54 offen offset:1024 sc1 lds
    buffer_load_dwordx4 v3, s[12:15], s54 offen offset:2048 sc1 lds
    buffer_load_dwordx4 v3, s[12:15], s54 offen offset:3072 sc1 lds
    s_add_u32 m0, m0, 4096
    s_add_u32 s54, s54, 4096
    buffer_load_dwordx4 v3, s[12:15], s54 offen sc1 lds
    ds_read_b32 v5, v4
    s_waitcnt vmcnt(15)
    v_mov_b32 v6, 40
    s_mov_b64 exec, 1
    ds_max_u32 v7, v6
    s_mov_b64 exec, -1
    s_add_u32 s54, s47, 122880
    s_cmp_ge_u32 s54, 276480
    s_cselect_b32 s55, 276480, 0
    s_sub_u32 s54, s54, s55
    s_add_u32 s54, s54, s53
    s_add_u32 m0, s49, 102400
    s_nop 0
    buffer_load_dwordx4 v3, s[12:15], s54 offen sc1 lds
    buffer_load_dwordx4 v3, s[12:15], s54 offen offset:1024 sc1 lds
    buffer_load_dwordx4 v3, s[12:15], s54 offen offset:2048 sc1 lds
    buffer_load_dwordx4 v3, s[12:15], s54 offen offset:3072 sc1 lds
    s_add_u32 m0, m0, 4096
    s_add_u32 s54, s54, 4096
    buffer_load_dwordx4 v3, s[12:15], s54 offen sc1 lds
    ds_read_b32 v5, v4
    s_waitcnt vmcnt(15)
    v_mov_b32 v6, 41
    s_mov_b64 exec, 1
    ds_max_u32 v7, v6
    s_mov_b64 exec, -1
    s_add_u32 s54, s47, 133120
    s_cmp_ge_u32 s54, 276480
    s_cselect_b32 s55, 276480, 0
    s_sub_u32 s54, s54, s55
    s_add_u32 s54, s54, s53
    s_add_u32 m0, s49, 112640
    s_nop 0
    buffer_load_dwordx4 v3, s[12:15], s54 offen sc1 lds
    buffer_load_dwordx4 v3, s[12:15], s54 offen offset:1024 sc1 lds
    buffer_load_dwordx4 v3, s[12:15], s54 offen offset:2048 sc1 lds
    buffer_load_dwordx4 v3, s[12:15], s54 offen offset:3072 sc1 lds
    s_add_u32 m0, m0, 4096
    s_add_u32 s54, s54, 4096
    buffer_load_dwordx4 v3, s[12:15], s54 offen sc1 lds
    ds_read_b32 v5, v4
    s_waitcnt vmcnt(15)
    v_mov_b32 v6, 42
    s_mov_b64 exec, 1
    ds_max_u32 v7, v6
    s_mov_b64 exec, -1
    s_waitcnt vmcnt(0)
    v_mov_b32 v6, 46
    s_mov_b64 exec, 1
    ds_max_u32 v7, v6
    s_mov_b64 exec, -1
    v_add_u32 v2, s49, v3
    s_mov_b32 s91, 0
SP_130:
    ds_read_b32 v5, v4
    s_add_u32 s91, s91, 1
    s_waitcnt lgkmcnt(0)
    v_cmp_le_u32 vcc, 44, v5
    s_cmp_ge_u32 s91, 400000
    s_cbranch_scc1 OK_129
    s_cmp_lg_u64 vcc, -1
    s_cbranch_scc1 SP_130
OK_129:
    s_add_u32 s54, s47, 256000
    s_cmp_ge_u32 s54, 276480
    s_cselect_b32 s55, 276480, 0
    s_sub_u32 s54, s54, s55
    s_add_u32 s54, s54, s53
    s_add_u32 m0, s49, 122880
    s_nop 0
    buffer_load_dwordx4 v3, s[12:15], s54 offen sc1 lds
    buffer_load_dwordx4 v3, s[12:15], s54 offen offset:1024 sc1 lds
    buffer_load_dwordx4 v3, s[12:15], s54 offen offset:2048 sc1 lds
    buffer_load_dwordx4 v3, s[12:15], s54 offen offset:3072 sc1 lds
    s_add_u32 m0, m0, 4096
    s_add_u32 s54, s54, 4096
    buffer_load_dwordx4 v3, s[12:15], s54 offen sc1 lds
    s_add_u32 s54, s47, 266240
    s_cmp_ge_u32 s54, 276480
    s_cselect_b32 s55, 276480, 0
    s_sub_u32 s54, s54, s55
    s_add_u32 s54, s54, s53
    s_add_u32 m0, s49, 133120
    s_nop 0
    buffer_load_dwordx4 v3, s[12:15], s54 offen sc1 lds
    buffer_load_dwordx4 v3, s[12:15], s54 offen offset:1024 sc1 lds
    buffer_load_dwordx4 v3, s[12:15], s54 offen offset:2048 sc1 lds
    buffer_load_dwordx4 v3, s[12:15], s54 offen offset:3072 sc1 lds
    s_add_u32 m0, m0, 4096
    s_add_u32 s54, s54, 4096
    buffer_load_dwordx4 v3, s[12:15], s54 offen sc1 lds
    ds_read_b32 v5, v4
    s_waitcnt lgkmcnt(0)
    v_cmp_le_u32 vcc, 44, v5
    s_nop 0
    s_cmp_lg_u64 vcc, -1
    s_cbranch_scc1 SP_132s
OK_131:
    v_add_u32 v1, 0, v2
    ds_write_b128 v1, v[28:31] offset:0
    ds_write_b128 v1, v[32:35] offset:1024
    ds_write_b128 v1, v[36:39] offset:2048
    ds_write_b128 v1, v[40:43] offset:3072
    ds_write_b128 v1, v[44:47] offset:4096
    v_mov_b32 v6, 47
    s_mov_b64 exec, 1
    ds_max_u32 v7, v6
    s_mov_b64 exec, -1
    ds_read_b32 v5, v4
    s_waitcnt lgkmcnt(0)
    v_cmp_le_u32 vcc, 47, v5
    s_nop 0
    s_cmp_lg_u64 vcc, -1
    s_cbranch_scc1 SP_134s
OK_133:
    v_add_u32 v1, 10240, v2
    ds_write_b128 v1, v[48:51] offset:0
    ds_write_b128 v1, v[52:55] offset:1024
    ds_write_b128 v1, v[56:59] offset:2048
    ds_write_b128 v1, v[60:63] offset:3072
    ds_write_b128 v1, v[64:67] offset:4096
    v_mov_b32 v6, 48
    s_mov_b64 exec, 1
    ds_max_u32 v7, v6
    s_mov_b64 exec, -1
    v_add_u32 v1, 20480, v2
    ds_write_b128 v1, v[68:71] offset:0
    ds_write_b128 v1, v[72:75] offset:1024
    ds_write_b128 v1, v[76:79] offset:2048
    ds_write_b128 v1, v[80:83] offset:3072
    ds_write_b128 v1, v[84:87] offset:4096
    v_mov_b32 v6, 49
    s_mov_b64 exec, 1
    ds_max_u32 v7, v6
    s_mov_b64 exec, -1
    v_add_u32 v1, 30720, v2
    ds_write_b128 v1, v[88:91] offset:0
    ds_write_b128 v1, v[92:95] offset:1024
    ds_write_b128 v1, v[96:99] offset:2048
    ds_write_b128 v1, v[100:103] offset:3072
    ds_write_b128 v1, v[104:107] offset:4096
    v_mov_b32 v6, 50
    s_mov_b64 exec, 1
    ds_max_u32 v7, v6
    s_mov_b64 exec, -1
    ds_read_b32 v5, v4
    s_waitcnt lgkmcnt(0)
    v_cmp_le_u32 vcc, 50, v5
    s_nop 0
    s_cmp_lg_u64 vcc, -1
    s_cbranch_scc1 SP_136s
OK_135:
    v_add_u32 v1, 40960, v2
    ds_write_b128 v1, v[108:111] offset:0
    ds_write_b128 v1, v[112:115] offset:1024
    ds_write_b128 v1, v[116:119] offset:2048
    ds_write_b128 v1, v[120:123] offset:3072
    ds_write_b128 v1, v[124:127] offset:4096
    v_mov_b32 v6, 51
    s_mov_b64 exec, 1
    ds_max_u32 v7, v6
    s_mov_b64 exec, -1
    v_add_u32 v1, 51200, v2
    ds_write_b128 v1, v[128:131] offset:0
    ds_write_b128 v1, v[132:135] offset:1024
    ds_write_b128 v1, v[136:139] offset:2048
    ds_write_b128 v1, v[140:143] offset:3072
    ds_write_b128 v1, v[144:147] offset:4096
    v_mov_b32 v6, 52
    s_mov_b64 exec, 1
    ds_max_u32 v7, v6
    s_mov_b64 exec, -1
    v_add_u32 v1, 61440, v2
    ds_write_b128 v1, v[148:151] offset:0
    ds_write_b128 v1, v[152:155] offset:1024
    ds_write_b128 v1, v[156:159] offset:2048
    ds_write_b128 v1, v[160:163] offset:3072
    ds_write_b128 v1, v[164:167] offset:4096
    v_mov_b32 v6, 53
    s_mov_b64 exec, 1
    ds_max_u32 v7, v6
    s_mov_b64 exec, -1
    ds_read_b32 v5, v4
    s_waitcnt lgkmcnt(0)
    v_cmp_le_u32 vcc, 53, v5
    s_nop 0
    s_cmp_lg_u64 vcc, -1
    s_cbranch_scc1 SP_138s
OK_137:
    v_add_u32 v1, 71680, v2
    ds_write_b128 v1, v[168:171] offset:0
    ds_write_b128 v1, v[172:175] offset:1024
    ds_write_b128 v1, v[176:179] offset:2048
    ds_write_b128 v1, v[180:183] offset:3072
    ds_write_b128 v1, v[184:187] offset:4096
    v_mov_b32 v6, 54
    s_mov_b64 exec, 1
    ds_max_u32 v7, v6
    s_mov_b64 exec, -1
    v_add_u32 v1, 81920, v2
    ds_write_b128 v1, v[188:191] offset:0
    ds_write_b128 v1, v[192:195] offset:1024
    ds_write_b128 v1, v[196:199] offset:2048
    ds_write_b128 v1, v[200:203] offset:3072
    ds_write_b128 v1, v[204:207] offset:4096
    v_mov_b32 v6, 55
    s_mov_b64 exec, 1
    ds_max_u32 v7, v6
    s_mov_b64 exec, -1
    v_add_u32 v1, 92160, v2
    ds_write_b128 v1, v[208:211] offset:0
    ds_write_b128 v1, v[212:215] offset:1024
    ds_write_b128 v1, v[216:219] offset:2048
    ds_write_b128 v1, v[220:223] offset:3072
    ds_write_b128 v1, v[224:227] offset:4096
    v_mov_b32 v6, 56
    s_mov_b64 exec, 1
    ds_max_u32 v7, v6
    s_mov_b64 exec, -1
    ds_read_b32 v5, v4
    s_waitcnt vmcnt(0)
    v_mov_b32 v6, 58
    s_mov_b64 exec, 1
    ds_max_u32 v7, v6
    s_mov_b64 exec, -1
    s_waitcnt lgkmcnt(0)
    s_endpgm
SUB_P3:
    s_lshl_b32 s55, 1, s47
    s_and_b32 s55, s55, 135300
    s_cbranch_scc1 SP3_139
    buffer_load_dwordx4 v26, s[4:7], s48 offen lds
    s_add_u32 m0, m0, 1024
    s_nop 0
    buffer_load_dwordx4 v27, s[4:7], s48 offen lds
    s_add_u32 m0, m0, 1024
    s_nop 0
    buffer_load_dwordx4 v28, s[4:7], s48 offen lds
    s_add_u32 m0, m0, 1024
    s_nop 0
    buffer_load_dwordx4 v29, s[4:7], s48 offen lds
    s_add_u32 m0, m0, 1024
    s_nop 0
    buffer_load_dwordx4 v30, s[4:7], s48 offen lds
    s_add_u32 m0, m0, 1024
    s_nop 0
    buffer_load_dwordx4 v31, s[4:7], s48 offen lds
    s_add_u32 m0, m0, 1024
    s_nop 0
    buffer_load_dwordx4 v32, s[4:7], s48 offen lds
    s_add_u32 m0, m0, 8192
    s_branch NX3_140
SP3_139:
    buffer_load_dwordx4 v33, s[4:7], s48 offen lds
    s_add_u32 m0, m0, 1024
    s_nop 0
    buffer_load_dwordx4 v34, s[4:7], s48 offen lds
    s_add_u32 m0, m0, 1024
    s_nop 0
    buffer_load_dwordx4 v35, s[4:7], s48 offen lds
    s_add_u32 m0, m0, 1024
    s_nop 0
    buffer_load_dwordx4 v36, s[4:7], s48 offen lds
    s_add_u32 m0, m0, 1024
    s_nop 0
    buffer_load_dwordx4 v37, s[4:7], s48 offen lds
    s_add_u32 m0, m0, 1024
    s_nop 0
    buffer_load_dwordx4 v38, s[4:7], s48 offen lds
    s_add_u32 m0, m0, 1024
    s_nop 0
    buffer_load_dwordx4 v39, s[4:7], s48 offen lds
    s_add_u32 m0, m0, 8192
NX3_140:
    s_add_u32 s48, s48, 110592
    s_add_u32 s47, s47, 1
    s_bitcmp1_b32 s47, 0
    s_cbranch_scc1 SUB_P3
    s_cmp_eq_u32 s70, 0
    s_cbranch_scc1 R3_89
    s_cmp_eq_u32 s70, 1
    s_cbranch_scc1 R3_92
    s_cmp_eq_u32 s70, 2
    s_cbranch_scc1 R3_95
    s_cmp_eq_u32 s70, 3
    s_cbranch_scc1 R3_98
    s_cmp_eq_u32 s70, 4
    s_cbranch_scc1 R3_101
    s_cmp_eq_u32 s70, 5
    s_cbranch_scc1 R3_104
    s_cmp_eq_u32 s70, 6
    s_cbranch_scc1 R3_107
    s_cmp_eq_u32 s70, 7
    s_cbranch_scc1 R3_110
    s_cmp_eq_u32 s70, 8
    s_cbranch_scc1 R3_113
    s_branch R3_116
SWAVE:
    v_lshrrev_b32 v4, 5, v0
    v_lshlrev_b32 v4, 4, v4
    v_bfe_u32 v9, v0, 3, 2
    v_add_u32 v4, v4, v9
    v_and_b32 v2, 7, v0
    v_lshlrev_b32 v2, 4, v2
    s_mov_b32 s38, 2211840
    s_mov_b32 s39, 0x20000
    s_waitcnt lgkmcnt(0)
    s_mov_b32 s12, s34
    s_mov_b32 s13, s35
    s_mov_b32 s14, 0x1600000
    s_mov_b32 s15, 0x20000
    v_mov_b32 v65, 145664
    s_barrier
    ds_read_b32 v65, v65
    s_waitcnt lgkmcnt(0)
    v_readfirstlane_b32 s2, v65
    s_nop 0
    s_and_b32 s41, s2, 7
    s_lshl_b32 s41, s41, 1
    s_lshr_b32 s42, s2, 7
    s_add_u32 s41, s41, s42
    s_lshr_b32 s42, s2, 3
    s_and_b32 s42, s42, 15
    s_lshr_b32 s43, s42, 3
    s_lshl_b32 s44, s41, 1
    s_add_u32 s43, s43, s44
    s_and_b32 s44, s42, 7
    s_mul_i32 s3, s43, 2
    s_mul_i32 s91, s44, 1
    s_add_u32 s3, s3, s91
    s_mul_i32 s91, s3, 147
    s_lshr_b32 s91, s91, 10
    s_mul_i32 s91, s91, 7
    s_sub_u32 s3, s3, s91
    v_and_b32 v65, 3, v0
    v_lshlrev_b32 v65, 8, v65
    v_add_u32 v65, 144384, v65
    v_lshlrev_b32 v1, 4, v0
    v_lshrrev_b32 v3, 4, v0
    v_lshlrev_b32 v7, 10, v3
    v_bfe_u32 v9, v0, 2, 2
    v_lshl_add_u32 v7, v9, 7, v7
    v_and_b32 v9, 3, v0
    v_lshl_add_u32 v7, v9, 3, v7
    v_lshlrev_b32 v3, 4, v3
    v_add_u32 v3, 0x1540000, v3
    v_mov_b32 v60, 0x3f803f80
    v_mov_b32 v61, 0x3f803f80
    v_mov_b32 v62, 0x3f803f80
    v_mov_b32 v63, 0x3f803f80
    s_mov_b32 s91, 0
SP_142:
    s_sleep 4
    ds_read_b32 v66, v65
    s_add_u32 s91, s91, 1
    s_waitcnt lgkmcnt(0)
    v_cmp_le_u32 vcc, 10, v66
    s_cmp_ge_u32 s91, 400000
    s_cbranch_scc1 OK_141
    s_cmp_lg_u64 vcc, -1
    s_cbranch_scc1 SP_142
OK_141:
    s_mov_b32 s4, s20
    s_mov_b32 s5, s21
    s_mov_b32 s6, 0xc8000
    s_mov_b32 s7, 0x20000
    s_mul_i32 s49, s2, 3200
    v_min_u32 v9, 24, v0
    v_lshlrev_b32 v9, 7, v9
    buffer_load_dword v64, v9, s[4:7], s49 offen
    s_mov_b32 s91, 0
SP_144:
    s_sleep 4
    ds_read_b32 v66, v65
    s_add_u32 s91, s91, 1
    s_waitcnt lgkmcnt(0)
    v_cmp_le_u32 vcc, 15, v66
    s_cmp_ge_u32 s91, 400000
    s_cbranch_scc1 OK_143
    s_cmp_lg_u64 vcc, -1
    s_cbranch_scc1 SP_144
OK_143:
    s_mov_b32 s46, 0
    s_mov_b32 s47, 0
    s_branch SUB_I
RET_145:
    s_mov_b32 s46, 1
    s_mov_b32 s47, 1
    s_branch SUB_I
RET_146:
    s_mov_b32 s46, 2
    s_mov_b32 s47, 0
    s_branch SUB_T
RET_147:
    s_mov_b32 s46, 3
    s_mov_b32 s47, 1
    s_branch SUB_T
RET_148:
    s_waitcnt vmcnt(0)
    s_mov_b32 s46, 0
    s_mov_b32 s47, 0
    s_branch SUB_P
RET_149:
    s_mov_b32 s46, 2
    s_mov_b32 s47, 2
    s_branch SUB_I
RET_150:
    s_waitcnt vmcnt(0)
    s_mov_b32 s46, 1
    s_mov_b32 s47, 1
    s_branch SUB_P
RET_151:
    s_mov_b32 s46, 3
    s_mov_b32 s47, 3
    s_branch SUB_I
RET_152:
    s_waitcnt vmcnt(0)
    s_mov_b32 s46, 2
    s_mov_b32 s47, 2
    s_branch SUB_P
RET_153:
    s_waitcnt vmcnt(0)
    s_mov_b32 s46, 3
    s_mov_b32 s47, 3
    s_branch SUB_P
RET_154:
    s_lshl_b32 s49, s2, 2
    s_add_u32 s49, s49, 0x1581000
    v_mov_b32 v9, 1
    v_mov_b32 v10, 0
    s_mov_b64 exec, 1
    s_waitcnt vmcnt(0)
    buffer_store_dword v9, v10, s[12:15], s49 offen sc1
    s_mov_b64 exec, -1
    s_endpgm
SUB_T:
    s_lshl_b32 s55, s46, 8
    s_add_u32 s55, s55, s2
    s_cmp_ge_u32 s55, 810
    s_cbranch_scc1 SUB_T_END
    s_cmp_lt_u32 s55, 270
    s_cbranch_scc1 RB_155
    s_cmp_ge_u32 s55, 540
    s_movk_i32 s49, 270
    s_cselect_b32 s49, 540, s49
    s_sub_u32 s49, s55, s49
    s_mul_i32 s57, s49, 152
    s_lshr_b32 s57, s57, 12
    s_mul_i32 s50, s57, 27
    s_sub_u32 s56, s49, s50
    s_movk_i32 s58, 3456
    s_branch RD_156
RB_155:
    s_mul_i32 s57, s55, 205
    s_lshr_b32 s57, s57, 11
    s_mul_i32 s50, s57, 10
    s_sub_u32 s56, s55, s50
    s_movk_i32 s58, 1280
RD_156:
    s_and_b32 s48, s46, 1
    s_lshl_b32 s48, s48, 13
    s_add_u32 s48, s48, 147456
    s_cmp_ge_u32 s55, 540
    s_cselect_b32 s36, s26, s24
    s_cselect_b32 s37, s27, s25
    s_cmp_lt_u32 s55, 270
    s_cselect_b32 s36, s28, s36
    s_cselect_b32 s37, s29, s37
    s_mul_i32 s49, s57, s58
    s_lshl_b32 s49, s49, 6
    s_lshl_b32 s50, s56, 7
    s_add_u32 s49, s49, s50
    v_mul_u32_u24 v5, s58, v0
    buffer_load_dword v64, v5, s[36:39], s49 offen
SUB_T_END:
    s_cmp_eq_u32 s47, 0
    s_cbranch_scc1 RET_147
    s_branch RET_148
SUB_I:
    s_lshl_b32 s55, s46, 8
    s_add_u32 s55, s55, s2
    s_cmp_ge_u32 s55, 810
    s_cbranch_scc1 SUB_I_END
    s_cmp_lt_u32 s55, 270
    s_cbranch_scc1 RB_157
    s_cmp_ge_u32 s55, 540
    s_movk_i32 s49, 270
    s_cselect_b32 s49, 540, s49
    s_sub_u32 s49, s55, s49
    s_mul_i32 s57, s49, 152
    s_lshr_b32 s57, s57, 12
    s_mul_i32 s50, s57, 27
    s_sub_u32 s56, s49, s50
    s_movk_i32 s58, 3456
    s_branch RD_158
RB_157:
    s_mul_i32 s57, s55, 205
    s_lshr_b32 s57, s57, 11
    s_mul_i32 s50, s57, 10
    s_sub_u32 s56, s55, s50
    s_movk_i32 s58, 1280
RD_158:
    s_and_b32 s48, s46, 1
    s_lshl_b32 s48, s48, 13
    s_add_u32 s48, s48, 147456
    s_cmp_ge_u32 s55, 540
    s_cselect_b32 s36, s26, s24
    s_cselect_b32 s37, s27, s25
    s_cmp_lt_u32 s55, 270
    s_cselect_b32 s36, s28, s36
    s_cselect_b32 s37, s29, s37
    v_mad_u32_u24 v5, v4, s58, v2
    s_mov_b32 m0, s48
    s_mul_i32 s49, s57, s58
    s_lshl_b32 s49, s49, 6
    s_lshl_b32 s50, s56, 7
    s_add_u32 s49, s49, s50
    s_lshl_b32 s50, s58, 2
    s_mul_i32 s51, s58, 20
    v_lshrrev_b32 v8, 3, v0
    v_mad_u32_u24 v8, v8, s58, v2
    s_lshl_b32 s53, s57, 1
    s_lshl_b32 s51, s58, 5
    s_lshl_b32 s52, s58, 3
    s_mul_i32 s54, s53, 37
    s_lshr_b32 s54, s54, 8
    s_mul_i32 s54, s54, 7
    s_sub_u32 s54, s53, s54
    s_cmp_lt_u32 s55, 270
    s_cselect_b32 s54, s54, 0
    s_cmp_eq_u32 s54, 3
    s_mov_b32 s54, s49
    s_cbranch_scc1 US_159
    buffer_load_dwordx4 v5, s[36:39], s54 offen lds
    s_add_u32 m0, m0, 1024
    s_add_u32 s54, s54, s50
    buffer_load_dwordx4 v5, s[36:39], s54 offen lds
    s_add_u32 m0, m0, 1024
    s_add_u32 s54, s54, s50
    buffer_load_dwordx4 v5, s[36:39], s54 offen lds
    s_add_u32 m0, m0, 1024
    s_add_u32 s54, s54, s50
    buffer_load_dwordx4 v5, s[36:39], s54 offen lds
    s_add_u32 m0, m0, 1024
    s_add_u32 s54, s54, s50
    s_branch UN_160
US_159:
    buffer_load_dwordx4 v8, s[36:39], s54 offen lds
    s_add_u32 m0, m0, 1024
    s_add_u32 s54, s54, s52
    buffer_load_dwordx4 v8, s[36:39], s54 offen lds
    s_add_u32 m0, m0, 1024
    s_add_u32 s54, s54, s52
    buffer_load_dwordx4 v8, s[36:39], s54 offen lds
    s_add_u32 m0, m0, 1024
    s_add_u32 s54, s54, s52
    buffer_load_dwordx4 v8, s[36:39], s54 offen lds
    s_add_u32 m0, m0, 1024
    s_add_u32 s54, s54, s52
UN_160:
    s_add_u32 s49, s49, s51
    s_add_u32 s53, s53, 1
    s_mul_i32 s54, s53, 37
    s_lshr_b32 s54, s54, 8
    s_mul_i32 s54, s54, 7
    s_sub_u32 s54, s53, s54
    s_cmp_lt_u32 s55, 270
    s_cselect_b32 s54, s54, 0
    s_cmp_eq_u32 s54, 3
    s_mov_b32 s54, s49
    s_cbranch_scc1 US_161
    buffer_load_dwordx4 v5, s[36:39], s54 offen lds
    s_add_u32 m0, m0, 1024
    s_add_u32 s54, s54, s50
    buffer_load_dwordx4 v5, s[36:39], s54 offen lds
    s_add_u32 m0, m0, 1024
    s_add_u32 s54, s54, s50
    buffer_load_dwordx4 v5, s[36:39], s54 offen lds
    s_add_u32 m0, m0, 1024
    s_add_u32 s54, s54, s50
    buffer_load_dwordx4 v5, s[36:39], s54 offen lds
    s_add_u32 m0, m0, 1024
    s_add_u32 s54, s54, s50
    s_branch UN_162
US_161:
    buffer_load_dwordx4 v8, s[36:39], s54 offen lds
    s_add_u32 m0, m0, 1024
    s_add_u32 s54, s54, s52
    buffer_load_dwordx4 v8, s[36:39], s54 offen lds
    s_add_u32 m0, m0, 1024
    s_add_u32 s54, s54, s52
    buffer_load_dwordx4 v8, s[36:39], s54 offen lds
    s_add_u32 m0, m0, 1024
    s_add_u32 s54, s54, s52
    buffer_load_dwordx4 v8, s[36:39], s54 offen lds
    s_add_u32 m0, m0, 1024
    s_add_u32 s54, s54, s52
UN_162:
SUB_I_END:
    s_cmp_eq_u32 s47, 0
    s_cbranch_scc1 RET_145
    s_cmp_eq_u32 s47, 1
    s_cbranch_scc1 RET_146
    s_cmp_eq_u32 s47, 2
    s_cbranch_scc1 RET_150
    s_branch RET_152
SUB_P:
    s_lshl_b32 s55, s46, 8
    s_add_u32 s55, s55, s2
    s_cmp_ge_u32 s55, 810
    s_cbranch_scc1 SUB_P_END
    s_cmp_lt_u32 s55, 270
    s_cbranch_scc1 RB_163
    s_cmp_ge_u32 s55, 540
    s_movk_i32 s49, 270
    s_cselect_b32 s49, 540, s49
    s_sub_u32 s49, s55, s49
    s_mul_i32 s57, s49, 152
    s_lshr_b32 s57, s57, 12
    s_mul_i32 s50, s57, 27
    s_sub_u32 s56, s49, s50
    s_movk_i32 s58, 3456
    s_branch RD_164
RB_163:
    s_mul_i32 s57, s55, 205
    s_lshr_b32 s57, s57, 11
    s_mul_i32 s50, s57, 10
    s_sub_u32 s56, s55, s50
    s_movk_i32 s58, 1280
RD_164:
    s_and_b32 s48, s46, 1
    s_lshl_b32 s48, s48, 13
    s_add_u32 s48, s48, 147456
    v_add_u32 v6, s48, v7
    ds_read_b64_tr_b16 v[12:13], v6 offset:0
    ds_read_b64_tr_b16 v[14:15], v6 offset:512
    ds_read_b64_tr_b16 v[28:29], v6 offset:4096
    ds_read_b64_tr_b16 v[30:31], v6 offset:4608
    ds_read_b64_tr_b16 v[16:17], v6 offset:32
    ds_read_b64_tr_b16 v[18:19], v6 offset:544
    ds_read_b64_tr_b16 v[32:33], v6 offset:4128
    ds_read_b64_tr_b16 v[34:35], v6 offset:4640
    ds_read_b64_tr_b16 v[20:21], v6 offset:64
    ds_read_b64_tr_b16 v[22:23], v6 offset:576
    ds_read_b64_tr_b16 v[36:37], v6 offset:4160
    ds_read_b64_tr_b16 v[38:39], v6 offset:4672
    ds_read_b64_tr_b16 v[24:25], v6 offset:96
    ds_read_b64_tr_b16 v[26:27], v6 offset:608
    ds_read_b64_tr_b16 v[40:41], v6 offset:4192
    ds_read_b64_tr_b16 v[42:43], v6 offset:4704
    s_lshl_b32 s49, s56, 2
    s_cmp_ge_u32 s55, 270
    s_cbranch_scc1 RGU_165
    s_lshl_b32 s53, s57, 1
    s_add_u32 s53, s53, 0
    s_mul_i32 s54, s53, 37
    s_lshr_b32 s54, s54, 8
    s_mul_i32 s50, s54, 7
    s_sub_u32 s53, s53, s50
    s_lshl_b32 s50, s53, 2
    s_lshr_b32 s50, 0x2321010, s50
    s_and_b32 s50, s50, 15
    s_mul_i32 s52, s54, 3
    s_add_u32 s52, s52, 31
    s_lshl_b32 s54, s54, 2
    s_bitcmp1_b32 s53, 1
    s_cselect_b32 s52, s52, s54
    s_add_u32 s52, s52, s50
    s_mul_i32 s52, s52, 5120
    s_add_u32 s52, s52, 0x1200000
    s_lshl_b32 s53, s57, 1
    s_add_u32 s53, s53, 1
    s_mul_i32 s54, s53, 37
    s_lshr_b32 s54, s54, 8
    s_mul_i32 s50, s54, 7
    s_sub_u32 s53, s53, s50
    s_lshl_b32 s50, s53, 2
    s_lshr_b32 s50, 0x2321010, s50
    s_and_b32 s50, s50, 15
    s_mul_i32 s59, s54, 3
    s_add_u32 s59, s59, 31
    s_lshl_b32 s54, s54, 2
    s_bitcmp1_b32 s53, 1
    s_cselect_b32 s59, s59, s54
    s_add_u32 s59, s59, s50
    s_mul_i32 s59, s59, 5120
    s_add_u32 s59, s59, 0x1200000
    s_mul_i32 s50, s49, 205
    s_lshr_b32 s50, s50, 10
    s_mul_i32 s50, s50, 271360
    s_lshl_b32 s53, s49, 10
    s_add_u32 s53, s53, s50
    s_add_u32 s54, s53, s59
    s_add_u32 s53, s53, s52
    s_add_u32 s49, s49, 1
    s_waitcnt lgkmcnt(12)
    buffer_store_dwordx4 v[12:15], v1, s[12:15], s53 offen sc1
    buffer_store_dwordx4 v[28:31], v1, s[12:15], s54 offen sc1
    s_mul_i32 s50, s49, 205
    s_lshr_b32 s50, s50, 10
    s_mul_i32 s50, s50, 271360
    s_lshl_b32 s53, s49, 10
    s_add_u32 s53, s53, s50
    s_add_u32 s54, s53, s59
    s_add_u32 s53, s53, s52
    s_add_u32 s49, s49, 1
    s_waitcnt lgkmcnt(8)
    buffer_store_dwordx4 v[16:19], v1, s[12:15], s53 offen sc1
    buffer_store_dwordx4 v[32:35], v1, s[12:15], s54 offen sc1
    s_mul_i32 s50, s49, 205
    s_lshr_b32 s50, s50, 10
    s_mul_i32 s50, s50, 271360
    s_lshl_b32 s53, s49, 10
    s_add_u32 s53, s53, s50
    s_add_u32 s54, s53, s59
    s_add_u32 s53, s53, s52
    s_add_u32 s49, s49, 1
    s_waitcnt lgkmcnt(4)
    buffer_store_dwordx4 v[20:23], v1, s[12:15], s53 offen sc1
    buffer_store_dwordx4 v[36:39], v1, s[12:15], s54 offen sc1
    s_mul_i32 s50, s49, 205
    s_lshr_b32 s50, s50, 10
    s_mul_i32 s50, s50, 271360
    s_lshl_b32 s53, s49, 10
    s_add_u32 s53, s53, s50
    s_add_u32 s54, s53, s59
    s_add_u32 s53, s53, s52
    s_add_u32 s49, s49, 1
    s_waitcnt lgkmcnt(0)
    buffer_store_dwordx4 v[24:27], v1, s[12:15], s53 offen sc1
    buffer_store_dwordx4 v[40:43], v1, s[12:15], s54 offen sc1
    s_branch SUB_P_END
RGU_165:
    s_mul_i32 s50, s49, 147
    s_lshr_b32 s50, s50, 10
    s_mul_i32 s50, s50, 448
    s_lshl_b32 s59, s49, 6
    s_add_u32 s59, s59, s50
    s_add_u32 s49, s49, 1
    s_waitcnt lgkmcnt(12)
    v_mfma_f32_16x16x32_bf16 v[44:47], v[12:15], v[60:63], 0
    v_mfma_f32_16x16x32_bf16 v[44:47], v[28:31], v[60:63], v[44:47]
    s_mul_i32 s50, s49, 147
    s_lshr_b32 s50, s50, 10
    s_mul_i32 s50, s50, 448
    s_lshl_b32 s60, s49, 6
    s_add_u32 s60, s60, s50
    s_add_u32 s49, s49, 1
    s_waitcnt lgkmcnt(8)
    v_mfma_f32_16x16x32_bf16 v[48:51], v[16:19], v[60:63], 0
    v_mfma_f32_16x16x32_bf16 v[48:51], v[32:35], v[60:63], v[48:51]
    s_mul_i32 s50, s49, 147
    s_lshr_b32 s50, s50, 10
    s_mul_i32 s50, s50, 448
    s_lshl_b32 s61, s49, 6
    s_add_u32 s61, s61, s50
    s_add_u32 s49, s49, 1
    s_waitcnt lgkmcnt(4)
    v_mfma_f32_16x16x32_bf16 v[52:55], v[20:23], v[60:63], 0
    v_mfma_f32_16x16x32_bf16 v[52:55], v[36:39], v[60:63], v[52:55]
    s_mul_i32 s50, s49, 147
    s_lshr_b32 s50, s50, 10
    s_mul_i32 s50, s50, 448
    s_lshl_b32 s62, s49, 6
    s_add_u32 s62, s62, s50
    s_add_u32 s49, s49, 1
    s_waitcnt lgkmcnt(0)
    v_mfma_f32_16x16x32_bf16 v[56:59], v[24:27], v[60:63], 0
    v_mfma_f32_16x16x32_bf16 v[56:59], v[40:43], v[60:63], v[56:59]
    s_mul_i32 s49, s57, 14336
    s_cmp_ge_u32 s55, 540
    s_cselect_b32 s50, 448, 0
    s_add_u32 s49, s49, s50
    v_add_u32 v9, s49, v3
    s_mov_b32 exec_lo, 0x00010001
    s_mov_b32 exec_hi, 0x00010001
    buffer_store_dwordx4 v[44:47], v9, s[12:15], s59 offen sc1
    buffer_store_dwordx4 v[48:51], v9, s[12:15], s60 offen sc1
    buffer_store_dwordx4 v[52:55], v9, s[12:15], s61 offen sc1
    buffer_store_dwordx4 v[56:59], v9, s[12:15], s62 offen sc1
    s_mov_b64 exec, -1
    s_nop 1
SUB_P_END:
    s_cmp_eq_u32 s47, 0
    s_cbranch_scc1 RET_149
    s_cmp_eq_u32 s47, 1
    s_cbranch_scc1 RET_151
    s_cmp_eq_u32 s47, 2
    s_cbranch_scc1 RET_153
    s_branch RET_154
PWAVE:
    s_getreg_b32 s52, hwreg(HW_REG_XCC_ID, 0, 3)
    s_lshl_b32 s49, s52, 7
    s_add_u32 s49, s49, 0x1582000
    v_mov_b32 v2, 0
    v_mov_b32 v8, 31
    v_mov_b32 v9, 145664
    s_waitcnt lgkmcnt(0)
    s_mov_b32 s12, s34
    s_mov_b32 s13, s35
    s_mov_b32 s14, 0x1600000
    s_mov_b32 s15, 0x20000
    s_mov_b64 exec, 1
    buffer_atomic_inc v8, v2, s[12:15], s49 offen sc0 sc1
    s_mov_b64 exec, -1
    s_mov_b32 s4, s16
    s_mov_b32 s5, s17
    s_mov_b32 s6, 0x280000
    s_mov_b32 s7, 0x20000
    s_mov_b32 s8, s18
    s_mov_b32 s9, s19
    s_mov_b32 s10, 0x258000
    s_mov_b32 s11, 0x20000
    v_min_u32 v10, 59, v0
    v_lshlrev_b32 v10, 7, v10
    s_lshr_b32 s50, s2, 3
    s_mul_i32 s51, s50, 7680
    buffer_load_dword v11, v10, s[8:11], s51 offen
    s_mul_i32 s50, s50, 26
    v_min_u32 v12, 25, v0
    v_add_u32 v12, s50, v12
    v_mul_u32_u24 v13, 1366, v12
    v_lshrrev_b32 v13, 12, v13
    v_mul_u32_u24 v14, 3, v13
    v_sub_u32 v12, v12, v14
    s_mov_b32 s50, s52
    s_lshl_b32 s50, s50, 8
    s_sub_u32 s50, s50, 16
    v_add_u32 v13, s50, v13
    v_max_i32 v13, 0, v13
    v_mul_u32_u24 v13, 1280, v13
    v_lshl_add_u32 v13, v12, 7, v13
    buffer_load_dword v11, v13, s[4:7], 0 offen
    s_add_u32 s51, s51, 245760
    buffer_load_dword v11, v10, s[8:11], s51 offen
    s_add_u32 s51, s51, 245760
    buffer_load_dword v11, v10, s[8:11], s51 offen
    s_mov_b32 s36, s32
    s_mov_b32 s37, s33
    s_mov_b32 s38, 0x80
    s_mov_b32 s39, 0x20000
    s_add_u32 s36, s36, 128
    s_addc_u32 s37, s37, 0
    v_lshlrev_b32 v1, 4, v0
    v_and_b32 v3, 15, v0
    v_lshlrev_b32 v5, 2, v3
    v_lshlrev_b32 v3, 3, v3
    v_mov_b32 v254, 144384
    s_waitcnt vmcnt(4)
    v_min_u32 v8, 31, v8
    v_lshl_add_u32 v8, v8, 3, s52
    s_mov_b64 exec, 1
    ds_write_b32 v9, v8
    s_mov_b64 exec, -1
    s_waitcnt lgkmcnt(0)
    v_mov_b32 v58, 145664
    s_barrier
    ds_read_b32 v58, v58
    s_waitcnt lgkmcnt(0)
    v_readfirstlane_b32 s2, v58
    s_nop 0
    s_and_b32 s41, s2, 7
    s_lshl_b32 s41, s41, 1
    s_lshr_b32 s42, s2, 7
    s_add_u32 s41, s41, s42
    s_lshr_b32 s42, s2, 3
    s_and_b32 s42, s42, 15
    s_lshr_b32 s43, s42, 3
    s_lshl_b32 s44, s41, 1
    s_add_u32 s43, s43, s44
    s_and_b32 s44, s42, 7
    s_mul_i32 s3, s43, 2
    s_mul_i32 s91, s44, 1
    s_add_u32 s3, s3, s91
    s_mul_i32 s91, s3, 147
    s_lshr_b32 s91, s91, 10
    s_mul_i32 s91, s91, 7
    s_sub_u32 s3, s3, s91
    v_and_b32 v58, 3, v0
    v_lshlrev_b32 v58, 8, v58
    v_add_u32 v58, 144384, v58
    s_lshl_b32 s48, s41, 8
    s_add_u32 s48, s48, 0x1583000
    s_lshl_b32 s49, s42, 4
    s_add_u32 s49, s49, s48
    s_lshl_b32 s50, s2, 2
    s_add_u32 s50, s50, 0x1581000
    v_lshlrev_b32 v5, 2, v0
    v_add_u32 v4, s49, v5
    v_writelane_b32 v4, s50, 4
    s_mov_b64 exec, 31
    buffer_store_dword v2, v4, s[12:15], 0 offen sc1
    s_mov_b64 exec, -1
    s_lshl_b32 s49, s52, 2
    s_lshl_b32 s52, 1, s49
    v_mov_b32 v8, 1
    v_mov_b32 v9, s52
    s_lshl_b32 s52, s52, 4
    s_lshl_b32 s49, s41, 3
    v_mov_b32 v10, s49
    s_waitcnt vmcnt(0)
    s_mov_b64 exec, 1
    buffer_atomic_add_x2 v[8:9], v10, s[36:39], 0 offen sc1
    s_mov_b64 exec, -1
    s_mov_b32 s91, 0
SP_167:
    s_sleep 4
    ds_read_b32 v59, v58
    s_add_u32 s91, s91, 1
    s_waitcnt lgkmcnt(0)
    v_cmp_le_u32 vcc, 14, v59
    s_cmp_ge_u32 s91, 400000
    s_cbranch_scc1 OK_166
    s_cmp_lg_u64 vcc, -1
    s_cbranch_scc1 SP_167
OK_166:
    s_mov_b32 s47, 0
SP_168:
    buffer_load_dwordx2 v[56:57], v3, s[36:39], 0 offen sc1
    buffer_load_dword v8, v5, s[12:15], s48 offen sc1
    s_waitcnt vmcnt(0)
    v_readlane_b32 s50, v56, s41
    v_readlane_b32 s51, v57, s41
    s_cmp_eq_u32 s50, 16
    s_cbranch_scc1 SQ_169
    s_sleep 16
    s_add_u32 s47, s47, 1
    s_cmp_lt_u32 s47, 20000
    s_cbranch_scc1 SP_168
SQ_169:
    v_mov_b32 v13, 1
    s_mov_b64 exec, 1
    ds_write_b32 v254, v13 offset:1032
    s_mov_b64 exec, -1
    s_mov_b32 s91, 0
SP_171:
    s_sleep 1
    ds_read_b32 v59, v58
    s_add_u32 s91, s91, 1
    s_waitcnt lgkmcnt(0)
    v_cmp_le_u32 vcc, 25, v59
    s_cmp_ge_u32 s91, 400000
    s_cbranch_scc1 OK_170
    s_cmp_lg_u64 vcc, -1
    s_cbranch_scc1 SP_171
OK_170:
    s_mov_b32 s47, 0
SP_172:
    buffer_load_dword v12, v3, s[36:39], 0 offen sc1
    s_waitcnt vmcnt(0)
    v_cmp_eq_u32 vcc, 16, v12
    s_nop 0
    s_cmp_eq_u64 vcc, -1
    s_cbranch_scc1 SQ_173
    s_sleep 16
    s_add_u32 s47, s47, 1
    s_cmp_lt_u32 s47, 20000
    s_cbranch_scc1 SP_172
SQ_173:
    s_mov_b32 s91, 0
SP_175:
    s_sleep 1
    ds_read_b32 v59, v58
    s_add_u32 s91, s91, 1
    s_waitcnt lgkmcnt(0)
    v_cmp_le_u32 vcc, 30, v59
    s_cmp_ge_u32 s91, 400000
    s_cbranch_scc1 OK_174
    s_cmp_lg_u64 vcc, -1
    s_cbranch_scc1 SP_175
OK_174:
    s_mov_b32 s54, 0x1581000
    s_mov_b32 s47, 0
SP_176:
    buffer_load_dwordx4 v[8:11], v1, s[12:15], s54 offen sc1
    s_waitcnt vmcnt(0)
    v_min_u32 v8, v8, v9
    v_min3_u32 v8, v8, v10, v11
    v_cmp_le_u32 vcc, 1, v8
    s_nop 0
    s_cmp_eq_u64 vcc, -1
    s_cbranch_scc1 SQ_177
    s_sleep 16
    s_add_u32 s47, s47, 1
    s_cmp_lt_u32 s47, 20000
    s_cbranch_scc1 SP_176
SQ_177:
    v_mov_b32 v13, 1
    s_mov_b64 exec, 1
    ds_write_b32 v254, v13 offset:1036
    s_mov_b64 exec, -1
    s_mul_i32 s49, s42, 896
    s_add_u32 s49, s49, 0x1540000
    v_min_u32 v8, 880, v1
    s_mov_b32 s50, 143360
    buffer_load_dwordx4 v[16:19], v8, s[12:15], s49 offen sc1
    s_add_u32 s49, s49, 14336
    buffer_load_dwordx4 v[20:23], v8, s[12:15], s49 offen sc1
    s_add_u32 s49, s49, 14336
    buffer_load_dwordx4 v[24:27], v8, s[12:15], s49 offen sc1
    s_add_u32 s49, s49, 14336
    buffer_load_dwordx4 v[28:31], v8, s[12:15], s49 offen sc1
    s_add_u32 s49, s49, 14336
    buffer_load_dwordx4 v[32:35], v8, s[12:15], s49 offen sc1
    s_add_u32 s49, s49, 14336
    buffer_load_dwordx4 v[36:39], v8, s[12:15], s49 offen sc1
    s_add_u32 s49, s49, 14336
    buffer_load_dwordx4 v[40:43], v8, s[12:15], s49 offen sc1
    s_add_u32 s49, s49, 14336
    buffer_load_dwordx4 v[44:47], v8, s[12:15], s49 offen sc1
    s_add_u32 s49, s49, 14336
    buffer_load_dwordx4 v[48:51], v8, s[12:15], s49 offen sc1
    s_add_u32 s49, s49, 14336
    buffer_load_dwordx4 v[52:55], v8, s[12:15], s49 offen sc1
    s_and_b32 s49, s42, 1
    s_lshl_b32 s49, s49, 6
    v_cmp_le_u32 vcc, 448, v8
    s_nop 1
    v_cndmask_b32 v9, 0, 1, vcc
    v_mul_u32_u24 v9, 448, v9
    v_sub_u32 v8, v8, v9
    v_subrev_u32 v8, s49, v8
    v_add_u32 v10, 448, v8
    v_min_u32 v8, v8, v10
    v_add3_u32 v8, v8, v9, s50
    s_waitcnt vmcnt(0)
    v_add_f32 v16, v16, v20
    v_add_f32 v17, v17, v21
    v_add_f32 v18, v18, v22
    v_add_f32 v19, v19, v23
    v_add_f32 v16, v16, v24
    v_add_f32 v17, v17, v25
    v_add_f32 v18, v18, v26
    v_add_f32 v19, v19, v27
    v_add_f32 v16, v16, v28
    v_add_f32 v17, v17, v29
    v_add_f32 v18, v18, v30
    v_add_f32 v19, v19, v31
    v_add_f32 v16, v16, v32
    v_add_f32 v17, v17, v33
    v_add_f32 v18, v18, v34
    v_add_f32 v19, v19, v35
    v_add_f32 v16, v16, v36
    v_add_f32 v17, v17, v37
    v_add_f32 v18, v18, v38
    v_add_f32 v19, v19, v39
    v_add_f32 v16, v16, v40
    v_add_f32 v17, v17, v41
    v_add_f32 v18, v18, v42
    v_add_f32 v19, v19, v43
    v_add_f32 v16, v16, v44
    v_add_f32 v17, v17, v45
    v_add_f32 v18, v18, v46
    v_add_f32 v19, v19, v47
    v_add_f32 v16, v16, v48
    v_add_f32 v17, v17, v49
    v_add_f32 v18, v18, v50
    v_add_f32 v19, v19, v51
    v_add_f32 v16, v16, v52
    v_add_f32 v17, v17, v53
    v_add_f32 v18, v18, v54
    v_add_f32 v19, v19, v55
    ds_write_b128 v8, v[16:19]
    v_mov_b32 v13, 2
    s_mov_b64 exec, 1
    ds_write_b32 v254, v13 offset:1036
    s_mov_b64 exec, -1
    s_waitcnt lgkmcnt(0)
LEND:
    s_endpgm
SP_6s:
    s_mov_b32 s91, 0
SP_6:
    ds_read_b64 v[252:253], v254 offset:1024
    s_add_u32 s91, s91, 1
    s_waitcnt lgkmcnt(0)
    v_min_u32 v252, v252, v253
    s_nop 0
    v_readfirstlane_b32 s92, v252
    s_cmp_ge_u32 s91, 400000
    s_cbranch_scc1 OK_5
    s_cmp_lt_u32 s92, s54
    s_cbranch_scc1 SP_6
    s_branch OK_5
SP_8s:
    s_mov_b32 s91, 0
SP_8:
    ds_read_b64 v[252:253], v254 offset:1024
    s_add_u32 s91, s91, 1
    s_waitcnt lgkmcnt(0)
    v_min_u32 v252, v252, v253
    s_nop 0
    v_readfirstlane_b32 s92, v252
    s_cmp_ge_u32 s91, 400000
    s_cbranch_scc1 OK_7
    s_cmp_lt_u32 s92, s54
    s_cbranch_scc1 SP_8
    s_branch OK_7
XCAP:
    s_cmp_lg_u32 s48, s58
    s_cbranch_scc1 XR_178
    v_add_u32 v101, s46, v107
    ds_read_b64 v[240:241], v101
XR_178:
    s_cmp_lg_u32 s48, s59
    s_cbranch_scc1 XR_179
    v_add_u32 v101, s46, v108
    ds_read_b64 v[242:243], v101
XR_179:
    s_cmp_lg_u32 s48, s60
    s_cbranch_scc1 XR_180
    v_add_u32 v101, s46, v109
    ds_read_b64 v[244:245], v101
XR_180:
    s_cmp_lg_u32 s48, s61
    s_cbranch_scc1 XR_181
    v_add_u32 v101, s46, v110
    ds_read_b64 v[246:247], v101
XR_181:
    s_cmp_lg_u32 s48, s62
    s_cbranch_scc1 XR_182
    v_add_u32 v101, s46, v111
    ds_read_b64 v[248:249], v101
XR_182:
    s_branch XCAPR
SP_11s:
    s_mov_b32 s91, 0
SP_11:
    ds_read_b32 v134, v238
    s_add_u32 s91, s91, 1
    s_waitcnt lgkmcnt(0)
    v_cmp_le_u32 vcc, 22, v134
    s_cmp_ge_u32 s91, 400000
    s_cbranch_scc1 OK_10
    s_cmp_lg_u64 vcc, -1
    s_cbranch_scc1 SP_11
    s_branch OK_10
SP_22s:
    s_mov_b32 s91, 0
SP_22:
    ds_read_b32 v57, v51
    s_add_u32 s91, s91, 1
    s_waitcnt lgkmcnt(0)
    v_cmp_le_u32 vcc, 26, v57
    s_cmp_ge_u32 s91, 400000
    s_cbranch_scc1 OK_21
    s_cmp_lg_u64 vcc, -1
    s_cbranch_scc1 SP_22
    s_branch OK_21
SP_32s:
    s_mov_b32 s91, 0
SP_32:
    ds_read_b64 v[252:253], v254 offset:1024
    s_add_u32 s91, s91, 1
    s_waitcnt lgkmcnt(0)
    v_min_u32 v252, v252, v253
    s_nop 0
    v_readfirstlane_b32 s92, v252
    s_cmp_ge_u32 s91, 400000
    s_cbranch_scc1 OK_31
    s_cmp_lt_u32 s92, 23
    s_cbranch_scc1 SP_32
    s_branch OK_31
SP_34s:
    s_mov_b32 s91, 0
SP_34:
    ds_read_b64 v[252:253], v254 offset:1024
    s_add_u32 s91, s91, 1
    s_waitcnt lgkmcnt(0)
    v_min_u32 v252, v252, v253
    s_nop 0
    v_readfirstlane_b32 s92, v252
    s_cmp_ge_u32 s91, 400000
    s_cbranch_scc1 OK_33
    s_cmp_lt_u32 s92, 24
    s_cbranch_scc1 SP_34
    s_branch OK_33
SP_36s:
    s_mov_b32 s91, 0
SP_36:
    ds_read_b64 v[252:253], v254 offset:1024
    s_add_u32 s91, s91, 1
    s_waitcnt lgkmcnt(0)
    v_min_u32 v252, v252, v253
    s_nop 0
    v_readfirstlane_b32 s92, v252
    s_cmp_ge_u32 s91, 400000
    s_cbranch_scc1 OK_35
    s_cmp_lt_u32 s92, 25
    s_cbranch_scc1 SP_36
    s_branch OK_35
SP_38s:
    s_mov_b32 s91, 0
SP_38:
    ds_read_b64 v[252:253], v254 offset:1024
    s_add_u32 s91, s91, 1
    s_waitcnt lgkmcnt(0)
    v_min_u32 v252, v252, v253
    s_nop 0
    v_readfirstlane_b32 s92, v252
    s_cmp_ge_u32 s91, 400000
    s_cbranch_scc1 OK_37
    s_cmp_lt_u32 s92, 26
    s_cbranch_scc1 SP_38
    s_branch OK_37
SP_40s:
    s_mov_b32 s91, 0
SP_40:
    ds_read_b64 v[252:253], v254 offset:1024
    s_add_u32 s91, s91, 1
    s_waitcnt lgkmcnt(0)
    v_min_u32 v252, v252, v253
    s_nop 0
    v_readfirstlane_b32 s92, v252
    s_cmp_ge_u32 s91, 400000
    s_cbranch_scc1 OK_39
    s_cmp_lt_u32 s92, 27
    s_cbranch_scc1 SP_40
    s_branch OK_39
SP_42s:
    s_mov_b32 s91, 0
SP_42:
    ds_read_b64 v[252:253], v254 offset:1024
    s_add_u32 s91, s91, 1
    s_waitcnt lgkmcnt(0)
    v_min_u32 v252, v252, v253
    s_nop 0
    v_readfirstlane_b32 s92, v252
    s_cmp_ge_u32 s91, 400000
    s_cbranch_scc1 OK_41
    s_cmp_lt_u32 s92, 28
    s_cbranch_scc1 SP_42
    s_branch OK_41
SP_44s:
    s_mov_b32 s91, 0
SP_44:
    ds_read_b64 v[252:253], v254 offset:1024
    s_add_u32 s91, s91, 1
    s_waitcnt lgkmcnt(0)
    v_min_u32 v252, v252, v253
    s_nop 0
    v_readfirstlane_b32 s92, v252
    s_cmp_ge_u32 s91, 400000
    s_cbranch_scc1 OK_43
    s_cmp_lt_u32 s92, 29
    s_cbranch_scc1 SP_44
    s_branch OK_43
SP_46s:
    s_mov_b32 s91, 0
SP_46:
    ds_read_b64 v[252:253], v254 offset:1024
    s_add_u32 s91, s91, 1
    s_waitcnt lgkmcnt(0)
    v_min_u32 v252, v252, v253
    s_nop 0
    v_readfirstlane_b32 s92, v252
    s_cmp_ge_u32 s91, 400000
    s_cbranch_scc1 OK_45
    s_cmp_lt_u32 s92, 30
    s_cbranch_scc1 SP_46
    s_branch OK_45
SP_48s:
    s_mov_b32 s91, 0
SP_48:
    ds_read_b64 v[252:253], v254 offset:1024
    s_add_u32 s91, s91, 1
    s_waitcnt lgkmcnt(0)
    v_min_u32 v252, v252, v253
    s_nop 0
    v_readfirstlane_b32 s92, v252
    s_cmp_ge_u32 s91, 400000
    s_cbranch_scc1 OK_47
    s_cmp_lt_u32 s92, 31
    s_cbranch_scc1 SP_48
    s_branch OK_47
SP_50s:
    s_mov_b32 s91, 0
SP_50:
    ds_read_b32 v252, v254 offset:1036
    s_add_u32 s91, s91, 1
    s_waitcnt lgkmcnt(0)
    v_readfirstlane_b32 s92, v252
    s_cmp_ge_u32 s91, 400000
    s_cbranch_scc1 OK_49
    s_cmp_lt_u32 s92, 2
    s_cbranch_scc1 SP_50
    s_branch OK_49
LS_56:
    s_mov_b32 s91, 0
LS_56l:
    buffer_load_dword v238, v177, s[12:15], s62 offen sc1
    s_add_u32 s91, s91, 1
    s_waitcnt vmcnt(0)
    s_cmp_ge_u32 s91, 80000
    s_cbranch_scc1 LK_55
    v_cmp_le_u32 vcc, 4, v238
    s_nop 0
    s_and_b64 vcc, vcc, s[60:61]
    s_cmp_lg_u64 vcc, s[60:61]
    s_cbranch_scc1 LS_56l
    s_branch LK_55
SP_58s:
    s_mov_b32 s91, 0
SP_58:
    ds_read_b64 v[252:253], v254 offset:1024
    s_add_u32 s91, s91, 1
    s_waitcnt lgkmcnt(0)
    v_min_u32 v252, v252, v253
    s_nop 0
    v_readfirstlane_b32 s92, v252
    s_cmp_ge_u32 s91, 400000
    s_cbranch_scc1 OK_57
    s_cmp_lt_u32 s92, 37
    s_cbranch_scc1 SP_58
    s_branch OK_57
SP_60s:
    s_mov_b32 s91, 0
SP_60:
    ds_read_b64 v[252:253], v254 offset:1024
    s_add_u32 s91, s91, 1
    s_waitcnt lgkmcnt(0)
    v_min_u32 v252, v252, v253
    s_nop 0
    v_readfirstlane_b32 s92, v252
    s_cmp_ge_u32 s91, 400000
    s_cbranch_scc1 OK_59
    s_cmp_lt_u32 s92, 40
    s_cbranch_scc1 SP_60
    s_branch OK_59
SP_62s:
    s_mov_b32 s91, 0
SP_62:
    ds_read_b64 v[252:253], v254 offset:1024
    s_add_u32 s91, s91, 1
    s_waitcnt lgkmcnt(0)
    v_min_u32 v252, v252, v253
    s_nop 0
    v_readfirstlane_b32 s92, v252
    s_cmp_ge_u32 s91, 400000
    s_cbranch_scc1 OK_61
    s_cmp_lt_u32 s92, 43
    s_cbranch_scc1 SP_62
    s_branch OK_61
SP_64s:
    s_mov_b32 s91, 0
SP_64:
    ds_read_b64 v[252:253], v254 offset:1024
    s_add_u32 s91, s91, 1
    s_waitcnt lgkmcnt(0)
    v_min_u32 v252, v252, v253
    s_nop 0
    v_readfirstlane_b32 s92, v252
    s_cmp_ge_u32 s91, 400000
    s_cbranch_scc1 OK_63
    s_cmp_lt_u32 s92, 46
    s_cbranch_scc1 SP_64
    s_branch OK_63
SP_66s:
    s_mov_b32 s91, 0
SP_66:
    ds_read_b64 v[252:253], v254 offset:1024
    s_add_u32 s91, s91, 1
    s_waitcnt lgkmcnt(0)
    v_min_u32 v252, v252, v253
    s_nop 0
    v_readfirstlane_b32 s92, v252
    s_cmp_ge_u32 s91, 400000
    s_cbranch_scc1 OK_65
    s_cmp_lt_u32 s92, 49
    s_cbranch_scc1 SP_66
    s_branch OK_65
SP_68s:
    s_mov_b32 s91, 0
SP_68:
    ds_read_b64 v[252:253], v254 offset:1024
    s_add_u32 s91, s91, 1
    s_waitcnt lgkmcnt(0)
    v_min_u32 v252, v252, v253
    s_nop 0
    v_readfirstlane_b32 s92, v252
    s_cmp_ge_u32 s91, 400000
    s_cbranch_scc1 OK_67
    s_cmp_lt_u32 s92, 52
    s_cbranch_scc1 SP_68
    s_branch OK_67
SP_70s:
    s_mov_b32 s91, 0
SP_70:
    ds_read_b64 v[252:253], v254 offset:1024
    s_add_u32 s91, s91, 1
    s_waitcnt lgkmcnt(0)
    v_min_u32 v252, v252, v253
    s_nop 0
    v_readfirstlane_b32 s92, v252
    s_cmp_ge_u32 s91, 400000
    s_cbranch_scc1 OK_69
    s_cmp_lt_u32 s92, 55
    s_cbranch_scc1 SP_70
    s_branch OK_69
SP_72s:
    s_mov_b32 s91, 0
SP_72:
    ds_read_b64 v[252:253], v254 offset:1024
    s_add_u32 s91, s91, 1
    s_waitcnt lgkmcnt(0)
    v_min_u32 v252, v252, v253
    s_nop 0
    v_readfirstlane_b32 s92, v252
    s_cmp_ge_u32 s91, 400000
    s_cbranch_scc1 OK_71
    s_cmp_lt_u32 s92, 58
    s_cbranch_scc1 SP_72
    s_branch OK_71
SP_76s:
    s_mov_b32 s91, 0
SP_76:
    ds_read_b32 v53, v54
    s_add_u32 s91, s91, 1
    s_waitcnt lgkmcnt(0)
    v_cmp_le_u32 vcc, 56, v53
    s_cmp_ge_u32 s91, 400000
    s_cbranch_scc1 OK_75
    s_cmp_lg_u64 vcc, -1
    s_cbranch_scc1 SP_76
    s_branch OK_75
SP_80s:
    s_waitcnt vmcnt(0)
    v_mov_b32 v6, s55
    s_mov_b64 exec, 1
    ds_max_u32 v7, v6
    s_mov_b64 exec, -1
    s_mov_b32 s91, 0
SP_80:
    s_sleep 1
    ds_read_b32 v5, v4
    s_add_u32 s91, s91, 1
    s_waitcnt lgkmcnt(0)
    v_cmp_le_u32 vcc, s57, v5
    s_cmp_ge_u32 s91, 400000
    s_cbranch_scc1 OK_79
    s_cmp_lg_u64 vcc, -1
    s_cbranch_scc1 SP_80
    s_branch OK_79
SP_82s:
    s_waitcnt vmcnt(0)
    v_mov_b32 v6, s58
    s_mov_b64 exec, 1
    ds_max_u32 v7, v6
    s_mov_b64 exec, -1
    s_mov_b32 s91, 0
SP_82:
    s_sleep 1
    ds_read_b32 v5, v4
    s_add_u32 s91, s91, 1
    s_waitcnt lgkmcnt(0)
    v_cmp_le_u32 vcc, s57, v5
    s_cmp_ge_u32 s91, 400000
    s_cbranch_scc1 OK_81
    s_cmp_lg_u64 vcc, -1
    s_cbranch_scc1 SP_82
    s_branch OK_81
SP_91s:
    s_waitcnt vmcnt(0)
    v_mov_b32 v6, 22
    s_mov_b64 exec, 1
    ds_max_u32 v7, v6
    s_mov_b64 exec, -1
    s_mov_b32 s91, 0
SP_91:
    s_sleep 1
    ds_read_b32 v5, v4
    s_add_u32 s91, s91, 1
    s_waitcnt lgkmcnt(0)
    v_cmp_le_u32 vcc, 26, v5
    s_cmp_ge_u32 s91, 400000
    s_cbranch_scc1 OK_90
    s_cmp_lg_u64 vcc, -1
    s_cbranch_scc1 SP_91
    s_branch OK_90
SP_94s:
    s_waitcnt vmcnt(0)
    v_mov_b32 v6, 23
    s_mov_b64 exec, 1
    ds_max_u32 v7, v6
    s_mov_b64 exec, -1
    s_mov_b32 s91, 0
SP_94:
    s_sleep 1
    ds_read_b32 v5, v4
    s_add_u32 s91, s91, 1
    s_waitcnt lgkmcnt(0)
    v_cmp_le_u32 vcc, 29, v5
    s_cmp_ge_u32 s91, 400000
    s_cbranch_scc1 OK_93
    s_cmp_lg_u64 vcc, -1
    s_cbranch_scc1 SP_94
    s_branch OK_93
SP_97s:
    s_waitcnt vmcnt(0)
    v_mov_b32 v6, 24
    s_mov_b64 exec, 1
    ds_max_u32 v7, v6
    s_mov_b64 exec, -1
    s_mov_b32 s91, 0
SP_97:
    s_sleep 1
    ds_read_b32 v5, v4
    s_add_u32 s91, s91, 1
    s_waitcnt lgkmcnt(0)
    v_cmp_le_u32 vcc, 30, v5
    s_cmp_ge_u32 s91, 400000
    s_cbranch_scc1 OK_96
    s_cmp_lg_u64 vcc, -1
    s_cbranch_scc1 SP_97
    s_branch OK_96
SP_100s:
    s_waitcnt vmcnt(0)
    v_mov_b32 v6, 25
    s_mov_b64 exec, 1
    ds_max_u32 v7, v6
    s_mov_b64 exec, -1
    s_mov_b32 s91, 0
SP_100:
    s_sleep 1
    ds_read_b32 v5, v4
    s_add_u32 s91, s91, 1
    s_waitcnt lgkmcnt(0)
    v_cmp_le_u32 vcc, 30, v5
    s_cmp_ge_u32 s91, 400000
    s_cbranch_scc1 OK_99
    s_cmp_lg_u64 vcc, -1
    s_cbranch_scc1 SP_100
    s_branch OK_99
SP_103s:
    s_waitcnt vmcnt(0)
    v_mov_b32 v6, 26
    s_mov_b64 exec, 1
    ds_max_u32 v7, v6
    s_mov_b64 exec, -1
    s_mov_b32 s91, 0
SP_103:
    s_sleep 1
    ds_read_b32 v5, v4
    s_add_u32 s91, s91, 1
    s_waitcnt lgkmcnt(0)
    v_cmp_le_u32 vcc, 31, v5
    s_cmp_ge_u32 s91, 400000
    s_cbranch_scc1 OK_102
    s_cmp_lg_u64 vcc, -1
    s_cbranch_scc1 SP_103
    s_branch OK_102
SP_106s:
    s_waitcnt vmcnt(0)
    v_mov_b32 v6, 27
    s_mov_b64 exec, 1
    ds_max_u32 v7, v6
    s_mov_b64 exec, -1
    s_mov_b32 s91, 0
SP_106:
    s_sleep 1
    ds_read_b32 v5, v4
    s_add_u32 s91, s91, 1
    s_waitcnt lgkmcnt(0)
    v_cmp_le_u32 vcc, 32, v5
    s_cmp_ge_u32 s91, 400000
    s_cbranch_scc1 OK_105
    s_cmp_lg_u64 vcc, -1
    s_cbranch_scc1 SP_106
    s_branch OK_105
SP_109s:
    s_waitcnt vmcnt(0)
    v_mov_b32 v6, 28
    s_mov_b64 exec, 1
    ds_max_u32 v7, v6
    s_mov_b64 exec, -1
    s_mov_b32 s91, 0
SP_109:
    s_sleep 1
    ds_read_b32 v5, v4
    s_add_u32 s91, s91, 1
    s_waitcnt lgkmcnt(0)
    v_cmp_le_u32 vcc, 33, v5
    s_cmp_ge_u32 s91, 400000
    s_cbranch_scc1 OK_108
    s_cmp_lg_u64 vcc, -1
    s_cbranch_scc1 SP_109
    s_branch OK_108
SP_112s:
    s_waitcnt vmcnt(0)
    v_mov_b32 v6, 29
    s_mov_b64 exec, 1
    ds_max_u32 v7, v6
    s_mov_b64 exec, -1
    s_mov_b32 s91, 0
SP_112:
    s_sleep 1
    ds_read_b32 v5, v4
    s_add_u32 s91, s91, 1
    s_waitcnt lgkmcnt(0)
    v_cmp_le_u32 vcc, 34, v5
    s_cmp_ge_u32 s91, 400000
    s_cbranch_scc1 OK_111
    s_cmp_lg_u64 vcc, -1
    s_cbranch_scc1 SP_112
    s_branch OK_111
SP_115s:
    s_waitcnt vmcnt(0)
    v_mov_b32 v6, 30
    s_mov_b64 exec, 1
    ds_max_u32 v7, v6
    s_mov_b64 exec, -1
    s_mov_b32 s91, 0
SP_115:
    s_sleep 1
    ds_read_b32 v5, v4
    s_add_u32 s91, s91, 1
    s_waitcnt lgkmcnt(0)
    v_cmp_le_u32 vcc, 35, v5
    s_cmp_ge_u32 s91, 400000
    s_cbranch_scc1 OK_114
    s_cmp_lg_u64 vcc, -1
    s_cbranch_scc1 SP_115
    s_branch OK_114
SP_120s:
    s_waitcnt vmcnt(0)
    v_mov_b32 v6, 31
    s_mov_b64 exec, 1
    ds_max_u32 v7, v6
    s_mov_b64 exec, -1
    s_mov_b32 s91, 0
SP_120:
    s_sleep 1
    ds_read_b32 v5, v4
    s_add_u32 s91, s91, 1
    s_waitcnt lgkmcnt(0)
    v_cmp_le_u32 vcc, 36, v5
    s_cmp_ge_u32 s91, 400000
    s_cbranch_scc1 OK_119
    s_cmp_lg_u64 vcc, -1
    s_cbranch_scc1 SP_120
    s_branch OK_119
SP_122s:
    s_waitcnt vmcnt(0)
    v_mov_b32 v6, 33
    s_mov_b64 exec, 1
    ds_max_u32 v7, v6
    s_mov_b64 exec, -1
    s_mov_b32 s91, 0
SP_122:
    s_sleep 1
    ds_read_b32 v5, v4
    s_add_u32 s91, s91, 1
    s_waitcnt lgkmcnt(0)
    v_cmp_le_u32 vcc, 37, v5
    s_cmp_ge_u32 s91, 400000
    s_cbranch_scc1 OK_121
    s_cmp_lg_u64 vcc, -1
    s_cbranch_scc1 SP_122
    s_branch OK_121
SP_124s:
    s_waitcnt vmcnt(0)
    v_mov_b32 v6, 35
    s_mov_b64 exec, 1
    ds_max_u32 v7, v6
    s_mov_b64 exec, -1
    s_mov_b32 s91, 0
SP_124:
    s_sleep 1
    ds_read_b32 v5, v4
    s_add_u32 s91, s91, 1
    s_waitcnt lgkmcnt(0)
    v_cmp_le_u32 vcc, 38, v5
    s_cmp_ge_u32 s91, 400000
    s_cbranch_scc1 OK_123
    s_cmp_lg_u64 vcc, -1
    s_cbranch_scc1 SP_124
    s_branch OK_123
SP_126s:
    s_waitcnt vmcnt(0)
    v_mov_b32 v6, 38
    s_mov_b64 exec, 1
    ds_max_u32 v7, v6
    s_mov_b64 exec, -1
    s_mov_b32 s91, 0
SP_126:
    s_sleep 1
    ds_read_b32 v5, v4
    s_add_u32 s91, s91, 1
    s_waitcnt lgkmcnt(0)
    v_cmp_le_u32 vcc, 39, v5
    s_cmp_ge_u32 s91, 400000
    s_cbranch_scc1 OK_125
    s_cmp_lg_u64 vcc, -1
    s_cbranch_scc1 SP_126
    s_branch OK_125
SP_128s:
    s_waitcnt vmcnt(0)
    v_mov_b32 v6, 41
    s_mov_b64 exec, 1
    ds_max_u32 v7, v6
    s_mov_b64 exec, -1
    s_mov_b32 s91, 0
SP_128:
    s_sleep 1
    ds_read_b32 v5, v4
    s_add_u32 s91, s91, 1
    s_waitcnt lgkmcnt(0)
    v_cmp_le_u32 vcc, 40, v5
    s_cmp_ge_u32 s91, 400000
    s_cbranch_scc1 OK_127
    s_cmp_lg_u64 vcc, -1
    s_cbranch_scc1 SP_128
    s_branch OK_127
SP_132s:
    s_mov_b32 s91, 0
SP_132:
    ds_read_b32 v5, v4
    s_add_u32 s91, s91, 1
    s_waitcnt lgkmcnt(0)
    v_cmp_le_u32 vcc, 44, v5
    s_cmp_ge_u32 s91, 400000
    s_cbranch_scc1 OK_131
    s_cmp_lg_u64 vcc, -1
    s_cbranch_scc1 SP_132
    s_branch OK_131
SP_134s:
    s_mov_b32 s91, 0
SP_134:
    ds_read_b32 v5, v4
    s_add_u32 s91, s91, 1
    s_waitcnt lgkmcnt(0)
    v_cmp_le_u32 vcc, 47, v5
    s_cmp_ge_u32 s91, 400000
    s_cbranch_scc1 OK_133
    s_cmp_lg_u64 vcc, -1
    s_cbranch_scc1 SP_134
    s_branch OK_133
SP_136s:
    s_mov_b32 s91, 0
SP_136:
    ds_read_b32 v5, v4
    s_add_u32 s91, s91, 1
    s_waitcnt lgkmcnt(0)
    v_cmp_le_u32 vcc, 50, v5
    s_cmp_ge_u32 s91, 400000
    s_cbranch_scc1 OK_135
    s_cmp_lg_u64 vcc, -1
    s_cbranch_scc1 SP_136
    s_branch OK_135
SP_138s:
    s_mov_b32 s91, 0
SP_138:
    ds_read_b32 v5, v4
    s_add_u32 s91, s91, 1
    s_waitcnt lgkmcnt(0)
    v_cmp_le_u32 vcc, 53, v5
    s_cmp_ge_u32 s91, 400000
    s_cbranch_scc1 OK_137
    s_cmp_lg_u64 vcc, -1
    s_cbranch_scc1 SP_138
    s_branch OK_137
.section .rodata,"a"
.p2align 6
.amdhsa_kernel sequential_preLN__sliding_local_dilated__swiglu_ffn__prompt_kernel
  .amdhsa_next_free_vgpr 256
  .amdhsa_next_free_sgpr 102
  .amdhsa_accum_offset 256
  .amdhsa_group_segment_fixed_size 0
  .amdhsa_kernarg_size 80
  .amdhsa_user_sgpr_count 2
  .amdhsa_user_sgpr_kernarg_segment_ptr 1
  .amdhsa_system_sgpr_workgroup_id_x 1
.end_amdhsa_kernel
```
